```python
import torch

def _softmax(x, axis=-1):
    return torch.softmax(x, dim=axis)

def _gelu(x):
    return torch.nn.functional.gelu(x, approximate='tanh')

def _silu(x):
    return torch.nn.functional.silu(x)

def _sigmoid(x):
    return torch.sigmoid(x)

def _layernorm(x, axis=-1, eps=1e-05):
    m = x.mean(dim=axis, keepdim=True)
    v = x.var(dim=axis, keepdim=True, unbiased=False)
    return (x - m) / torch.sqrt(v + eps)

def _scatter_add(tgt, idx, src, axis=0):
    return tgt.clone().index_add_(axis, idx, src)

def _segment_sum(src, seg, n):
    out = torch.zeros((n,) + src.shape[1:], dtype=src.dtype)
    return out.index_add_(0, seg, src)

def _pad(x, pw):
    flat = tuple((v for pair in reversed(pw) for v in pair))
    return torch.nn.functional.pad(x, flat)
kernel_name = 'adaLN_cond__mha_block_cached__dense_activation_silu__prompt'

def setup_inputs():

    _w = lambda a: (lambda t: t.to(torch.bfloat16) if t.is_floating_point() else t)(torch.as_tensor(a))

    def _A_setup():
        B, Sq, D = (1, 2048, 576)
        H, Sk, Dh = (32, 2048, 128)
        return {'x': _w((lambda *s: torch.randn(*s, dtype=torch.bfloat16) * 0.1)(B, Sq, D)), 'k_cache': _w((lambda *s: torch.randn(*s, dtype=torch.bfloat16) * 0.8)(B, H, Sk, Dh)), 'v_cache': _w((lambda *s: torch.randn(*s, dtype=torch.bfloat16) * 3.2)(B, H, Sk, Dh)), 'wq': _w((lambda *s: torch.randn(*s, dtype=torch.bfloat16) * 0.8)(D, H * Dh) * D ** (-0.5)), 'wo': _w((lambda *s: torch.randn(*s, dtype=torch.bfloat16) * 3.2)(H * Dh, D) * (H * Dh) ** (-0.5))}
    _A_in = _A_setup()

    def _B_setup():
        B, S, D, F = (1, 2048, 576, 4608)
        return {'x': _w((lambda *s: torch.randn(*s, dtype=torch.bfloat16) * 0.1)(B, S, D)), 'w1': _w((lambda *s: torch.randn(*s, dtype=torch.bfloat16) * 3.2)(D, F) * D ** (-0.5)), 'w2': _w((lambda *s: torch.randn(*s, dtype=torch.bfloat16) * 3.2)(F, D) * F ** (-0.5))}
    _B_in = _B_setup()
    return {'A_x': _A_in['x'], 'A_k_cache': _A_in['k_cache'], 'A_v_cache': _A_in['v_cache'], 'A_wq': _A_in['wq'], 'A_wo': _A_in['wo'], 'B_x': _B_in['x'], 'B_w1': _B_in['w1'], 'B_w2': _B_in['w2'], 'c': _w((lambda *s: torch.randn(*s, dtype=torch.bfloat16) * 0.2)(1, 576) * 8.0), 'w_mod': _w((lambda *s: torch.randn(*s, dtype=torch.bfloat16) * 0.2)(576, 6 * 576) * 576 ** (-0.5) * 8.0)}

def reference(A_x, A_k_cache, A_v_cache, A_wq, A_wo, B_x, B_w1, B_w2, c, w_mod):

    def _A_ref(x, k_cache, v_cache, wq, wo):
        B, Sq, D = x.shape
        H, Dh = (32, 128)
        q = (lambda x, *d: x.permute(*d))((x @ wq).reshape(B, Sq, H, Dh), 0, 2, 1, 3)
        scores = torch.einsum('bhqd,bhkd->bhqk', q, k_cache) * Dh ** (-0.5)
        p = _softmax(scores, axis=-1)
        o = torch.einsum('bhqk,bhkd->bhqd', p, v_cache)
        return (lambda x, *d: x.permute(*d))(o, 0, 2, 1, 3).reshape(B, Sq, H * Dh) @ wo

    def _B_ref(x, w1, w2):
        h = torch.einsum('bsd,df->bsf', x, w1)
        h = _silu(h)
        out = torch.einsum('bsf,fd->bsd', h, w2)
        return out
    x = A_x
    mod = (_silu(c) @ w_mod).reshape(c.shape[0], 6, 1, -1)
    sa, ca, ga, sb, cb, gb = (mod[:, 0].clone(), mod[:, 1].clone(), mod[:, 2].clone(), mod[:, 3].clone(), mod[:, 4].clone(), mod[:, 5].clone())
    h = _layernorm(x, axis=-1) * (1 + ca) + sa
    x = x + ga * _A_ref(h, A_k_cache, A_v_cache, A_wq, A_wo)
    h = _layernorm(x, axis=-1) * (1 + cb) + sb
    x = x + gb * _B_ref(h, B_w1, B_w2)
    return x
```

```asm
; @launch kernel=mod_kernel grid=(256,1,1) block=(1024,1,1) lds=8192
; @launch kernel=ln1_kernel grid=(256,1,1) block=(256,1,1) lds=0
; @launch kernel=attn_kernel grid=(256,1,1) block=(256,1,1) lds=163840
; @launch kernel=oproj_kernel grid=(256,1,1) block=(256,1,1) lds=110592
; @launch kernel=ln2_kernel grid=(256,1,1) block=(256,1,1) lds=0
; @launch kernel=ffn1_kernel grid=(256,1,1) block=(512,1,1) lds=159744
; @launch kernel=ffn2_kernel grid=(256,1,1) block=(256,1,1) lds=110592
; @launch kernel=fin_kernel grid=(256,1,1) block=(256,1,1) lds=0
.amdgcn_target "amdgcn-amd-amdhsa--gfx950"
.text
.globl mod_kernel
.p2align 8
.type mod_kernel,@function
mod_kernel:
  s_cmp_ge_u32 s2, 256
  s_cbranch_scc1 mod_end_1
  s_cmp_ge_u32 s2, 108
  s_cbranch_scc1 mod_pf_2
  s_load_dwordx2 s[4:5], s[0:1], 64
  s_load_dwordx2 s[6:7], s[0:1], 72
  s_load_dwordx2 s[8:9], s[0:1], 96
  v_lshrrev_b32 v1, 6, v0
  v_and_b32 v2, 63, v0
  v_lshrrev_b32 v3, 4, v2
  v_and_b32 v6, 15, v2
  v_lshlrev_b32 v6, 2, v6
  v_mul_u32_u24 v4, 36, v1
  v_add_u32 v4, v4, v3
  s_movk_i32 s24, 6912
  v_mul_lo_u32 v5, v4, s24
  s_lshl_b32 s25, s2, 6
  v_add3_u32 v5, v5, v6, s25
  v_lshlrev_b32 v4, 1, v4
  s_waitcnt lgkmcnt(0)
  s_mov_b32 s12, s4
  s_mov_b32 s13, s5
  s_mov_b32 s14, 0x480
  s_mov_b32 s15, 0x00020000
  s_mov_b32 s16, s6
  s_mov_b32 s17, s7
  s_mov_b32 s18, 0x3cc000
  s_mov_b32 s19, 0x00020000
  s_mov_b32 s20, s8
  s_mov_b32 s21, s9
  s_mov_b32 s22, 0x1b00
  s_mov_b32 s23, 0x00020000
  s_mov_b32 s26, 0
  buffer_load_dword v10, v5, s[16:19], s26 offen
  s_mov_b32 s26, 27648
  buffer_load_dword v11, v5, s[16:19], s26 offen
  s_mov_b32 s26, 55296
  buffer_load_dword v12, v5, s[16:19], s26 offen
  s_mov_b32 s26, 82944
  buffer_load_dword v13, v5, s[16:19], s26 offen
  s_mov_b32 s26, 110592
  buffer_load_dword v14, v5, s[16:19], s26 offen
  s_mov_b32 s26, 138240
  buffer_load_dword v15, v5, s[16:19], s26 offen
  s_mov_b32 s26, 165888
  buffer_load_dword v16, v5, s[16:19], s26 offen
  s_mov_b32 s26, 193536
  buffer_load_dword v17, v5, s[16:19], s26 offen
  s_mov_b32 s26, 221184
  buffer_load_dword v18, v5, s[16:19], s26 offen
  buffer_load_ushort v20, v4, s[12:15], 0 offen offset:0
  buffer_load_ushort v21, v4, s[12:15], 0 offen offset:8
  buffer_load_ushort v22, v4, s[12:15], 0 offen offset:16
  buffer_load_ushort v23, v4, s[12:15], 0 offen offset:24
  buffer_load_ushort v24, v4, s[12:15], 0 offen offset:32
  buffer_load_ushort v25, v4, s[12:15], 0 offen offset:40
  buffer_load_ushort v26, v4, s[12:15], 0 offen offset:48
  buffer_load_ushort v27, v4, s[12:15], 0 offen offset:56
  buffer_load_ushort v28, v4, s[12:15], 0 offen offset:64
  s_mov_b32 s27, 0xbfb8aa3b
  v_mov_b32 v8, 0
  v_mov_b32 v9, 0
  s_waitcnt vmcnt(0)
  v_lshlrev_b32 v20, 16, v20
  v_mul_f32 v30, s27, v20
  v_exp_f32 v30, v30
  v_lshlrev_b32 v21, 16, v21
  v_mul_f32 v31, s27, v21
  v_exp_f32 v31, v31
  v_lshlrev_b32 v22, 16, v22
  v_mul_f32 v32, s27, v22
  v_exp_f32 v32, v32
  v_lshlrev_b32 v23, 16, v23
  v_mul_f32 v33, s27, v23
  v_exp_f32 v33, v33
  v_lshlrev_b32 v24, 16, v24
  v_mul_f32 v34, s27, v24
  v_exp_f32 v34, v34
  v_lshlrev_b32 v25, 16, v25
  v_mul_f32 v35, s27, v25
  v_exp_f32 v35, v35
  v_lshlrev_b32 v26, 16, v26
  v_mul_f32 v36, s27, v26
  v_exp_f32 v36, v36
  v_lshlrev_b32 v27, 16, v27
  v_mul_f32 v37, s27, v27
  v_exp_f32 v37, v37
  v_lshlrev_b32 v28, 16, v28
  v_mul_f32 v38, s27, v28
  v_exp_f32 v38, v38
  v_add_f32 v30, 1.0, v30
  v_rcp_f32 v30, v30
  v_add_f32 v31, 1.0, v31
  v_rcp_f32 v31, v31
  v_add_f32 v32, 1.0, v32
  v_rcp_f32 v32, v32
  v_add_f32 v33, 1.0, v33
  v_rcp_f32 v33, v33
  v_add_f32 v34, 1.0, v34
  v_rcp_f32 v34, v34
  v_add_f32 v35, 1.0, v35
  v_rcp_f32 v35, v35
  v_add_f32 v36, 1.0, v36
  v_rcp_f32 v36, v36
  v_add_f32 v37, 1.0, v37
  v_rcp_f32 v37, v37
  v_add_f32 v38, 1.0, v38
  v_rcp_f32 v38, v38
  s_nop 0
  v_mul_f32 v30, v30, v20
  v_cvt_pk_bf16_f32 v30, v30, v30
  v_lshlrev_b32 v30, 16, v30
  v_lshlrev_b32 v50, 16, v10
  v_and_b32 v51, 0xffff0000, v10
  v_fmac_f32 v8, v30, v50
  v_fmac_f32 v9, v30, v51
  v_mul_f32 v31, v31, v21
  v_cvt_pk_bf16_f32 v31, v31, v31
  v_lshlrev_b32 v31, 16, v31
  v_lshlrev_b32 v50, 16, v11
  v_and_b32 v51, 0xffff0000, v11
  v_fmac_f32 v8, v31, v50
  v_fmac_f32 v9, v31, v51
  v_mul_f32 v32, v32, v22
  v_cvt_pk_bf16_f32 v32, v32, v32
  v_lshlrev_b32 v32, 16, v32
  v_lshlrev_b32 v50, 16, v12
  v_and_b32 v51, 0xffff0000, v12
  v_fmac_f32 v8, v32, v50
  v_fmac_f32 v9, v32, v51
  v_mul_f32 v33, v33, v23
  v_cvt_pk_bf16_f32 v33, v33, v33
  v_lshlrev_b32 v33, 16, v33
  v_lshlrev_b32 v50, 16, v13
  v_and_b32 v51, 0xffff0000, v13
  v_fmac_f32 v8, v33, v50
  v_fmac_f32 v9, v33, v51
  v_mul_f32 v34, v34, v24
  v_cvt_pk_bf16_f32 v34, v34, v34
  v_lshlrev_b32 v34, 16, v34
  v_lshlrev_b32 v50, 16, v14
  v_and_b32 v51, 0xffff0000, v14
  v_fmac_f32 v8, v34, v50
  v_fmac_f32 v9, v34, v51
  v_mul_f32 v35, v35, v25
  v_cvt_pk_bf16_f32 v35, v35, v35
  v_lshlrev_b32 v35, 16, v35
  v_lshlrev_b32 v50, 16, v15
  v_and_b32 v51, 0xffff0000, v15
  v_fmac_f32 v8, v35, v50
  v_fmac_f32 v9, v35, v51
  v_mul_f32 v36, v36, v26
  v_cvt_pk_bf16_f32 v36, v36, v36
  v_lshlrev_b32 v36, 16, v36
  v_lshlrev_b32 v50, 16, v16
  v_and_b32 v51, 0xffff0000, v16
  v_fmac_f32 v8, v36, v50
  v_fmac_f32 v9, v36, v51
  v_mul_f32 v37, v37, v27
  v_cvt_pk_bf16_f32 v37, v37, v37
  v_lshlrev_b32 v37, 16, v37
  v_lshlrev_b32 v50, 16, v17
  v_and_b32 v51, 0xffff0000, v17
  v_fmac_f32 v8, v37, v50
  v_fmac_f32 v9, v37, v51
  v_mul_f32 v38, v38, v28
  v_cvt_pk_bf16_f32 v38, v38, v38
  v_lshlrev_b32 v38, 16, v38
  v_lshlrev_b32 v50, 16, v18
  v_and_b32 v51, 0xffff0000, v18
  v_fmac_f32 v8, v38, v50
  v_fmac_f32 v9, v38, v51
  v_lshlrev_b32 v3, 3, v0
  ds_write_b64 v3, v[8:9]
  s_waitcnt lgkmcnt(0)
  s_barrier
  v_readfirstlane_b32 s28, v1
  s_nop 3
  s_cmp_lg_u32 s28, 0
  s_cbranch_scc1 mod_end_1
  ds_read_b64 v[10:11], v3 offset:0
  ds_read_b64 v[12:13], v3 offset:512
  ds_read_b64 v[14:15], v3 offset:1024
  ds_read_b64 v[16:17], v3 offset:1536
  ds_read_b64 v[18:19], v3 offset:2048
  ds_read_b64 v[20:21], v3 offset:2560
  ds_read_b64 v[22:23], v3 offset:3072
  ds_read_b64 v[24:25], v3 offset:3584
  ds_read_b64 v[26:27], v3 offset:4096
  ds_read_b64 v[28:29], v3 offset:4608
  ds_read_b64 v[30:31], v3 offset:5120
  ds_read_b64 v[32:33], v3 offset:5632
  ds_read_b64 v[34:35], v3 offset:6144
  ds_read_b64 v[36:37], v3 offset:6656
  ds_read_b64 v[38:39], v3 offset:7168
  ds_read_b64 v[40:41], v3 offset:7680
  s_waitcnt lgkmcnt(0)
  v_add_f32 v10, v10, v12
  v_add_f32 v11, v11, v13
  v_add_f32 v10, v10, v14
  v_add_f32 v11, v11, v15
  v_add_f32 v10, v10, v16
  v_add_f32 v11, v11, v17
  v_add_f32 v10, v10, v18
  v_add_f32 v11, v11, v19
  v_add_f32 v10, v10, v20
  v_add_f32 v11, v11, v21
  v_add_f32 v10, v10, v22
  v_add_f32 v11, v11, v23
  v_add_f32 v10, v10, v24
  v_add_f32 v11, v11, v25
  v_add_f32 v10, v10, v26
  v_add_f32 v11, v11, v27
  v_add_f32 v10, v10, v28
  v_add_f32 v11, v11, v29
  v_add_f32 v10, v10, v30
  v_add_f32 v11, v11, v31
  v_add_f32 v10, v10, v32
  v_add_f32 v11, v11, v33
  v_add_f32 v10, v10, v34
  v_add_f32 v11, v11, v35
  v_add_f32 v10, v10, v36
  v_add_f32 v11, v11, v37
  v_add_f32 v10, v10, v38
  v_add_f32 v11, v11, v39
  v_add_f32 v10, v10, v40
  v_add_f32 v11, v11, v41
  ds_write_b64 v3, v[10:11]
  v_lshlrev_b32 v4, 1, v6
  s_waitcnt lgkmcnt(0)
  ds_read_b64 v[12:13], v4 offset:0
  ds_read_b64 v[14:15], v4 offset:128
  ds_read_b64 v[16:17], v4 offset:256
  ds_read_b64 v[18:19], v4 offset:384
  s_waitcnt lgkmcnt(0)
  v_add_f32 v12, v12, v14
  v_add_f32 v13, v13, v15
  v_add_f32 v12, v12, v16
  v_add_f32 v13, v13, v17
  v_add_f32 v12, v12, v18
  v_add_f32 v13, v13, v19
  v_cvt_pk_bf16_f32 v10, v12, v13
  v_add_u32 v6, s25, v6
  v_cmp_gt_u32 vcc, 16, v2
  s_and_saveexec_b64 s[30:31], vcc
  buffer_store_dword v10, v6, s[20:23], 0 offen
mod_end_1:
  s_endpgm
mod_pf_2:
  s_load_dwordx4 s[4:7], s[0:1], 24
  s_load_dwordx4 s[8:11], s[0:1], 48
  s_sub_u32 s3, s2, 108
  s_lshl_b32 s3, s3, 14
  v_lshlrev_b32 v1, 4, v0
  v_add_u32 v1, s3, v1
  s_mov_b32 s28, 2424832
  s_waitcnt lgkmcnt(0)
  s_mov_b32 s12, s4
  s_mov_b32 s13, s5
  s_mov_b32 s14, 0x480000
  s_mov_b32 s15, 0x00020000
  s_mov_b32 s16, s6
  s_mov_b32 s17, s7
  s_mov_b32 s18, 0x480000
  s_mov_b32 s19, 0x00020000
  s_mov_b32 s20, s8
  s_mov_b32 s21, s9
  s_mov_b32 s22, 0x510000
  s_mov_b32 s23, 0x00020000
  s_mov_b32 s24, s10
  s_mov_b32 s25, s11
  s_mov_b32 s26, 0x510000
  s_mov_b32 s27, 0x00020000
  buffer_load_dwordx4 v[4:7], v1, s[12:15], 0 offen
  buffer_load_dwordx4 v[8:11], v1, s[12:15], s28 offen
  s_waitcnt vmcnt(0)
  s_endpgm
.text
.globl ln1_kernel
.p2align 8
.type ln1_kernel,@function
ln1_kernel:
  s_cmp_ge_u32 s2, 256
  s_cbranch_scc1 ln_end_3
  s_load_dwordx2 s[4:5], s[0:1], 0
  s_load_dwordx2 s[6:7], s[0:1], 96
  s_load_dwordx2 s[8:9], s[0:1], 80
  v_lshrrev_b32 v1, 5, v0
  s_lshl_b32 s3, s2, 3
  v_add_u32 v1, s3, v1
  v_and_b32 v2, 31, v0
  v_lshlrev_b32 v2, 2, v2
  s_movk_i32 s10, 1152
  v_mul_lo_u32 v3, v1, s10
  v_add_u32 v3, v3, v2
  v_lshlrev_b32 v4, 1, v3
  s_waitcnt lgkmcnt(0)
  s_mov_b32 s12, s6
  s_mov_b32 s13, s7
  s_mov_b32 s14, 0x1b00
  s_mov_b32 s15, 0x00020000
  s_mov_b32 s16, s4
  s_mov_b32 s17, s5
  s_mov_b32 s18, 0x240000
  s_mov_b32 s19, 0x00020000
  s_add_u32 s20, s6, 0x10000
  s_addc_u32 s21, s7, 0
  s_mov_b32 s22, 0x240000
  s_mov_b32 s23, 0x00020000
  buffer_load_dword v10, v3, s[16:19], 0 offen offset:0
  buffer_load_dword v11, v3, s[16:19], 0 offen offset:128
  buffer_load_dword v12, v3, s[16:19], 0 offen offset:256
  buffer_load_dword v13, v3, s[16:19], 0 offen offset:384
  buffer_load_dword v14, v3, s[16:19], 0 offen offset:512
  buffer_load_dword v15, v3, s[16:19], 0 offen offset:640
  buffer_load_dword v16, v3, s[16:19], 0 offen offset:768
  buffer_load_dword v17, v3, s[16:19], 0 offen offset:896
  buffer_load_dword v18, v3, s[16:19], 0 offen offset:1024
  s_movk_i32 s11, 1152
  buffer_load_dword v20, v2, s[12:15], s11 offen offset:0
  buffer_load_dword v21, v2, s[12:15], s11 offen offset:128
  buffer_load_dword v22, v2, s[12:15], s11 offen offset:256
  buffer_load_dword v23, v2, s[12:15], s11 offen offset:384
  buffer_load_dword v24, v2, s[12:15], s11 offen offset:512
  buffer_load_dword v25, v2, s[12:15], s11 offen offset:640
  buffer_load_dword v26, v2, s[12:15], s11 offen offset:768
  buffer_load_dword v27, v2, s[12:15], s11 offen offset:896
  buffer_load_dword v28, v2, s[12:15], s11 offen offset:1024
  s_movk_i32 s11, 0
  buffer_load_dword v30, v2, s[12:15], s11 offen offset:0
  buffer_load_dword v31, v2, s[12:15], s11 offen offset:128
  buffer_load_dword v32, v2, s[12:15], s11 offen offset:256
  buffer_load_dword v33, v2, s[12:15], s11 offen offset:384
  buffer_load_dword v34, v2, s[12:15], s11 offen offset:512
  buffer_load_dword v35, v2, s[12:15], s11 offen offset:640
  buffer_load_dword v36, v2, s[12:15], s11 offen offset:768
  buffer_load_dword v37, v2, s[12:15], s11 offen offset:896
  buffer_load_dword v38, v2, s[12:15], s11 offen offset:1024
  s_waitcnt vmcnt(0)
  v_lshlrev_b32 v60, 16, v10
  v_and_b32 v61, 0xffff0000, v10
  v_lshlrev_b32 v62, 16, v11
  v_and_b32 v63, 0xffff0000, v11
  v_lshlrev_b32 v64, 16, v12
  v_and_b32 v65, 0xffff0000, v12
  v_lshlrev_b32 v66, 16, v13
  v_and_b32 v67, 0xffff0000, v13
  v_lshlrev_b32 v68, 16, v14
  v_and_b32 v69, 0xffff0000, v14
  v_lshlrev_b32 v70, 16, v15
  v_and_b32 v71, 0xffff0000, v15
  v_lshlrev_b32 v72, 16, v16
  v_and_b32 v73, 0xffff0000, v16
  v_lshlrev_b32 v74, 16, v17
  v_and_b32 v75, 0xffff0000, v17
  v_lshlrev_b32 v76, 16, v18
  v_and_b32 v77, 0xffff0000, v18
  v_add_f32 v5, v60, v61
  v_add_f32 v5, v5, v62
  v_add_f32 v5, v5, v63
  v_add_f32 v5, v5, v64
  v_add_f32 v5, v5, v65
  v_add_f32 v5, v5, v66
  v_add_f32 v5, v5, v67
  v_add_f32 v5, v5, v68
  v_add_f32 v5, v5, v69
  v_add_f32 v5, v5, v70
  v_add_f32 v5, v5, v71
  v_add_f32 v5, v5, v72
  v_add_f32 v5, v5, v73
  v_add_f32 v5, v5, v74
  v_add_f32 v5, v5, v75
  v_add_f32 v5, v5, v76
  v_add_f32 v5, v5, v77
  s_nop 1
  v_add_f32_dpp v5, v5, v5 quad_perm:[1,0,3,2] row_mask:0xf bank_mask:0xf
  s_nop 1
  v_add_f32_dpp v5, v5, v5 quad_perm:[2,3,0,1] row_mask:0xf bank_mask:0xf
  s_nop 1
  v_add_f32_dpp v5, v5, v5 row_half_mirror row_mask:0xf bank_mask:0xf
  s_nop 1
  v_add_f32_dpp v5, v5, v5 row_mirror row_mask:0xf bank_mask:0xf
  ds_swizzle_b32 v6, v5 offset:0x401F
  s_waitcnt lgkmcnt(0)
  v_add_f32 v5, v5, v6
  s_mov_b32 s11, 0x3ae38e39
  v_mul_f32 v5, s11, v5
  v_mov_b32 v8, 0
  v_sub_f32 v6, v60, v5
  v_fmac_f32 v8, v6, v6
  v_sub_f32 v6, v61, v5
  v_fmac_f32 v8, v6, v6
  v_sub_f32 v6, v62, v5
  v_fmac_f32 v8, v6, v6
  v_sub_f32 v6, v63, v5
  v_fmac_f32 v8, v6, v6
  v_sub_f32 v6, v64, v5
  v_fmac_f32 v8, v6, v6
  v_sub_f32 v6, v65, v5
  v_fmac_f32 v8, v6, v6
  v_sub_f32 v6, v66, v5
  v_fmac_f32 v8, v6, v6
  v_sub_f32 v6, v67, v5
  v_fmac_f32 v8, v6, v6
  v_sub_f32 v6, v68, v5
  v_fmac_f32 v8, v6, v6
  v_sub_f32 v6, v69, v5
  v_fmac_f32 v8, v6, v6
  v_sub_f32 v6, v70, v5
  v_fmac_f32 v8, v6, v6
  v_sub_f32 v6, v71, v5
  v_fmac_f32 v8, v6, v6
  v_sub_f32 v6, v72, v5
  v_fmac_f32 v8, v6, v6
  v_sub_f32 v6, v73, v5
  v_fmac_f32 v8, v6, v6
  v_sub_f32 v6, v74, v5
  v_fmac_f32 v8, v6, v6
  v_sub_f32 v6, v75, v5
  v_fmac_f32 v8, v6, v6
  v_sub_f32 v6, v76, v5
  v_fmac_f32 v8, v6, v6
  v_sub_f32 v6, v77, v5
  v_fmac_f32 v8, v6, v6
  s_nop 1
  v_add_f32_dpp v8, v8, v8 quad_perm:[1,0,3,2] row_mask:0xf bank_mask:0xf
  s_nop 1
  v_add_f32_dpp v8, v8, v8 quad_perm:[2,3,0,1] row_mask:0xf bank_mask:0xf
  s_nop 1
  v_add_f32_dpp v8, v8, v8 row_half_mirror row_mask:0xf bank_mask:0xf
  s_nop 1
  v_add_f32_dpp v8, v8, v8 row_mirror row_mask:0xf bank_mask:0xf
  ds_swizzle_b32 v6, v8 offset:0x401F
  s_waitcnt lgkmcnt(0)
  v_add_f32 v8, v8, v6
  v_mul_f32 v8, s11, v8
  v_cvt_pk_bf16_f32 v6, v5, v8
  v_lshlrev_b32 v5, 16, v6
  v_and_b32 v8, 0xffff0000, v6
  v_add_f32 v8, 0x3727c5ac, v8
  v_cvt_pk_bf16_f32 v6, v8, v8
  v_lshlrev_b32 v8, 16, v6
  v_sqrt_f32 v8, v8
  s_nop 0
  v_cvt_pk_bf16_f32 v6, v8, v8
  v_lshlrev_b32 v8, 16, v6
  v_rcp_f32 v8, v8
  s_nop 0
  v_sub_f32 v60, v60, v5
  v_sub_f32 v61, v61, v5
  v_cvt_pk_bf16_f32 v6, v60, v61
  v_lshlrev_b32 v60, 16, v6
  v_and_b32 v61, 0xffff0000, v6
  v_mul_f32 v60, v60, v8
  v_mul_f32 v61, v61, v8
  v_cvt_pk_bf16_f32 v6, v60, v61
  v_lshlrev_b32 v60, 16, v6
  v_and_b32 v61, 0xffff0000, v6
  v_lshlrev_b32 v6, 16, v20
  v_and_b32 v7, 0xffff0000, v20
  v_add_f32 v6, 1.0, v6
  v_add_f32 v7, 1.0, v7
  v_cvt_pk_bf16_f32 v9, v6, v7
  v_lshlrev_b32 v6, 16, v9
  v_and_b32 v7, 0xffff0000, v9
  v_mul_f32 v60, v60, v6
  v_mul_f32 v61, v61, v7
  v_cvt_pk_bf16_f32 v9, v60, v61
  v_lshlrev_b32 v60, 16, v9
  v_and_b32 v61, 0xffff0000, v9
  v_lshlrev_b32 v6, 16, v30
  v_and_b32 v7, 0xffff0000, v30
  v_add_f32 v60, v60, v6
  v_add_f32 v61, v61, v7
  v_cvt_pk_bf16_f32 v50, v60, v61
  buffer_store_dword v50, v3, s[20:23], 0 offen offset:0
  v_sub_f32 v62, v62, v5
  v_sub_f32 v63, v63, v5
  v_cvt_pk_bf16_f32 v6, v62, v63
  v_lshlrev_b32 v62, 16, v6
  v_and_b32 v63, 0xffff0000, v6
  v_mul_f32 v62, v62, v8
  v_mul_f32 v63, v63, v8
  v_cvt_pk_bf16_f32 v6, v62, v63
  v_lshlrev_b32 v62, 16, v6
  v_and_b32 v63, 0xffff0000, v6
  v_lshlrev_b32 v6, 16, v21
  v_and_b32 v7, 0xffff0000, v21
  v_add_f32 v6, 1.0, v6
  v_add_f32 v7, 1.0, v7
  v_cvt_pk_bf16_f32 v9, v6, v7
  v_lshlrev_b32 v6, 16, v9
  v_and_b32 v7, 0xffff0000, v9
  v_mul_f32 v62, v62, v6
  v_mul_f32 v63, v63, v7
  v_cvt_pk_bf16_f32 v9, v62, v63
  v_lshlrev_b32 v62, 16, v9
  v_and_b32 v63, 0xffff0000, v9
  v_lshlrev_b32 v6, 16, v31
  v_and_b32 v7, 0xffff0000, v31
  v_add_f32 v62, v62, v6
  v_add_f32 v63, v63, v7
  v_cvt_pk_bf16_f32 v51, v62, v63
  buffer_store_dword v51, v3, s[20:23], 0 offen offset:128
  v_sub_f32 v64, v64, v5
  v_sub_f32 v65, v65, v5
  v_cvt_pk_bf16_f32 v6, v64, v65
  v_lshlrev_b32 v64, 16, v6
  v_and_b32 v65, 0xffff0000, v6
  v_mul_f32 v64, v64, v8
  v_mul_f32 v65, v65, v8
  v_cvt_pk_bf16_f32 v6, v64, v65
  v_lshlrev_b32 v64, 16, v6
  v_and_b32 v65, 0xffff0000, v6
  v_lshlrev_b32 v6, 16, v22
  v_and_b32 v7, 0xffff0000, v22
  v_add_f32 v6, 1.0, v6
  v_add_f32 v7, 1.0, v7
  v_cvt_pk_bf16_f32 v9, v6, v7
  v_lshlrev_b32 v6, 16, v9
  v_and_b32 v7, 0xffff0000, v9
  v_mul_f32 v64, v64, v6
  v_mul_f32 v65, v65, v7
  v_cvt_pk_bf16_f32 v9, v64, v65
  v_lshlrev_b32 v64, 16, v9
  v_and_b32 v65, 0xffff0000, v9
  v_lshlrev_b32 v6, 16, v32
  v_and_b32 v7, 0xffff0000, v32
  v_add_f32 v64, v64, v6
  v_add_f32 v65, v65, v7
  v_cvt_pk_bf16_f32 v52, v64, v65
  buffer_store_dword v52, v3, s[20:23], 0 offen offset:256
  v_sub_f32 v66, v66, v5
  v_sub_f32 v67, v67, v5
  v_cvt_pk_bf16_f32 v6, v66, v67
  v_lshlrev_b32 v66, 16, v6
  v_and_b32 v67, 0xffff0000, v6
  v_mul_f32 v66, v66, v8
  v_mul_f32 v67, v67, v8
  v_cvt_pk_bf16_f32 v6, v66, v67
  v_lshlrev_b32 v66, 16, v6
  v_and_b32 v67, 0xffff0000, v6
  v_lshlrev_b32 v6, 16, v23
  v_and_b32 v7, 0xffff0000, v23
  v_add_f32 v6, 1.0, v6
  v_add_f32 v7, 1.0, v7
  v_cvt_pk_bf16_f32 v9, v6, v7
  v_lshlrev_b32 v6, 16, v9
  v_and_b32 v7, 0xffff0000, v9
  v_mul_f32 v66, v66, v6
  v_mul_f32 v67, v67, v7
  v_cvt_pk_bf16_f32 v9, v66, v67
  v_lshlrev_b32 v66, 16, v9
  v_and_b32 v67, 0xffff0000, v9
  v_lshlrev_b32 v6, 16, v33
  v_and_b32 v7, 0xffff0000, v33
  v_add_f32 v66, v66, v6
  v_add_f32 v67, v67, v7
  v_cvt_pk_bf16_f32 v53, v66, v67
  buffer_store_dword v53, v3, s[20:23], 0 offen offset:384
  v_sub_f32 v68, v68, v5
  v_sub_f32 v69, v69, v5
  v_cvt_pk_bf16_f32 v6, v68, v69
  v_lshlrev_b32 v68, 16, v6
  v_and_b32 v69, 0xffff0000, v6
  v_mul_f32 v68, v68, v8
  v_mul_f32 v69, v69, v8
  v_cvt_pk_bf16_f32 v6, v68, v69
  v_lshlrev_b32 v68, 16, v6
  v_and_b32 v69, 0xffff0000, v6
  v_lshlrev_b32 v6, 16, v24
  v_and_b32 v7, 0xffff0000, v24
  v_add_f32 v6, 1.0, v6
  v_add_f32 v7, 1.0, v7
  v_cvt_pk_bf16_f32 v9, v6, v7
  v_lshlrev_b32 v6, 16, v9
  v_and_b32 v7, 0xffff0000, v9
  v_mul_f32 v68, v68, v6
  v_mul_f32 v69, v69, v7
  v_cvt_pk_bf16_f32 v9, v68, v69
  v_lshlrev_b32 v68, 16, v9
  v_and_b32 v69, 0xffff0000, v9
  v_lshlrev_b32 v6, 16, v34
  v_and_b32 v7, 0xffff0000, v34
  v_add_f32 v68, v68, v6
  v_add_f32 v69, v69, v7
  v_cvt_pk_bf16_f32 v54, v68, v69
  buffer_store_dword v54, v3, s[20:23], 0 offen offset:512
  v_sub_f32 v70, v70, v5
  v_sub_f32 v71, v71, v5
  v_cvt_pk_bf16_f32 v6, v70, v71
  v_lshlrev_b32 v70, 16, v6
  v_and_b32 v71, 0xffff0000, v6
  v_mul_f32 v70, v70, v8
  v_mul_f32 v71, v71, v8
  v_cvt_pk_bf16_f32 v6, v70, v71
  v_lshlrev_b32 v70, 16, v6
  v_and_b32 v71, 0xffff0000, v6
  v_lshlrev_b32 v6, 16, v25
  v_and_b32 v7, 0xffff0000, v25
  v_add_f32 v6, 1.0, v6
  v_add_f32 v7, 1.0, v7
  v_cvt_pk_bf16_f32 v9, v6, v7
  v_lshlrev_b32 v6, 16, v9
  v_and_b32 v7, 0xffff0000, v9
  v_mul_f32 v70, v70, v6
  v_mul_f32 v71, v71, v7
  v_cvt_pk_bf16_f32 v9, v70, v71
  v_lshlrev_b32 v70, 16, v9
  v_and_b32 v71, 0xffff0000, v9
  v_lshlrev_b32 v6, 16, v35
  v_and_b32 v7, 0xffff0000, v35
  v_add_f32 v70, v70, v6
  v_add_f32 v71, v71, v7
  v_cvt_pk_bf16_f32 v55, v70, v71
  buffer_store_dword v55, v3, s[20:23], 0 offen offset:640
  v_sub_f32 v72, v72, v5
  v_sub_f32 v73, v73, v5
  v_cvt_pk_bf16_f32 v6, v72, v73
  v_lshlrev_b32 v72, 16, v6
  v_and_b32 v73, 0xffff0000, v6
  v_mul_f32 v72, v72, v8
  v_mul_f32 v73, v73, v8
  v_cvt_pk_bf16_f32 v6, v72, v73
  v_lshlrev_b32 v72, 16, v6
  v_and_b32 v73, 0xffff0000, v6
  v_lshlrev_b32 v6, 16, v26
  v_and_b32 v7, 0xffff0000, v26
  v_add_f32 v6, 1.0, v6
  v_add_f32 v7, 1.0, v7
  v_cvt_pk_bf16_f32 v9, v6, v7
  v_lshlrev_b32 v6, 16, v9
  v_and_b32 v7, 0xffff0000, v9
  v_mul_f32 v72, v72, v6
  v_mul_f32 v73, v73, v7
  v_cvt_pk_bf16_f32 v9, v72, v73
  v_lshlrev_b32 v72, 16, v9
  v_and_b32 v73, 0xffff0000, v9
  v_lshlrev_b32 v6, 16, v36
  v_and_b32 v7, 0xffff0000, v36
  v_add_f32 v72, v72, v6
  v_add_f32 v73, v73, v7
  v_cvt_pk_bf16_f32 v56, v72, v73
  buffer_store_dword v56, v3, s[20:23], 0 offen offset:768
  v_sub_f32 v74, v74, v5
  v_sub_f32 v75, v75, v5
  v_cvt_pk_bf16_f32 v6, v74, v75
  v_lshlrev_b32 v74, 16, v6
  v_and_b32 v75, 0xffff0000, v6
  v_mul_f32 v74, v74, v8
  v_mul_f32 v75, v75, v8
  v_cvt_pk_bf16_f32 v6, v74, v75
  v_lshlrev_b32 v74, 16, v6
  v_and_b32 v75, 0xffff0000, v6
  v_lshlrev_b32 v6, 16, v27
  v_and_b32 v7, 0xffff0000, v27
  v_add_f32 v6, 1.0, v6
  v_add_f32 v7, 1.0, v7
  v_cvt_pk_bf16_f32 v9, v6, v7
  v_lshlrev_b32 v6, 16, v9
  v_and_b32 v7, 0xffff0000, v9
  v_mul_f32 v74, v74, v6
  v_mul_f32 v75, v75, v7
  v_cvt_pk_bf16_f32 v9, v74, v75
  v_lshlrev_b32 v74, 16, v9
  v_and_b32 v75, 0xffff0000, v9
  v_lshlrev_b32 v6, 16, v37
  v_and_b32 v7, 0xffff0000, v37
  v_add_f32 v74, v74, v6
  v_add_f32 v75, v75, v7
  v_cvt_pk_bf16_f32 v57, v74, v75
  buffer_store_dword v57, v3, s[20:23], 0 offen offset:896
  v_sub_f32 v76, v76, v5
  v_sub_f32 v77, v77, v5
  v_cvt_pk_bf16_f32 v6, v76, v77
  v_lshlrev_b32 v76, 16, v6
  v_and_b32 v77, 0xffff0000, v6
  v_mul_f32 v76, v76, v8
  v_mul_f32 v77, v77, v8
  v_cvt_pk_bf16_f32 v6, v76, v77
  v_lshlrev_b32 v76, 16, v6
  v_and_b32 v77, 0xffff0000, v6
  v_lshlrev_b32 v6, 16, v28
  v_and_b32 v7, 0xffff0000, v28
  v_add_f32 v6, 1.0, v6
  v_add_f32 v7, 1.0, v7
  v_cvt_pk_bf16_f32 v9, v6, v7
  v_lshlrev_b32 v6, 16, v9
  v_and_b32 v7, 0xffff0000, v9
  v_mul_f32 v76, v76, v6
  v_mul_f32 v77, v77, v7
  v_cvt_pk_bf16_f32 v9, v76, v77
  v_lshlrev_b32 v76, 16, v9
  v_and_b32 v77, 0xffff0000, v9
  v_lshlrev_b32 v6, 16, v38
  v_and_b32 v7, 0xffff0000, v38
  v_add_f32 v76, v76, v6
  v_add_f32 v77, v77, v7
  v_cvt_pk_bf16_f32 v58, v76, v77
  buffer_store_dword v58, v3, s[20:23], 0 offen offset:1024
ln_end_3:
  s_endpgm
.text
.globl attn_kernel
.p2align 8
.type attn_kernel,@function
attn_kernel:
  s_cmp_ge_u32 s2, 256
  s_cbranch_scc1 at_end_4
  s_load_dwordx2 s[4:5], s[0:1], 8
  s_load_dwordx2 s[6:7], s[0:1], 16
  s_load_dwordx2 s[8:9], s[0:1], 96
  s_load_dwordx2 s[10:11], s[0:1], 24
  s_load_dwordx2 s[46:47], s[0:1], 32
  s_load_dwordx4 s[96:99], s[0:1], 48
  v_and_b32 v1, 63, v0
  v_lshrrev_b32 v2, 6, v0
  s_and_b32 s35, s2, 7
  s_lshr_b32 s36, s2, 3
  s_lshl_b32 s35, s35, 2
  s_lshr_b32 s37, s36, 3
  s_add_u32 s35, s35, s37
  s_and_b32 s36, s36, 7
  v_readfirstlane_b32 s37, v2
  s_lshl_b32 s38, s35, 19
  s_waitcnt lgkmcnt(0)
  s_add_u32 s12, s4, s38
  s_addc_u32 s13, s5, 0
  s_mov_b32 s14, 0x80000
  s_mov_b32 s15, 0x00020000
  s_add_u32 s16, s6, s38
  s_addc_u32 s17, s7, 0
  s_mov_b32 s18, 0x80000
  s_mov_b32 s19, 0x00020000
  s_add_u32 s20, s8, 0x10000
  s_addc_u32 s21, s9, 0
  s_mov_b32 s22, 0x240000
  s_mov_b32 s23, 0x00020000
  s_mov_b32 s88, s10
  s_mov_b32 s89, s11
  s_mov_b32 s90, 0x480000
  s_mov_b32 s91, 0x00020000
  s_mov_b32 s76, s46
  s_mov_b32 s77, s47
  s_mov_b32 s78, 0x480000
  s_mov_b32 s79, 0x00020000
  s_mov_b32 s80, s96
  s_mov_b32 s81, s97
  s_mov_b32 s82, 0x510000
  s_mov_b32 s83, 0x00020000
  s_mov_b32 s84, s98
  s_mov_b32 s85, s99
  s_mov_b32 s86, 0x510000
  s_mov_b32 s87, 0x00020000
  s_lshl_b32 s95, s2, 2
  s_add_u32 s95, s95, s37
  v_lshlrev_b32 v3, 4, v1
  s_mul_i32 s96, s95, 5120
  v_add_u32 v91, s96, v3
  s_mul_i32 s96, s95, 6144
  v_add_u32 v92, s96, v3
  s_add_u32 s24, s8, 0x1800000
  s_addc_u32 s25, s9, 0
  s_mov_b32 s26, 0x1000000
  s_mov_b32 s27, 0x00020000
  s_mov_b32 s28, 0x3e0293ee
  s_mov_b32 s29, 0x41000000
  s_mov_b32 s33, 0
  s_lshl_b32 s34, s37, 12
  v_lshrrev_b32 v3, 4, v1
  v_and_b32 v4, 15, v1
  s_lshl_b32 s39, s37, 4
  v_add_u32 v5, s39, v3
  v_lshlrev_b32 v5, 8, v5
  v_add_u32 v6, 0, v3
  v_xor_b32 v6, v6, v4
  v_lshlrev_b32 v6, 4, v6
  v_add_u32 v20, v5, v6
  v_add_u32 v6, 4, v3
  v_xor_b32 v6, v6, v4
  v_lshlrev_b32 v6, 4, v6
  v_add_u32 v21, v5, v6
  v_add_u32 v6, 8, v3
  v_xor_b32 v6, v6, v4
  v_lshlrev_b32 v6, 4, v6
  v_add_u32 v22, v5, v6
  v_add_u32 v6, 12, v3
  v_xor_b32 v6, v6, v4
  v_lshlrev_b32 v6, 4, v6
  v_add_u32 v23, v5, v6
  v_lshlrev_b32 v6, 2, v3
  v_xor_b32 v6, v6, v4
  v_lshlrev_b32 v6, 4, v6
  v_add_u32 v24, v5, v6
  s_mov_b32 s30, 0
  s_mov_b32 s31, 0
  s_lshl_b32 s39, s36, 8
  s_lshl_b32 s40, s37, 6
  s_add_u32 s39, s39, s40
  s_lshl_b32 s40, s35, 8
  v_lshrrev_b32 v5, 3, v1
  v_add_u32 v5, s39, v5
  s_movk_i32 s41, 1152
  v_mul_lo_u32 v5, v5, s41
  v_and_b32 v7, 7, v1
  v_add_u32 v6, 0, v3
  v_xor_b32 v6, v6, v7
  v_lshlrev_b32 v6, 4, v6
  v_add_u32 v88, v5, v6
  v_add_u32 v6, 4, v3
  v_xor_b32 v6, v6, v7
  v_lshlrev_b32 v6, 4, v6
  v_add_u32 v89, v5, v6
  s_lshl_b32 s41, s37, 4
  v_add_u32 v5, s41, v3
  v_lshlrev_b32 v5, 13, v5
  v_lshlrev_b32 v6, 2, v3
  v_xor_b32 v6, v6, v4
  v_lshlrev_b32 v6, 4, v6
  v_add3_u32 v90, v5, v6, s40
  s_lshl_b32 s92, s37, 13
  s_lshl_b32 s93, s37, 12
  s_add_u32 s93, s93, 32768
  s_add_u32 m0, s92, 0
  s_mov_b32 s94, 0
  buffer_load_dwordx4 v88, s[20:23], s94 offen lds
  s_add_u32 m0, s92, 1024
  s_mov_b32 s94, 9216
  buffer_load_dwordx4 v89, s[20:23], s94 offen lds
  s_add_u32 m0, s92, 2048
  s_mov_b32 s94, 18432
  buffer_load_dwordx4 v88, s[20:23], s94 offen lds
  s_add_u32 m0, s92, 3072
  s_mov_b32 s94, 27648
  buffer_load_dwordx4 v89, s[20:23], s94 offen lds
  s_add_u32 m0, s92, 4096
  s_mov_b32 s94, 36864
  buffer_load_dwordx4 v88, s[20:23], s94 offen lds
  s_add_u32 m0, s92, 5120
  s_mov_b32 s94, 46080
  buffer_load_dwordx4 v89, s[20:23], s94 offen lds
  s_add_u32 m0, s92, 6144
  s_mov_b32 s94, 55296
  buffer_load_dwordx4 v88, s[20:23], s94 offen lds
  s_add_u32 m0, s92, 7168
  s_mov_b32 s94, 64512
  buffer_load_dwordx4 v89, s[20:23], s94 offen lds
  s_add_u32 m0, s93, 0
  s_mov_b32 s94, 0
  buffer_load_dwordx4 v90, s[88:91], s94 offen lds
  s_add_u32 m0, s93, 1024
  s_mov_b32 s94, 32768
  buffer_load_dwordx4 v90, s[88:91], s94 offen lds
  s_add_u32 m0, s93, 2048
  s_mov_b32 s94, 65536
  buffer_load_dwordx4 v90, s[88:91], s94 offen lds
  s_add_u32 m0, s93, 3072
  s_mov_b32 s94, 98304
  buffer_load_dwordx4 v90, s[88:91], s94 offen lds
  s_add_u32 m0, s92, 49152
  s_mov_b32 s94, 128
  buffer_load_dwordx4 v88, s[20:23], s94 offen lds
  s_add_u32 m0, s92, 50176
  s_mov_b32 s94, 9344
  buffer_load_dwordx4 v89, s[20:23], s94 offen lds
  s_add_u32 m0, s92, 51200
  s_mov_b32 s94, 18560
  buffer_load_dwordx4 v88, s[20:23], s94 offen lds
  s_add_u32 m0, s92, 52224
  s_mov_b32 s94, 27776
  buffer_load_dwordx4 v89, s[20:23], s94 offen lds
  s_add_u32 m0, s92, 53248
  s_mov_b32 s94, 36992
  buffer_load_dwordx4 v88, s[20:23], s94 offen lds
  s_add_u32 m0, s92, 54272
  s_mov_b32 s94, 46208
  buffer_load_dwordx4 v89, s[20:23], s94 offen lds
  s_add_u32 m0, s92, 55296
  s_mov_b32 s94, 55424
  buffer_load_dwordx4 v88, s[20:23], s94 offen lds
  s_add_u32 m0, s92, 56320
  s_mov_b32 s94, 64640
  buffer_load_dwordx4 v89, s[20:23], s94 offen lds
  s_add_u32 m0, s93, 49152
  s_mov_b32 s94, 524288
  buffer_load_dwordx4 v90, s[88:91], s94 offen lds
  s_add_u32 m0, s93, 50176
  s_mov_b32 s94, 557056
  buffer_load_dwordx4 v90, s[88:91], s94 offen lds
  s_add_u32 m0, s93, 51200
  s_mov_b32 s94, 589824
  buffer_load_dwordx4 v90, s[88:91], s94 offen lds
  s_add_u32 m0, s93, 52224
  s_mov_b32 s94, 622592
  buffer_load_dwordx4 v90, s[88:91], s94 offen lds
  s_add_u32 m0, s92, 98304
  s_mov_b32 s94, 256
  buffer_load_dwordx4 v88, s[20:23], s94 offen lds
  s_add_u32 m0, s92, 99328
  s_mov_b32 s94, 9472
  buffer_load_dwordx4 v89, s[20:23], s94 offen lds
  s_add_u32 m0, s92, 100352
  s_mov_b32 s94, 18688
  buffer_load_dwordx4 v88, s[20:23], s94 offen lds
  v_and_b32 v3, 31, v1
  v_lshrrev_b32 v4, 5, v1
  v_add_u32 v5, s39, v3
  v_lshlrev_b32 v5, 13, v5
  v_lshlrev_b32 v6, 4, v4
  v_add3_u32 v63, v5, v6, s40
  v_and_b32 v5, 15, v1
  v_lshlrev_b32 v6, 8, v3
  v_mov_b32 v42, v4
  v_xor_b32 v43, v42, v5
  v_lshlrev_b32 v43, 4, v43
  v_add_u32 v44, v6, v43
  v_add_u32 v8, 2, v4
  v_xor_b32 v43, v8, v5
  v_lshlrev_b32 v43, 4, v43
  v_add_u32 v45, v6, v43
  v_add_u32 v8, 4, v4
  v_xor_b32 v43, v8, v5
  v_lshlrev_b32 v43, 4, v43
  v_add_u32 v46, v6, v43
  v_add_u32 v8, 6, v4
  v_xor_b32 v43, v8, v5
  v_lshlrev_b32 v43, 4, v43
  v_add_u32 v47, v6, v43
  v_add_u32 v8, 8, v4
  v_xor_b32 v43, v8, v5
  v_lshlrev_b32 v43, 4, v43
  v_add_u32 v48, v6, v43
  v_add_u32 v8, 10, v4
  v_xor_b32 v43, v8, v5
  v_lshlrev_b32 v43, 4, v43
  v_add_u32 v49, v6, v43
  v_add_u32 v8, 12, v4
  v_xor_b32 v43, v8, v5
  v_lshlrev_b32 v43, 4, v43
  v_add_u32 v50, v6, v43
  v_add_u32 v8, 14, v4
  v_xor_b32 v43, v8, v5
  v_lshlrev_b32 v43, 4, v43
  v_add_u32 v51, v6, v43
  v_mov_b32 v8, v44
  v_mov_b32 v9, v45
  v_mov_b32 v10, v46
  v_mov_b32 v11, v47
  v_mov_b32 v12, v48
  v_mov_b32 v13, v49
  v_mov_b32 v14, v50
  v_mov_b32 v15, v51
  v_lshrrev_b32 v6, 2, v5
  v_and_b32 v3, 3, v5
  v_lshlrev_b32 v3, 3, v3
  v_lshrrev_b32 v5, 4, v1
  v_and_b32 v5, 1, v5
  v_lshlrev_b32 v5, 5, v5
  v_add_u32 v3, v3, v5
  v_lshlrev_b32 v5, 2, v4
  v_add_u32 v5, v5, v6
  v_lshlrev_b32 v5, 8, v5
  v_add_u32 v3, v3, v5
  v_add_u32 v3, 0x10000, v3
  v_xor_b32 v5, 0, v6
  v_lshlrev_b32 v5, 6, v5
  v_add_u32 v16, v3, v5
  v_xor_b32 v5, 1, v6
  v_lshlrev_b32 v5, 6, v5
  v_add_u32 v17, v3, v5
  v_xor_b32 v5, 2, v6
  v_lshlrev_b32 v5, 6, v5
  v_add_u32 v18, v3, v5
  v_xor_b32 v5, 3, v6
  v_lshlrev_b32 v5, 6, v5
  v_add_u32 v19, v3, v5
  v_mov_b32 v30, 0
  v_mov_b32 v31, 0
  v_and_b32 v3, 31, v1
  v_lshrrev_b32 v5, 1, v3
  v_and_b32 v5, 7, v5
  v_lshlrev_b32 v6, 7, v3
  v_add_u32 v6, s92, v6
  v_add_u32 v7, 0, v4
  v_xor_b32 v7, v7, v5
  v_lshlrev_b32 v7, 4, v7
  v_add_u32 v64, v6, v7
  v_add_u32 v7, 2, v4
  v_xor_b32 v7, v7, v5
  v_lshlrev_b32 v7, 4, v7
  v_add_u32 v65, v6, v7
  v_add_u32 v7, 4, v4
  v_xor_b32 v7, v7, v5
  v_lshlrev_b32 v7, 4, v7
  v_add_u32 v66, v6, v7
  v_add_u32 v7, 6, v4
  v_xor_b32 v7, v7, v5
  v_lshlrev_b32 v7, 4, v7
  v_add_u32 v67, v6, v7
  v_and_b32 v5, 15, v1
  v_lshrrev_b32 v6, 2, v5
  v_and_b32 v3, 3, v5
  v_lshlrev_b32 v3, 3, v3
  v_lshrrev_b32 v5, 4, v1
  v_and_b32 v5, 1, v5
  v_lshlrev_b32 v5, 5, v5
  v_add_u32 v3, v3, v5
  v_lshlrev_b32 v5, 3, v4
  v_add_u32 v5, v5, v6
  v_lshlrev_b32 v5, 8, v5
  v_add_u32 v3, v3, v5
  v_add_u32 v3, 0x8000, v3
  v_xor_b32 v5, 0, v6
  v_lshlrev_b32 v5, 6, v5
  v_add_u32 v68, v3, v5
  v_xor_b32 v5, 1, v6
  v_lshlrev_b32 v5, 6, v5
  v_add_u32 v69, v3, v5
  v_xor_b32 v5, 2, v6
  v_lshlrev_b32 v5, 6, v5
  v_add_u32 v70, v3, v5
  v_xor_b32 v5, 3, v6
  v_lshlrev_b32 v5, 6, v5
  v_add_u32 v71, v3, v5
  v_add_u32 v72, 49152, v64
  v_add_u32 v73, 49152, v65
  v_add_u32 v74, 49152, v66
  v_add_u32 v75, 49152, v67
  v_add_u32 v76, 49152, v68
  v_add_u32 v77, 49152, v69
  v_add_u32 v78, 49152, v70
  v_add_u32 v79, 49152, v71
  v_add_u32 v80, 98304, v64
  v_add_u32 v81, 98304, v65
  v_add_u32 v82, 98304, v66
  v_add_u32 v83, 98304, v67
  v_add_u32 v84, 98304, v68
  v_add_u32 v85, 98304, v69
  v_add_u32 v86, 98304, v70
  v_add_u32 v87, 98304, v71
  s_waitcnt vmcnt(15)
  s_barrier
  ds_read_b64_tr_b16 a[192:193], v68 offset:0
  ds_read_b64_tr_b16 a[194:195], v68 offset:1024
  ds_read_b64_tr_b16 a[196:197], v69 offset:0
  ds_read_b64_tr_b16 a[198:199], v69 offset:1024
  ds_read_b64_tr_b16 a[200:201], v70 offset:0
  ds_read_b64_tr_b16 a[202:203], v70 offset:1024
  ds_read_b64_tr_b16 a[204:205], v71 offset:0
  ds_read_b64_tr_b16 a[206:207], v71 offset:1024
  ds_read_b128 a[208:211], v64 offset:0
  ds_read_b128 a[212:215], v64 offset:4096
  s_waitcnt lgkmcnt(0)
  v_mfma_f32_32x32x16_bf16 a[0:15], a[192:195], a[208:211], 0
  ds_read_b64_tr_b16 a[216:217], v68 offset:4096
  ds_read_b64_tr_b16 a[218:219], v68 offset:5120
  ds_read_b64_tr_b16 a[220:221], v69 offset:4096
  v_mfma_f32_32x32x16_bf16 a[64:79], a[192:195], a[212:215], 0
  ds_read_b64_tr_b16 a[222:223], v69 offset:5120
  ds_read_b64_tr_b16 a[224:225], v70 offset:4096
  ds_read_b64_tr_b16 a[226:227], v70 offset:5120
  v_mfma_f32_32x32x16_bf16 a[16:31], a[196:199], a[208:211], 0
  ds_read_b64_tr_b16 a[228:229], v71 offset:4096
  ds_read_b64_tr_b16 a[230:231], v71 offset:5120
  ds_read_b128 a[232:235], v65 offset:0
  s_add_u32 m0, s92, 101376
  s_mov_b32 s94, 27904
  buffer_load_dwordx4 v89, s[20:23], s94 offen lds
  v_mfma_f32_32x32x16_bf16 a[80:95], a[196:199], a[212:215], 0
  ds_read_b128 a[236:239], v65 offset:4096
  v_mfma_f32_32x32x16_bf16 a[32:47], a[200:203], a[208:211], 0
  s_add_u32 m0, s92, 102400
  s_mov_b32 s94, 37120
  buffer_load_dwordx4 v88, s[20:23], s94 offen lds
  v_mfma_f32_32x32x16_bf16 a[96:111], a[200:203], a[212:215], 0
  v_mfma_f32_32x32x16_bf16 a[48:63], a[204:207], a[208:211], 0
  s_add_u32 m0, s92, 103424
  s_mov_b32 s94, 46336
  buffer_load_dwordx4 v89, s[20:23], s94 offen lds
  v_mfma_f32_32x32x16_bf16 a[112:127], a[204:207], a[212:215], 0
  s_waitcnt lgkmcnt(0)
  v_mfma_f32_32x32x16_bf16 a[0:15], a[216:219], a[232:235], a[0:15]
  ds_read_b64_tr_b16 a[192:193], v68 offset:8192
  ds_read_b64_tr_b16 a[194:195], v68 offset:9216
  ds_read_b64_tr_b16 a[196:197], v69 offset:8192
  v_mfma_f32_32x32x16_bf16 a[64:79], a[216:219], a[236:239], a[64:79]
  ds_read_b64_tr_b16 a[198:199], v69 offset:9216
  ds_read_b64_tr_b16 a[200:201], v70 offset:8192
  ds_read_b64_tr_b16 a[202:203], v70 offset:9216
  v_mfma_f32_32x32x16_bf16 a[16:31], a[220:223], a[232:235], a[16:31]
  ds_read_b64_tr_b16 a[204:205], v71 offset:8192
  ds_read_b64_tr_b16 a[206:207], v71 offset:9216
  ds_read_b128 a[208:211], v66 offset:0
  s_add_u32 m0, s92, 104448
  s_mov_b32 s94, 55552
  buffer_load_dwordx4 v88, s[20:23], s94 offen lds
  v_mfma_f32_32x32x16_bf16 a[80:95], a[220:223], a[236:239], a[80:95]
  ds_read_b128 a[212:215], v66 offset:4096
  v_mfma_f32_32x32x16_bf16 a[32:47], a[224:227], a[232:235], a[32:47]
  s_add_u32 m0, s92, 105472
  s_mov_b32 s94, 64768
  buffer_load_dwordx4 v89, s[20:23], s94 offen lds
  v_mfma_f32_32x32x16_bf16 a[96:111], a[224:227], a[236:239], a[96:111]
  v_mfma_f32_32x32x16_bf16 a[48:63], a[228:231], a[232:235], a[48:63]
  s_add_u32 m0, s93, 98304
  s_mov_b32 s94, 1048576
  buffer_load_dwordx4 v90, s[88:91], s94 offen lds
  v_mfma_f32_32x32x16_bf16 a[112:127], a[228:231], a[236:239], a[112:127]
  s_waitcnt lgkmcnt(0)
  v_mfma_f32_32x32x16_bf16 a[0:15], a[192:195], a[208:211], a[0:15]
  ds_read_b64_tr_b16 a[216:217], v68 offset:12288
  ds_read_b64_tr_b16 a[218:219], v68 offset:13312
  ds_read_b64_tr_b16 a[220:221], v69 offset:12288
  v_mfma_f32_32x32x16_bf16 a[64:79], a[192:195], a[212:215], a[64:79]
  ds_read_b64_tr_b16 a[222:223], v69 offset:13312
  ds_read_b64_tr_b16 a[224:225], v70 offset:12288
  ds_read_b64_tr_b16 a[226:227], v70 offset:13312
  v_mfma_f32_32x32x16_bf16 a[16:31], a[196:199], a[208:211], a[16:31]
  ds_read_b64_tr_b16 a[228:229], v71 offset:12288
  ds_read_b64_tr_b16 a[230:231], v71 offset:13312
  ds_read_b128 a[232:235], v67 offset:0
  s_add_u32 m0, s93, 99328
  s_mov_b32 s94, 1081344
  buffer_load_dwordx4 v90, s[88:91], s94 offen lds
  v_mfma_f32_32x32x16_bf16 a[80:95], a[196:199], a[212:215], a[80:95]
  ds_read_b128 a[236:239], v67 offset:4096
  v_mfma_f32_32x32x16_bf16 a[32:47], a[200:203], a[208:211], a[32:47]
  s_add_u32 m0, s93, 100352
  s_mov_b32 s94, 1114112
  buffer_load_dwordx4 v90, s[88:91], s94 offen lds
  v_mfma_f32_32x32x16_bf16 a[96:111], a[200:203], a[212:215], a[96:111]
  v_mfma_f32_32x32x16_bf16 a[48:63], a[204:207], a[208:211], a[48:63]
  s_add_u32 m0, s93, 101376
  s_mov_b32 s94, 1146880
  buffer_load_dwordx4 v90, s[88:91], s94 offen lds
  v_mfma_f32_32x32x16_bf16 a[112:127], a[204:207], a[212:215], a[112:127]
  s_waitcnt vmcnt(12) lgkmcnt(0)
  s_barrier
  v_mfma_f32_32x32x16_bf16 a[0:15], a[216:219], a[232:235], a[0:15]
  ds_read_b64_tr_b16 a[192:193], v76 offset:0
  ds_read_b64_tr_b16 a[194:195], v76 offset:1024
  ds_read_b64_tr_b16 a[196:197], v77 offset:0
  v_mfma_f32_32x32x16_bf16 a[64:79], a[216:219], a[236:239], a[64:79]
  ds_read_b64_tr_b16 a[198:199], v77 offset:1024
  ds_read_b64_tr_b16 a[200:201], v78 offset:0
  ds_read_b64_tr_b16 a[202:203], v78 offset:1024
  v_mfma_f32_32x32x16_bf16 a[16:31], a[220:223], a[232:235], a[16:31]
  ds_read_b64_tr_b16 a[204:205], v79 offset:0
  ds_read_b64_tr_b16 a[206:207], v79 offset:1024
  ds_read_b128 a[208:211], v72 offset:0
  s_add_u32 m0, s92, 0
  s_mov_b32 s94, 384
  buffer_load_dwordx4 v88, s[20:23], s94 offen lds
  v_mfma_f32_32x32x16_bf16 a[80:95], a[220:223], a[236:239], a[80:95]
  ds_read_b128 a[212:215], v72 offset:4096
  v_mfma_f32_32x32x16_bf16 a[32:47], a[224:227], a[232:235], a[32:47]
  s_add_u32 m0, s92, 1024
  s_mov_b32 s94, 9600
  buffer_load_dwordx4 v89, s[20:23], s94 offen lds
  v_mfma_f32_32x32x16_bf16 a[96:111], a[224:227], a[236:239], a[96:111]
  v_mfma_f32_32x32x16_bf16 a[48:63], a[228:231], a[232:235], a[48:63]
  s_add_u32 m0, s92, 2048
  s_mov_b32 s94, 18816
  buffer_load_dwordx4 v88, s[20:23], s94 offen lds
  v_mfma_f32_32x32x16_bf16 a[112:127], a[228:231], a[236:239], a[112:127]
  s_waitcnt lgkmcnt(0)
  v_mfma_f32_32x32x16_bf16 a[0:15], a[192:195], a[208:211], a[0:15]
  ds_read_b64_tr_b16 a[216:217], v76 offset:4096
  ds_read_b64_tr_b16 a[218:219], v76 offset:5120
  ds_read_b64_tr_b16 a[220:221], v77 offset:4096
  v_mfma_f32_32x32x16_bf16 a[64:79], a[192:195], a[212:215], a[64:79]
  ds_read_b64_tr_b16 a[222:223], v77 offset:5120
  ds_read_b64_tr_b16 a[224:225], v78 offset:4096
  ds_read_b64_tr_b16 a[226:227], v78 offset:5120
  v_mfma_f32_32x32x16_bf16 a[16:31], a[196:199], a[208:211], a[16:31]
  ds_read_b64_tr_b16 a[228:229], v79 offset:4096
  ds_read_b64_tr_b16 a[230:231], v79 offset:5120
  ds_read_b128 a[232:235], v73 offset:0
  s_add_u32 m0, s92, 3072
  s_mov_b32 s94, 28032
  buffer_load_dwordx4 v89, s[20:23], s94 offen lds
  v_mfma_f32_32x32x16_bf16 a[80:95], a[196:199], a[212:215], a[80:95]
  ds_read_b128 a[236:239], v73 offset:4096
  v_mfma_f32_32x32x16_bf16 a[32:47], a[200:203], a[208:211], a[32:47]
  s_add_u32 m0, s92, 4096
  s_mov_b32 s94, 37248
  buffer_load_dwordx4 v88, s[20:23], s94 offen lds
  v_mfma_f32_32x32x16_bf16 a[96:111], a[200:203], a[212:215], a[96:111]
  v_mfma_f32_32x32x16_bf16 a[48:63], a[204:207], a[208:211], a[48:63]
  s_add_u32 m0, s92, 5120
  s_mov_b32 s94, 46464
  buffer_load_dwordx4 v89, s[20:23], s94 offen lds
  v_mfma_f32_32x32x16_bf16 a[112:127], a[204:207], a[212:215], a[112:127]
  s_waitcnt lgkmcnt(0)
  v_mfma_f32_32x32x16_bf16 a[0:15], a[216:219], a[232:235], a[0:15]
  ds_read_b64_tr_b16 a[192:193], v76 offset:8192
  ds_read_b64_tr_b16 a[194:195], v76 offset:9216
  ds_read_b64_tr_b16 a[196:197], v77 offset:8192
  v_mfma_f32_32x32x16_bf16 a[64:79], a[216:219], a[236:239], a[64:79]
  ds_read_b64_tr_b16 a[198:199], v77 offset:9216
  ds_read_b64_tr_b16 a[200:201], v78 offset:8192
  ds_read_b64_tr_b16 a[202:203], v78 offset:9216
  v_mfma_f32_32x32x16_bf16 a[16:31], a[220:223], a[232:235], a[16:31]
  ds_read_b64_tr_b16 a[204:205], v79 offset:8192
  ds_read_b64_tr_b16 a[206:207], v79 offset:9216
  ds_read_b128 a[208:211], v74 offset:0
  s_add_u32 m0, s92, 6144
  s_mov_b32 s94, 55680
  buffer_load_dwordx4 v88, s[20:23], s94 offen lds
  v_mfma_f32_32x32x16_bf16 a[80:95], a[220:223], a[236:239], a[80:95]
  ds_read_b128 a[212:215], v74 offset:4096
  v_mfma_f32_32x32x16_bf16 a[32:47], a[224:227], a[232:235], a[32:47]
  s_add_u32 m0, s92, 7168
  s_mov_b32 s94, 64896
  buffer_load_dwordx4 v89, s[20:23], s94 offen lds
  v_mfma_f32_32x32x16_bf16 a[96:111], a[224:227], a[236:239], a[96:111]
  v_mfma_f32_32x32x16_bf16 a[48:63], a[228:231], a[232:235], a[48:63]
  s_add_u32 m0, s93, 0
  s_mov_b32 s94, 1572864
  buffer_load_dwordx4 v90, s[88:91], s94 offen lds
  v_mfma_f32_32x32x16_bf16 a[112:127], a[228:231], a[236:239], a[112:127]
  s_waitcnt lgkmcnt(0)
  v_mfma_f32_32x32x16_bf16 a[0:15], a[192:195], a[208:211], a[0:15]
  ds_read_b64_tr_b16 a[216:217], v76 offset:12288
  ds_read_b64_tr_b16 a[218:219], v76 offset:13312
  ds_read_b64_tr_b16 a[220:221], v77 offset:12288
  v_mfma_f32_32x32x16_bf16 a[64:79], a[192:195], a[212:215], a[64:79]
  ds_read_b64_tr_b16 a[222:223], v77 offset:13312
  ds_read_b64_tr_b16 a[224:225], v78 offset:12288
  ds_read_b64_tr_b16 a[226:227], v78 offset:13312
  v_mfma_f32_32x32x16_bf16 a[16:31], a[196:199], a[208:211], a[16:31]
  ds_read_b64_tr_b16 a[228:229], v79 offset:12288
  ds_read_b64_tr_b16 a[230:231], v79 offset:13312
  ds_read_b128 a[232:235], v75 offset:0
  s_add_u32 m0, s93, 1024
  s_mov_b32 s94, 1605632
  buffer_load_dwordx4 v90, s[88:91], s94 offen lds
  v_mfma_f32_32x32x16_bf16 a[80:95], a[196:199], a[212:215], a[80:95]
  ds_read_b128 a[236:239], v75 offset:4096
  v_mfma_f32_32x32x16_bf16 a[32:47], a[200:203], a[208:211], a[32:47]
  s_add_u32 m0, s93, 2048
  s_mov_b32 s94, 1638400
  buffer_load_dwordx4 v90, s[88:91], s94 offen lds
  v_mfma_f32_32x32x16_bf16 a[96:111], a[200:203], a[212:215], a[96:111]
  v_mfma_f32_32x32x16_bf16 a[48:63], a[204:207], a[208:211], a[48:63]
  s_add_u32 m0, s93, 3072
  s_mov_b32 s94, 1671168
  buffer_load_dwordx4 v90, s[88:91], s94 offen lds
  v_mfma_f32_32x32x16_bf16 a[112:127], a[204:207], a[212:215], a[112:127]
  s_waitcnt vmcnt(12) lgkmcnt(0)
  s_barrier
  v_mfma_f32_32x32x16_bf16 a[0:15], a[216:219], a[232:235], a[0:15]
  ds_read_b64_tr_b16 a[192:193], v84 offset:0
  ds_read_b64_tr_b16 a[194:195], v84 offset:1024
  ds_read_b64_tr_b16 a[196:197], v85 offset:0
  v_mfma_f32_32x32x16_bf16 a[64:79], a[216:219], a[236:239], a[64:79]
  ds_read_b64_tr_b16 a[198:199], v85 offset:1024
  ds_read_b64_tr_b16 a[200:201], v86 offset:0
  ds_read_b64_tr_b16 a[202:203], v86 offset:1024
  v_mfma_f32_32x32x16_bf16 a[16:31], a[220:223], a[232:235], a[16:31]
  ds_read_b64_tr_b16 a[204:205], v87 offset:0
  ds_read_b64_tr_b16 a[206:207], v87 offset:1024
  ds_read_b128 a[208:211], v80 offset:0
  s_add_u32 m0, s92, 49152
  s_mov_b32 s94, 512
  buffer_load_dwordx4 v88, s[20:23], s94 offen lds
  v_mfma_f32_32x32x16_bf16 a[80:95], a[220:223], a[236:239], a[80:95]
  ds_read_b128 a[212:215], v80 offset:4096
  v_mfma_f32_32x32x16_bf16 a[32:47], a[224:227], a[232:235], a[32:47]
  s_add_u32 m0, s92, 50176
  s_mov_b32 s94, 9728
  buffer_load_dwordx4 v89, s[20:23], s94 offen lds
  v_mfma_f32_32x32x16_bf16 a[96:111], a[224:227], a[236:239], a[96:111]
  v_mfma_f32_32x32x16_bf16 a[48:63], a[228:231], a[232:235], a[48:63]
  s_add_u32 m0, s92, 51200
  s_mov_b32 s94, 18944
  buffer_load_dwordx4 v88, s[20:23], s94 offen lds
  v_mfma_f32_32x32x16_bf16 a[112:127], a[228:231], a[236:239], a[112:127]
  s_waitcnt lgkmcnt(0)
  v_mfma_f32_32x32x16_bf16 a[0:15], a[192:195], a[208:211], a[0:15]
  ds_read_b64_tr_b16 a[216:217], v84 offset:4096
  ds_read_b64_tr_b16 a[218:219], v84 offset:5120
  ds_read_b64_tr_b16 a[220:221], v85 offset:4096
  v_mfma_f32_32x32x16_bf16 a[64:79], a[192:195], a[212:215], a[64:79]
  ds_read_b64_tr_b16 a[222:223], v85 offset:5120
  ds_read_b64_tr_b16 a[224:225], v86 offset:4096
  ds_read_b64_tr_b16 a[226:227], v86 offset:5120
  v_mfma_f32_32x32x16_bf16 a[16:31], a[196:199], a[208:211], a[16:31]
  ds_read_b64_tr_b16 a[228:229], v87 offset:4096
  ds_read_b64_tr_b16 a[230:231], v87 offset:5120
  ds_read_b128 a[232:235], v81 offset:0
  s_add_u32 m0, s92, 52224
  s_mov_b32 s94, 28160
  buffer_load_dwordx4 v89, s[20:23], s94 offen lds
  v_mfma_f32_32x32x16_bf16 a[80:95], a[196:199], a[212:215], a[80:95]
  ds_read_b128 a[236:239], v81 offset:4096
  v_mfma_f32_32x32x16_bf16 a[32:47], a[200:203], a[208:211], a[32:47]
  s_add_u32 m0, s92, 53248
  s_mov_b32 s94, 37376
  buffer_load_dwordx4 v88, s[20:23], s94 offen lds
  v_mfma_f32_32x32x16_bf16 a[96:111], a[200:203], a[212:215], a[96:111]
  v_mfma_f32_32x32x16_bf16 a[48:63], a[204:207], a[208:211], a[48:63]
  s_add_u32 m0, s92, 54272
  s_mov_b32 s94, 46592
  buffer_load_dwordx4 v89, s[20:23], s94 offen lds
  v_mfma_f32_32x32x16_bf16 a[112:127], a[204:207], a[212:215], a[112:127]
  s_waitcnt lgkmcnt(0)
  v_mfma_f32_32x32x16_bf16 a[0:15], a[216:219], a[232:235], a[0:15]
  ds_read_b64_tr_b16 a[192:193], v84 offset:8192
  ds_read_b64_tr_b16 a[194:195], v84 offset:9216
  ds_read_b64_tr_b16 a[196:197], v85 offset:8192
  v_mfma_f32_32x32x16_bf16 a[64:79], a[216:219], a[236:239], a[64:79]
  ds_read_b64_tr_b16 a[198:199], v85 offset:9216
  ds_read_b64_tr_b16 a[200:201], v86 offset:8192
  ds_read_b64_tr_b16 a[202:203], v86 offset:9216
  v_mfma_f32_32x32x16_bf16 a[16:31], a[220:223], a[232:235], a[16:31]
  ds_read_b64_tr_b16 a[204:205], v87 offset:8192
  ds_read_b64_tr_b16 a[206:207], v87 offset:9216
  ds_read_b128 a[208:211], v82 offset:0
  s_add_u32 m0, s92, 55296
  s_mov_b32 s94, 55808
  buffer_load_dwordx4 v88, s[20:23], s94 offen lds
  v_mfma_f32_32x32x16_bf16 a[80:95], a[220:223], a[236:239], a[80:95]
  ds_read_b128 a[212:215], v82 offset:4096
  v_mfma_f32_32x32x16_bf16 a[32:47], a[224:227], a[232:235], a[32:47]
  s_add_u32 m0, s92, 56320
  s_mov_b32 s94, 65024
  buffer_load_dwordx4 v89, s[20:23], s94 offen lds
  v_mfma_f32_32x32x16_bf16 a[96:111], a[224:227], a[236:239], a[96:111]
  v_mfma_f32_32x32x16_bf16 a[48:63], a[228:231], a[232:235], a[48:63]
  s_add_u32 m0, s93, 49152
  s_mov_b32 s94, 2097152
  buffer_load_dwordx4 v90, s[88:91], s94 offen lds
  v_mfma_f32_32x32x16_bf16 a[112:127], a[228:231], a[236:239], a[112:127]
  s_waitcnt lgkmcnt(0)
  v_mfma_f32_32x32x16_bf16 a[0:15], a[192:195], a[208:211], a[0:15]
  ds_read_b64_tr_b16 a[216:217], v84 offset:12288
  ds_read_b64_tr_b16 a[218:219], v84 offset:13312
  ds_read_b64_tr_b16 a[220:221], v85 offset:12288
  v_mfma_f32_32x32x16_bf16 a[64:79], a[192:195], a[212:215], a[64:79]
  ds_read_b64_tr_b16 a[222:223], v85 offset:13312
  ds_read_b64_tr_b16 a[224:225], v86 offset:12288
  ds_read_b64_tr_b16 a[226:227], v86 offset:13312
  v_mfma_f32_32x32x16_bf16 a[16:31], a[196:199], a[208:211], a[16:31]
  ds_read_b64_tr_b16 a[228:229], v87 offset:12288
  ds_read_b64_tr_b16 a[230:231], v87 offset:13312
  ds_read_b128 a[232:235], v83 offset:0
  s_add_u32 m0, s93, 50176
  s_mov_b32 s94, 2129920
  buffer_load_dwordx4 v90, s[88:91], s94 offen lds
  v_mfma_f32_32x32x16_bf16 a[80:95], a[196:199], a[212:215], a[80:95]
  ds_read_b128 a[236:239], v83 offset:4096
  v_mfma_f32_32x32x16_bf16 a[32:47], a[200:203], a[208:211], a[32:47]
  s_add_u32 m0, s93, 51200
  s_mov_b32 s94, 2162688
  buffer_load_dwordx4 v90, s[88:91], s94 offen lds
  v_mfma_f32_32x32x16_bf16 a[96:111], a[200:203], a[212:215], a[96:111]
  v_mfma_f32_32x32x16_bf16 a[48:63], a[204:207], a[208:211], a[48:63]
  s_add_u32 m0, s93, 52224
  s_mov_b32 s94, 2195456
  buffer_load_dwordx4 v90, s[88:91], s94 offen lds
  v_mfma_f32_32x32x16_bf16 a[112:127], a[204:207], a[212:215], a[112:127]
  s_waitcnt vmcnt(12) lgkmcnt(0)
  s_barrier
  v_mfma_f32_32x32x16_bf16 a[0:15], a[216:219], a[232:235], a[0:15]
  ds_read_b64_tr_b16 a[192:193], v68 offset:0
  ds_read_b64_tr_b16 a[194:195], v68 offset:1024
  ds_read_b64_tr_b16 a[196:197], v69 offset:0
  v_mfma_f32_32x32x16_bf16 a[64:79], a[216:219], a[236:239], a[64:79]
  ds_read_b64_tr_b16 a[198:199], v69 offset:1024
  ds_read_b64_tr_b16 a[200:201], v70 offset:0
  ds_read_b64_tr_b16 a[202:203], v70 offset:1024
  v_mfma_f32_32x32x16_bf16 a[16:31], a[220:223], a[232:235], a[16:31]
  ds_read_b64_tr_b16 a[204:205], v71 offset:0
  ds_read_b64_tr_b16 a[206:207], v71 offset:1024
  ds_read_b128 a[208:211], v64 offset:0
  s_add_u32 m0, s92, 98304
  s_mov_b32 s94, 640
  buffer_load_dwordx4 v88, s[20:23], s94 offen lds
  v_mfma_f32_32x32x16_bf16 a[80:95], a[220:223], a[236:239], a[80:95]
  ds_read_b128 a[212:215], v64 offset:4096
  v_mfma_f32_32x32x16_bf16 a[32:47], a[224:227], a[232:235], a[32:47]
  s_add_u32 m0, s92, 99328
  s_mov_b32 s94, 9856
  buffer_load_dwordx4 v89, s[20:23], s94 offen lds
  v_mfma_f32_32x32x16_bf16 a[96:111], a[224:227], a[236:239], a[96:111]
  v_mfma_f32_32x32x16_bf16 a[48:63], a[228:231], a[232:235], a[48:63]
  s_add_u32 m0, s92, 100352
  s_mov_b32 s94, 19072
  buffer_load_dwordx4 v88, s[20:23], s94 offen lds
  v_mfma_f32_32x32x16_bf16 a[112:127], a[228:231], a[236:239], a[112:127]
  s_waitcnt lgkmcnt(0)
  v_mfma_f32_32x32x16_bf16 a[0:15], a[192:195], a[208:211], a[0:15]
  ds_read_b64_tr_b16 a[216:217], v68 offset:4096
  ds_read_b64_tr_b16 a[218:219], v68 offset:5120
  ds_read_b64_tr_b16 a[220:221], v69 offset:4096
  v_mfma_f32_32x32x16_bf16 a[64:79], a[192:195], a[212:215], a[64:79]
  ds_read_b64_tr_b16 a[222:223], v69 offset:5120
  ds_read_b64_tr_b16 a[224:225], v70 offset:4096
  ds_read_b64_tr_b16 a[226:227], v70 offset:5120
  v_mfma_f32_32x32x16_bf16 a[16:31], a[196:199], a[208:211], a[16:31]
  ds_read_b64_tr_b16 a[228:229], v71 offset:4096
  ds_read_b64_tr_b16 a[230:231], v71 offset:5120
  ds_read_b128 a[232:235], v65 offset:0
  s_add_u32 m0, s92, 101376
  s_mov_b32 s94, 28288
  buffer_load_dwordx4 v89, s[20:23], s94 offen lds
  v_mfma_f32_32x32x16_bf16 a[80:95], a[196:199], a[212:215], a[80:95]
  ds_read_b128 a[236:239], v65 offset:4096
  v_mfma_f32_32x32x16_bf16 a[32:47], a[200:203], a[208:211], a[32:47]
  s_add_u32 m0, s92, 102400
  s_mov_b32 s94, 37504
  buffer_load_dwordx4 v88, s[20:23], s94 offen lds
  v_mfma_f32_32x32x16_bf16 a[96:111], a[200:203], a[212:215], a[96:111]
  v_mfma_f32_32x32x16_bf16 a[48:63], a[204:207], a[208:211], a[48:63]
  s_add_u32 m0, s92, 103424
  s_mov_b32 s94, 46720
  buffer_load_dwordx4 v89, s[20:23], s94 offen lds
  v_mfma_f32_32x32x16_bf16 a[112:127], a[204:207], a[212:215], a[112:127]
  s_waitcnt lgkmcnt(0)
  v_mfma_f32_32x32x16_bf16 a[0:15], a[216:219], a[232:235], a[0:15]
  ds_read_b64_tr_b16 a[192:193], v68 offset:8192
  ds_read_b64_tr_b16 a[194:195], v68 offset:9216
  ds_read_b64_tr_b16 a[196:197], v69 offset:8192
  v_mfma_f32_32x32x16_bf16 a[64:79], a[216:219], a[236:239], a[64:79]
  ds_read_b64_tr_b16 a[198:199], v69 offset:9216
  ds_read_b64_tr_b16 a[200:201], v70 offset:8192
  ds_read_b64_tr_b16 a[202:203], v70 offset:9216
  v_mfma_f32_32x32x16_bf16 a[16:31], a[220:223], a[232:235], a[16:31]
  ds_read_b64_tr_b16 a[204:205], v71 offset:8192
  ds_read_b64_tr_b16 a[206:207], v71 offset:9216
  ds_read_b128 a[208:211], v66 offset:0
  s_add_u32 m0, s92, 104448
  s_mov_b32 s94, 55936
  buffer_load_dwordx4 v88, s[20:23], s94 offen lds
  v_mfma_f32_32x32x16_bf16 a[80:95], a[220:223], a[236:239], a[80:95]
  ds_read_b128 a[212:215], v66 offset:4096
  v_mfma_f32_32x32x16_bf16 a[32:47], a[224:227], a[232:235], a[32:47]
  s_add_u32 m0, s92, 105472
  s_mov_b32 s94, 65152
  buffer_load_dwordx4 v89, s[20:23], s94 offen lds
  v_mfma_f32_32x32x16_bf16 a[96:111], a[224:227], a[236:239], a[96:111]
  v_mfma_f32_32x32x16_bf16 a[48:63], a[228:231], a[232:235], a[48:63]
  s_add_u32 m0, s93, 98304
  s_mov_b32 s94, 2621440
  buffer_load_dwordx4 v90, s[88:91], s94 offen lds
  v_mfma_f32_32x32x16_bf16 a[112:127], a[228:231], a[236:239], a[112:127]
  s_waitcnt lgkmcnt(0)
  v_mfma_f32_32x32x16_bf16 a[0:15], a[192:195], a[208:211], a[0:15]
  ds_read_b64_tr_b16 a[216:217], v68 offset:12288
  ds_read_b64_tr_b16 a[218:219], v68 offset:13312
  ds_read_b64_tr_b16 a[220:221], v69 offset:12288
  v_mfma_f32_32x32x16_bf16 a[64:79], a[192:195], a[212:215], a[64:79]
  ds_read_b64_tr_b16 a[222:223], v69 offset:13312
  ds_read_b64_tr_b16 a[224:225], v70 offset:12288
  ds_read_b64_tr_b16 a[226:227], v70 offset:13312
  v_mfma_f32_32x32x16_bf16 a[16:31], a[196:199], a[208:211], a[16:31]
  ds_read_b64_tr_b16 a[228:229], v71 offset:12288
  ds_read_b64_tr_b16 a[230:231], v71 offset:13312
  ds_read_b128 a[232:235], v67 offset:0
  s_add_u32 m0, s93, 99328
  s_mov_b32 s94, 2654208
  buffer_load_dwordx4 v90, s[88:91], s94 offen lds
  v_mfma_f32_32x32x16_bf16 a[80:95], a[196:199], a[212:215], a[80:95]
  ds_read_b128 a[236:239], v67 offset:4096
  v_mfma_f32_32x32x16_bf16 a[32:47], a[200:203], a[208:211], a[32:47]
  s_add_u32 m0, s93, 100352
  s_mov_b32 s94, 2686976
  buffer_load_dwordx4 v90, s[88:91], s94 offen lds
  v_mfma_f32_32x32x16_bf16 a[96:111], a[200:203], a[212:215], a[96:111]
  v_mfma_f32_32x32x16_bf16 a[48:63], a[204:207], a[208:211], a[48:63]
  s_add_u32 m0, s93, 101376
  s_mov_b32 s94, 2719744
  buffer_load_dwordx4 v90, s[88:91], s94 offen lds
  v_mfma_f32_32x32x16_bf16 a[112:127], a[204:207], a[212:215], a[112:127]
  s_waitcnt vmcnt(12) lgkmcnt(0)
  s_barrier
  v_mfma_f32_32x32x16_bf16 a[0:15], a[216:219], a[232:235], a[0:15]
  ds_read_b64_tr_b16 a[192:193], v76 offset:0
  ds_read_b64_tr_b16 a[194:195], v76 offset:1024
  ds_read_b64_tr_b16 a[196:197], v77 offset:0
  v_mfma_f32_32x32x16_bf16 a[64:79], a[216:219], a[236:239], a[64:79]
  ds_read_b64_tr_b16 a[198:199], v77 offset:1024
  ds_read_b64_tr_b16 a[200:201], v78 offset:0
  ds_read_b64_tr_b16 a[202:203], v78 offset:1024
  v_mfma_f32_32x32x16_bf16 a[16:31], a[220:223], a[232:235], a[16:31]
  ds_read_b64_tr_b16 a[204:205], v79 offset:0
  ds_read_b64_tr_b16 a[206:207], v79 offset:1024
  ds_read_b128 a[208:211], v72 offset:0
  s_add_u32 m0, s92, 0
  s_mov_b32 s94, 768
  buffer_load_dwordx4 v88, s[20:23], s94 offen lds
  v_mfma_f32_32x32x16_bf16 a[80:95], a[220:223], a[236:239], a[80:95]
  ds_read_b128 a[212:215], v72 offset:4096
  v_mfma_f32_32x32x16_bf16 a[32:47], a[224:227], a[232:235], a[32:47]
  s_add_u32 m0, s92, 1024
  s_mov_b32 s94, 9984
  buffer_load_dwordx4 v89, s[20:23], s94 offen lds
  v_mfma_f32_32x32x16_bf16 a[96:111], a[224:227], a[236:239], a[96:111]
  v_mfma_f32_32x32x16_bf16 a[48:63], a[228:231], a[232:235], a[48:63]
  s_add_u32 m0, s92, 2048
  s_mov_b32 s94, 19200
  buffer_load_dwordx4 v88, s[20:23], s94 offen lds
  v_mfma_f32_32x32x16_bf16 a[112:127], a[228:231], a[236:239], a[112:127]
  s_waitcnt lgkmcnt(0)
  v_mfma_f32_32x32x16_bf16 a[0:15], a[192:195], a[208:211], a[0:15]
  ds_read_b64_tr_b16 a[216:217], v76 offset:4096
  ds_read_b64_tr_b16 a[218:219], v76 offset:5120
  ds_read_b64_tr_b16 a[220:221], v77 offset:4096
  v_mfma_f32_32x32x16_bf16 a[64:79], a[192:195], a[212:215], a[64:79]
  ds_read_b64_tr_b16 a[222:223], v77 offset:5120
  ds_read_b64_tr_b16 a[224:225], v78 offset:4096
  ds_read_b64_tr_b16 a[226:227], v78 offset:5120
  v_mfma_f32_32x32x16_bf16 a[16:31], a[196:199], a[208:211], a[16:31]
  ds_read_b64_tr_b16 a[228:229], v79 offset:4096
  ds_read_b64_tr_b16 a[230:231], v79 offset:5120
  ds_read_b128 a[232:235], v73 offset:0
  s_add_u32 m0, s92, 3072
  s_mov_b32 s94, 28416
  buffer_load_dwordx4 v89, s[20:23], s94 offen lds
  v_mfma_f32_32x32x16_bf16 a[80:95], a[196:199], a[212:215], a[80:95]
  ds_read_b128 a[236:239], v73 offset:4096
  v_mfma_f32_32x32x16_bf16 a[32:47], a[200:203], a[208:211], a[32:47]
  s_add_u32 m0, s92, 4096
  s_mov_b32 s94, 37632
  buffer_load_dwordx4 v88, s[20:23], s94 offen lds
  v_mfma_f32_32x32x16_bf16 a[96:111], a[200:203], a[212:215], a[96:111]
  v_mfma_f32_32x32x16_bf16 a[48:63], a[204:207], a[208:211], a[48:63]
  s_add_u32 m0, s92, 5120
  s_mov_b32 s94, 46848
  buffer_load_dwordx4 v89, s[20:23], s94 offen lds
  v_mfma_f32_32x32x16_bf16 a[112:127], a[204:207], a[212:215], a[112:127]
  s_waitcnt lgkmcnt(0)
  v_mfma_f32_32x32x16_bf16 a[0:15], a[216:219], a[232:235], a[0:15]
  ds_read_b64_tr_b16 a[192:193], v76 offset:8192
  ds_read_b64_tr_b16 a[194:195], v76 offset:9216
  ds_read_b64_tr_b16 a[196:197], v77 offset:8192
  v_mfma_f32_32x32x16_bf16 a[64:79], a[216:219], a[236:239], a[64:79]
  ds_read_b64_tr_b16 a[198:199], v77 offset:9216
  ds_read_b64_tr_b16 a[200:201], v78 offset:8192
  ds_read_b64_tr_b16 a[202:203], v78 offset:9216
  v_mfma_f32_32x32x16_bf16 a[16:31], a[220:223], a[232:235], a[16:31]
  ds_read_b64_tr_b16 a[204:205], v79 offset:8192
  ds_read_b64_tr_b16 a[206:207], v79 offset:9216
  ds_read_b128 a[208:211], v74 offset:0
  s_add_u32 m0, s92, 6144
  s_mov_b32 s94, 56064
  buffer_load_dwordx4 v88, s[20:23], s94 offen lds
  v_mfma_f32_32x32x16_bf16 a[80:95], a[220:223], a[236:239], a[80:95]
  ds_read_b128 a[212:215], v74 offset:4096
  v_mfma_f32_32x32x16_bf16 a[32:47], a[224:227], a[232:235], a[32:47]
  s_add_u32 m0, s92, 7168
  s_mov_b32 s94, 65280
  buffer_load_dwordx4 v89, s[20:23], s94 offen lds
  v_mfma_f32_32x32x16_bf16 a[96:111], a[224:227], a[236:239], a[96:111]
  v_mfma_f32_32x32x16_bf16 a[48:63], a[228:231], a[232:235], a[48:63]
  s_add_u32 m0, s93, 0
  s_mov_b32 s94, 3145728
  buffer_load_dwordx4 v90, s[88:91], s94 offen lds
  v_mfma_f32_32x32x16_bf16 a[112:127], a[228:231], a[236:239], a[112:127]
  s_waitcnt lgkmcnt(0)
  v_mfma_f32_32x32x16_bf16 a[0:15], a[192:195], a[208:211], a[0:15]
  ds_read_b64_tr_b16 a[216:217], v76 offset:12288
  ds_read_b64_tr_b16 a[218:219], v76 offset:13312
  ds_read_b64_tr_b16 a[220:221], v77 offset:12288
  v_mfma_f32_32x32x16_bf16 a[64:79], a[192:195], a[212:215], a[64:79]
  ds_read_b64_tr_b16 a[222:223], v77 offset:13312
  ds_read_b64_tr_b16 a[224:225], v78 offset:12288
  ds_read_b64_tr_b16 a[226:227], v78 offset:13312
  v_mfma_f32_32x32x16_bf16 a[16:31], a[196:199], a[208:211], a[16:31]
  ds_read_b64_tr_b16 a[228:229], v79 offset:12288
  ds_read_b64_tr_b16 a[230:231], v79 offset:13312
  ds_read_b128 a[232:235], v75 offset:0
  s_add_u32 m0, s93, 1024
  s_mov_b32 s94, 3178496
  buffer_load_dwordx4 v90, s[88:91], s94 offen lds
  v_mfma_f32_32x32x16_bf16 a[80:95], a[196:199], a[212:215], a[80:95]
  ds_read_b128 a[236:239], v75 offset:4096
  v_mfma_f32_32x32x16_bf16 a[32:47], a[200:203], a[208:211], a[32:47]
  s_add_u32 m0, s93, 2048
  s_mov_b32 s94, 3211264
  buffer_load_dwordx4 v90, s[88:91], s94 offen lds
  v_mfma_f32_32x32x16_bf16 a[96:111], a[200:203], a[212:215], a[96:111]
  v_mfma_f32_32x32x16_bf16 a[48:63], a[204:207], a[208:211], a[48:63]
  s_add_u32 m0, s93, 3072
  s_mov_b32 s94, 3244032
  buffer_load_dwordx4 v90, s[88:91], s94 offen lds
  v_mfma_f32_32x32x16_bf16 a[112:127], a[204:207], a[212:215], a[112:127]
  s_waitcnt vmcnt(12) lgkmcnt(0)
  s_barrier
  v_mfma_f32_32x32x16_bf16 a[0:15], a[216:219], a[232:235], a[0:15]
  ds_read_b64_tr_b16 a[192:193], v84 offset:0
  ds_read_b64_tr_b16 a[194:195], v84 offset:1024
  ds_read_b64_tr_b16 a[196:197], v85 offset:0
  v_mfma_f32_32x32x16_bf16 a[64:79], a[216:219], a[236:239], a[64:79]
  ds_read_b64_tr_b16 a[198:199], v85 offset:1024
  ds_read_b64_tr_b16 a[200:201], v86 offset:0
  ds_read_b64_tr_b16 a[202:203], v86 offset:1024
  v_mfma_f32_32x32x16_bf16 a[16:31], a[220:223], a[232:235], a[16:31]
  ds_read_b64_tr_b16 a[204:205], v87 offset:0
  ds_read_b64_tr_b16 a[206:207], v87 offset:1024
  ds_read_b128 a[208:211], v80 offset:0
  s_add_u32 m0, s92, 49152
  s_mov_b32 s94, 896
  buffer_load_dwordx4 v88, s[20:23], s94 offen lds
  v_mfma_f32_32x32x16_bf16 a[80:95], a[220:223], a[236:239], a[80:95]
  ds_read_b128 a[212:215], v80 offset:4096
  v_mfma_f32_32x32x16_bf16 a[32:47], a[224:227], a[232:235], a[32:47]
  s_add_u32 m0, s92, 50176
  s_mov_b32 s94, 10112
  buffer_load_dwordx4 v89, s[20:23], s94 offen lds
  v_mfma_f32_32x32x16_bf16 a[96:111], a[224:227], a[236:239], a[96:111]
  v_mfma_f32_32x32x16_bf16 a[48:63], a[228:231], a[232:235], a[48:63]
  s_add_u32 m0, s92, 51200
  s_mov_b32 s94, 19328
  buffer_load_dwordx4 v88, s[20:23], s94 offen lds
  v_mfma_f32_32x32x16_bf16 a[112:127], a[228:231], a[236:239], a[112:127]
  s_waitcnt lgkmcnt(0)
  v_mfma_f32_32x32x16_bf16 a[0:15], a[192:195], a[208:211], a[0:15]
  ds_read_b64_tr_b16 a[216:217], v84 offset:4096
  ds_read_b64_tr_b16 a[218:219], v84 offset:5120
  ds_read_b64_tr_b16 a[220:221], v85 offset:4096
  v_mfma_f32_32x32x16_bf16 a[64:79], a[192:195], a[212:215], a[64:79]
  ds_read_b64_tr_b16 a[222:223], v85 offset:5120
  ds_read_b64_tr_b16 a[224:225], v86 offset:4096
  ds_read_b64_tr_b16 a[226:227], v86 offset:5120
  v_mfma_f32_32x32x16_bf16 a[16:31], a[196:199], a[208:211], a[16:31]
  ds_read_b64_tr_b16 a[228:229], v87 offset:4096
  ds_read_b64_tr_b16 a[230:231], v87 offset:5120
  ds_read_b128 a[232:235], v81 offset:0
  s_add_u32 m0, s92, 52224
  s_mov_b32 s94, 28544
  buffer_load_dwordx4 v89, s[20:23], s94 offen lds
  v_mfma_f32_32x32x16_bf16 a[80:95], a[196:199], a[212:215], a[80:95]
  ds_read_b128 a[236:239], v81 offset:4096
  v_mfma_f32_32x32x16_bf16 a[32:47], a[200:203], a[208:211], a[32:47]
  s_add_u32 m0, s92, 53248
  s_mov_b32 s94, 37760
  buffer_load_dwordx4 v88, s[20:23], s94 offen lds
  v_mfma_f32_32x32x16_bf16 a[96:111], a[200:203], a[212:215], a[96:111]
  v_mfma_f32_32x32x16_bf16 a[48:63], a[204:207], a[208:211], a[48:63]
  s_add_u32 m0, s92, 54272
  s_mov_b32 s94, 46976
  buffer_load_dwordx4 v89, s[20:23], s94 offen lds
  v_mfma_f32_32x32x16_bf16 a[112:127], a[204:207], a[212:215], a[112:127]
  s_waitcnt lgkmcnt(0)
  v_mfma_f32_32x32x16_bf16 a[0:15], a[216:219], a[232:235], a[0:15]
  ds_read_b64_tr_b16 a[192:193], v84 offset:8192
  ds_read_b64_tr_b16 a[194:195], v84 offset:9216
  ds_read_b64_tr_b16 a[196:197], v85 offset:8192
  v_mfma_f32_32x32x16_bf16 a[64:79], a[216:219], a[236:239], a[64:79]
  ds_read_b64_tr_b16 a[198:199], v85 offset:9216
  ds_read_b64_tr_b16 a[200:201], v86 offset:8192
  ds_read_b64_tr_b16 a[202:203], v86 offset:9216
  v_mfma_f32_32x32x16_bf16 a[16:31], a[220:223], a[232:235], a[16:31]
  ds_read_b64_tr_b16 a[204:205], v87 offset:8192
  ds_read_b64_tr_b16 a[206:207], v87 offset:9216
  ds_read_b128 a[208:211], v82 offset:0
  s_add_u32 m0, s92, 55296
  s_mov_b32 s94, 56192
  buffer_load_dwordx4 v88, s[20:23], s94 offen lds
  v_mfma_f32_32x32x16_bf16 a[80:95], a[220:223], a[236:239], a[80:95]
  ds_read_b128 a[212:215], v82 offset:4096
  v_mfma_f32_32x32x16_bf16 a[32:47], a[224:227], a[232:235], a[32:47]
  s_add_u32 m0, s92, 56320
  s_mov_b32 s94, 65408
  buffer_load_dwordx4 v89, s[20:23], s94 offen lds
  v_mfma_f32_32x32x16_bf16 a[96:111], a[224:227], a[236:239], a[96:111]
  v_mfma_f32_32x32x16_bf16 a[48:63], a[228:231], a[232:235], a[48:63]
  s_add_u32 m0, s93, 49152
  s_mov_b32 s94, 3670016
  buffer_load_dwordx4 v90, s[88:91], s94 offen lds
  v_mfma_f32_32x32x16_bf16 a[112:127], a[228:231], a[236:239], a[112:127]
  s_waitcnt lgkmcnt(0)
  v_mfma_f32_32x32x16_bf16 a[0:15], a[192:195], a[208:211], a[0:15]
  ds_read_b64_tr_b16 a[216:217], v84 offset:12288
  ds_read_b64_tr_b16 a[218:219], v84 offset:13312
  ds_read_b64_tr_b16 a[220:221], v85 offset:12288
  v_mfma_f32_32x32x16_bf16 a[64:79], a[192:195], a[212:215], a[64:79]
  ds_read_b64_tr_b16 a[222:223], v85 offset:13312
  ds_read_b64_tr_b16 a[224:225], v86 offset:12288
  ds_read_b64_tr_b16 a[226:227], v86 offset:13312
  v_mfma_f32_32x32x16_bf16 a[16:31], a[196:199], a[208:211], a[16:31]
  ds_read_b64_tr_b16 a[228:229], v87 offset:12288
  ds_read_b64_tr_b16 a[230:231], v87 offset:13312
  ds_read_b128 a[232:235], v83 offset:0
  s_add_u32 m0, s93, 50176
  s_mov_b32 s94, 3702784
  buffer_load_dwordx4 v90, s[88:91], s94 offen lds
  v_mfma_f32_32x32x16_bf16 a[80:95], a[196:199], a[212:215], a[80:95]
  ds_read_b128 a[236:239], v83 offset:4096
  v_mfma_f32_32x32x16_bf16 a[32:47], a[200:203], a[208:211], a[32:47]
  s_add_u32 m0, s93, 51200
  s_mov_b32 s94, 3735552
  buffer_load_dwordx4 v90, s[88:91], s94 offen lds
  v_mfma_f32_32x32x16_bf16 a[96:111], a[200:203], a[212:215], a[96:111]
  v_mfma_f32_32x32x16_bf16 a[48:63], a[204:207], a[208:211], a[48:63]
  s_add_u32 m0, s93, 52224
  s_mov_b32 s94, 3768320
  buffer_load_dwordx4 v90, s[88:91], s94 offen lds
  v_mfma_f32_32x32x16_bf16 a[112:127], a[204:207], a[212:215], a[112:127]
  s_waitcnt vmcnt(12) lgkmcnt(0)
  s_barrier
  v_mfma_f32_32x32x16_bf16 a[0:15], a[216:219], a[232:235], a[0:15]
  ds_read_b64_tr_b16 a[192:193], v68 offset:0
  ds_read_b64_tr_b16 a[194:195], v68 offset:1024
  ds_read_b64_tr_b16 a[196:197], v69 offset:0
  v_mfma_f32_32x32x16_bf16 a[64:79], a[216:219], a[236:239], a[64:79]
  ds_read_b64_tr_b16 a[198:199], v69 offset:1024
  ds_read_b64_tr_b16 a[200:201], v70 offset:0
  ds_read_b64_tr_b16 a[202:203], v70 offset:1024
  v_mfma_f32_32x32x16_bf16 a[16:31], a[220:223], a[232:235], a[16:31]
  ds_read_b64_tr_b16 a[204:205], v71 offset:0
  ds_read_b64_tr_b16 a[206:207], v71 offset:1024
  ds_read_b128 a[208:211], v64 offset:0
  s_add_u32 m0, s92, 98304
  s_mov_b32 s94, 1024
  buffer_load_dwordx4 v88, s[20:23], s94 offen lds
  v_mfma_f32_32x32x16_bf16 a[80:95], a[220:223], a[236:239], a[80:95]
  ds_read_b128 a[212:215], v64 offset:4096
  v_mfma_f32_32x32x16_bf16 a[32:47], a[224:227], a[232:235], a[32:47]
  s_add_u32 m0, s92, 99328
  s_mov_b32 s94, 10240
  buffer_load_dwordx4 v89, s[20:23], s94 offen lds
  v_mfma_f32_32x32x16_bf16 a[96:111], a[224:227], a[236:239], a[96:111]
  v_mfma_f32_32x32x16_bf16 a[48:63], a[228:231], a[232:235], a[48:63]
  s_add_u32 m0, s92, 100352
  s_mov_b32 s94, 19456
  buffer_load_dwordx4 v88, s[20:23], s94 offen lds
  v_mfma_f32_32x32x16_bf16 a[112:127], a[228:231], a[236:239], a[112:127]
  s_waitcnt lgkmcnt(0)
  v_mfma_f32_32x32x16_bf16 a[0:15], a[192:195], a[208:211], a[0:15]
  ds_read_b64_tr_b16 a[216:217], v68 offset:4096
  ds_read_b64_tr_b16 a[218:219], v68 offset:5120
  ds_read_b64_tr_b16 a[220:221], v69 offset:4096
  v_mfma_f32_32x32x16_bf16 a[64:79], a[192:195], a[212:215], a[64:79]
  ds_read_b64_tr_b16 a[222:223], v69 offset:5120
  ds_read_b64_tr_b16 a[224:225], v70 offset:4096
  ds_read_b64_tr_b16 a[226:227], v70 offset:5120
  v_mfma_f32_32x32x16_bf16 a[16:31], a[196:199], a[208:211], a[16:31]
  ds_read_b64_tr_b16 a[228:229], v71 offset:4096
  ds_read_b64_tr_b16 a[230:231], v71 offset:5120
  ds_read_b128 a[232:235], v65 offset:0
  s_add_u32 m0, s92, 101376
  s_mov_b32 s94, 28672
  buffer_load_dwordx4 v89, s[20:23], s94 offen lds
  v_mfma_f32_32x32x16_bf16 a[80:95], a[196:199], a[212:215], a[80:95]
  ds_read_b128 a[236:239], v65 offset:4096
  v_mfma_f32_32x32x16_bf16 a[32:47], a[200:203], a[208:211], a[32:47]
  s_add_u32 m0, s92, 102400
  s_mov_b32 s94, 37888
  buffer_load_dwordx4 v88, s[20:23], s94 offen lds
  v_mfma_f32_32x32x16_bf16 a[96:111], a[200:203], a[212:215], a[96:111]
  v_mfma_f32_32x32x16_bf16 a[48:63], a[204:207], a[208:211], a[48:63]
  s_add_u32 m0, s92, 103424
  s_mov_b32 s94, 47104
  buffer_load_dwordx4 v89, s[20:23], s94 offen lds
  v_mfma_f32_32x32x16_bf16 a[112:127], a[204:207], a[212:215], a[112:127]
  s_waitcnt lgkmcnt(0)
  v_mfma_f32_32x32x16_bf16 a[0:15], a[216:219], a[232:235], a[0:15]
  ds_read_b64_tr_b16 a[192:193], v68 offset:8192
  ds_read_b64_tr_b16 a[194:195], v68 offset:9216
  ds_read_b64_tr_b16 a[196:197], v69 offset:8192
  v_mfma_f32_32x32x16_bf16 a[64:79], a[216:219], a[236:239], a[64:79]
  ds_read_b64_tr_b16 a[198:199], v69 offset:9216
  ds_read_b64_tr_b16 a[200:201], v70 offset:8192
  ds_read_b64_tr_b16 a[202:203], v70 offset:9216
  v_mfma_f32_32x32x16_bf16 a[16:31], a[220:223], a[232:235], a[16:31]
  ds_read_b64_tr_b16 a[204:205], v71 offset:8192
  ds_read_b64_tr_b16 a[206:207], v71 offset:9216
  ds_read_b128 a[208:211], v66 offset:0
  s_add_u32 m0, s92, 104448
  s_mov_b32 s94, 56320
  buffer_load_dwordx4 v88, s[20:23], s94 offen lds
  v_mfma_f32_32x32x16_bf16 a[80:95], a[220:223], a[236:239], a[80:95]
  ds_read_b128 a[212:215], v66 offset:4096
  v_mfma_f32_32x32x16_bf16 a[32:47], a[224:227], a[232:235], a[32:47]
  s_add_u32 m0, s92, 105472
  s_mov_b32 s94, 65536
  buffer_load_dwordx4 v89, s[20:23], s94 offen lds
  v_mfma_f32_32x32x16_bf16 a[96:111], a[224:227], a[236:239], a[96:111]
  v_mfma_f32_32x32x16_bf16 a[48:63], a[228:231], a[232:235], a[48:63]
  s_add_u32 m0, s93, 98304
  s_mov_b32 s94, 4194304
  buffer_load_dwordx4 v90, s[88:91], s94 offen lds
  v_mfma_f32_32x32x16_bf16 a[112:127], a[228:231], a[236:239], a[112:127]
  s_waitcnt lgkmcnt(0)
  v_mfma_f32_32x32x16_bf16 a[0:15], a[192:195], a[208:211], a[0:15]
  ds_read_b64_tr_b16 a[216:217], v68 offset:12288
  ds_read_b64_tr_b16 a[218:219], v68 offset:13312
  ds_read_b64_tr_b16 a[220:221], v69 offset:12288
  v_mfma_f32_32x32x16_bf16 a[64:79], a[192:195], a[212:215], a[64:79]
  ds_read_b64_tr_b16 a[222:223], v69 offset:13312
  ds_read_b64_tr_b16 a[224:225], v70 offset:12288
  ds_read_b64_tr_b16 a[226:227], v70 offset:13312
  v_mfma_f32_32x32x16_bf16 a[16:31], a[196:199], a[208:211], a[16:31]
  ds_read_b64_tr_b16 a[228:229], v71 offset:12288
  ds_read_b64_tr_b16 a[230:231], v71 offset:13312
  ds_read_b128 a[232:235], v67 offset:0
  s_add_u32 m0, s93, 99328
  s_mov_b32 s94, 4227072
  buffer_load_dwordx4 v90, s[88:91], s94 offen lds
  v_mfma_f32_32x32x16_bf16 a[80:95], a[196:199], a[212:215], a[80:95]
  ds_read_b128 a[236:239], v67 offset:4096
  v_mfma_f32_32x32x16_bf16 a[32:47], a[200:203], a[208:211], a[32:47]
  s_add_u32 m0, s93, 100352
  s_mov_b32 s94, 4259840
  buffer_load_dwordx4 v90, s[88:91], s94 offen lds
  v_mfma_f32_32x32x16_bf16 a[96:111], a[200:203], a[212:215], a[96:111]
  v_mfma_f32_32x32x16_bf16 a[48:63], a[204:207], a[208:211], a[48:63]
  s_add_u32 m0, s93, 101376
  s_mov_b32 s94, 4292608
  buffer_load_dwordx4 v90, s[88:91], s94 offen lds
  v_mfma_f32_32x32x16_bf16 a[112:127], a[204:207], a[212:215], a[112:127]
  s_waitcnt vmcnt(12) lgkmcnt(0)
  s_barrier
  v_mfma_f32_32x32x16_bf16 a[0:15], a[216:219], a[232:235], a[0:15]
  ds_read_b64_tr_b16 a[192:193], v76 offset:0
  ds_read_b64_tr_b16 a[194:195], v76 offset:1024
  ds_read_b64_tr_b16 a[196:197], v77 offset:0
  v_mfma_f32_32x32x16_bf16 a[64:79], a[216:219], a[236:239], a[64:79]
  ds_read_b64_tr_b16 a[198:199], v77 offset:1024
  ds_read_b64_tr_b16 a[200:201], v78 offset:0
  ds_read_b64_tr_b16 a[202:203], v78 offset:1024
  v_mfma_f32_32x32x16_bf16 a[16:31], a[220:223], a[232:235], a[16:31]
  ds_read_b64_tr_b16 a[204:205], v79 offset:0
  ds_read_b64_tr_b16 a[206:207], v79 offset:1024
  ds_read_b128 a[208:211], v72 offset:0
  s_add_u32 m0, s34, 0
  s_nop 0
  buffer_load_dwordx4 v20, s[12:15], s30 offen offset:0 lds
  v_mfma_f32_32x32x16_bf16 a[80:95], a[220:223], a[236:239], a[80:95]
  ds_read_b128 a[212:215], v72 offset:4096
  v_mfma_f32_32x32x16_bf16 a[32:47], a[224:227], a[232:235], a[32:47]
  buffer_load_dwordx4 v21, s[12:15], s30 offen offset:1024 lds
  v_mfma_f32_32x32x16_bf16 a[96:111], a[224:227], a[236:239], a[96:111]
  v_mfma_f32_32x32x16_bf16 a[48:63], a[228:231], a[232:235], a[48:63]
  buffer_load_dwordx4 v22, s[12:15], s30 offen offset:2048 lds
  v_mfma_f32_32x32x16_bf16 a[112:127], a[228:231], a[236:239], a[112:127]
  s_waitcnt lgkmcnt(0)
  v_mfma_f32_32x32x16_bf16 a[0:15], a[192:195], a[208:211], a[0:15]
  ds_read_b64_tr_b16 a[216:217], v76 offset:4096
  ds_read_b64_tr_b16 a[218:219], v76 offset:5120
  ds_read_b64_tr_b16 a[220:221], v77 offset:4096
  v_mfma_f32_32x32x16_bf16 a[64:79], a[192:195], a[212:215], a[64:79]
  ds_read_b64_tr_b16 a[222:223], v77 offset:5120
  ds_read_b64_tr_b16 a[224:225], v78 offset:4096
  ds_read_b64_tr_b16 a[226:227], v78 offset:5120
  v_mfma_f32_32x32x16_bf16 a[16:31], a[196:199], a[208:211], a[16:31]
  ds_read_b64_tr_b16 a[228:229], v79 offset:4096
  ds_read_b64_tr_b16 a[230:231], v79 offset:5120
  ds_read_b128 a[232:235], v73 offset:0
  buffer_load_dwordx4 v23, s[12:15], s30 offen offset:3072 lds
  s_add_u32 s30, s30, 16384
  v_mfma_f32_32x32x16_bf16 a[80:95], a[196:199], a[212:215], a[80:95]
  ds_read_b128 a[236:239], v73 offset:4096
  v_mfma_f32_32x32x16_bf16 a[32:47], a[200:203], a[208:211], a[32:47]
  s_add_u32 m0, s34, 16384
  s_nop 0
  buffer_load_dwordx4 v20, s[12:15], s30 offen offset:0 lds
  v_mfma_f32_32x32x16_bf16 a[96:111], a[200:203], a[212:215], a[96:111]
  v_mfma_f32_32x32x16_bf16 a[48:63], a[204:207], a[208:211], a[48:63]
  buffer_load_dwordx4 v21, s[12:15], s30 offen offset:1024 lds
  v_mfma_f32_32x32x16_bf16 a[112:127], a[204:207], a[212:215], a[112:127]
  s_waitcnt lgkmcnt(0)
  v_mfma_f32_32x32x16_bf16 a[0:15], a[216:219], a[232:235], a[0:15]
  ds_read_b64_tr_b16 a[192:193], v76 offset:8192
  ds_read_b64_tr_b16 a[194:195], v76 offset:9216
  ds_read_b64_tr_b16 a[196:197], v77 offset:8192
  v_mfma_f32_32x32x16_bf16 a[64:79], a[216:219], a[236:239], a[64:79]
  ds_read_b64_tr_b16 a[198:199], v77 offset:9216
  ds_read_b64_tr_b16 a[200:201], v78 offset:8192
  ds_read_b64_tr_b16 a[202:203], v78 offset:9216
  v_mfma_f32_32x32x16_bf16 a[16:31], a[220:223], a[232:235], a[16:31]
  ds_read_b64_tr_b16 a[204:205], v79 offset:8192
  ds_read_b64_tr_b16 a[206:207], v79 offset:9216
  ds_read_b128 a[208:211], v74 offset:0
  buffer_load_dwordx4 v22, s[12:15], s30 offen offset:2048 lds
  v_mfma_f32_32x32x16_bf16 a[80:95], a[220:223], a[236:239], a[80:95]
  ds_read_b128 a[212:215], v74 offset:4096
  v_mfma_f32_32x32x16_bf16 a[32:47], a[224:227], a[232:235], a[32:47]
  buffer_load_dwordx4 v23, s[12:15], s30 offen offset:3072 lds
  s_add_u32 s30, s30, 16384
  v_mfma_f32_32x32x16_bf16 a[96:111], a[224:227], a[236:239], a[96:111]
  v_mfma_f32_32x32x16_bf16 a[48:63], a[228:231], a[232:235], a[48:63]
  s_add_u32 m0, s34, 32768
  s_nop 0
  buffer_load_dwordx4 v20, s[12:15], s30 offen offset:0 lds
  v_mfma_f32_32x32x16_bf16 a[112:127], a[228:231], a[236:239], a[112:127]
  s_waitcnt lgkmcnt(0)
  v_mfma_f32_32x32x16_bf16 a[0:15], a[192:195], a[208:211], a[0:15]
  ds_read_b64_tr_b16 a[216:217], v76 offset:12288
  ds_read_b64_tr_b16 a[218:219], v76 offset:13312
  ds_read_b64_tr_b16 a[220:221], v77 offset:12288
  v_mfma_f32_32x32x16_bf16 a[64:79], a[192:195], a[212:215], a[64:79]
  ds_read_b64_tr_b16 a[222:223], v77 offset:13312
  ds_read_b64_tr_b16 a[224:225], v78 offset:12288
  ds_read_b64_tr_b16 a[226:227], v78 offset:13312
  v_mfma_f32_32x32x16_bf16 a[16:31], a[196:199], a[208:211], a[16:31]
  ds_read_b64_tr_b16 a[228:229], v79 offset:12288
  ds_read_b64_tr_b16 a[230:231], v79 offset:13312
  ds_read_b128 a[232:235], v75 offset:0
  buffer_load_dwordx4 v21, s[12:15], s30 offen offset:1024 lds
  v_mfma_f32_32x32x16_bf16 a[80:95], a[196:199], a[212:215], a[80:95]
  ds_read_b128 a[236:239], v75 offset:4096
  v_mfma_f32_32x32x16_bf16 a[32:47], a[200:203], a[208:211], a[32:47]
  buffer_load_dwordx4 v22, s[12:15], s30 offen offset:2048 lds
  v_mfma_f32_32x32x16_bf16 a[96:111], a[200:203], a[212:215], a[96:111]
  v_mfma_f32_32x32x16_bf16 a[48:63], a[204:207], a[208:211], a[48:63]
  buffer_load_dwordx4 v23, s[12:15], s30 offen offset:3072 lds
  s_add_u32 s30, s30, 16384
  v_mfma_f32_32x32x16_bf16 a[112:127], a[204:207], a[212:215], a[112:127]
  s_waitcnt vmcnt(12) lgkmcnt(0)
  s_barrier
  v_mfma_f32_32x32x16_bf16 a[0:15], a[216:219], a[232:235], a[0:15]
  ds_read_b64_tr_b16 a[192:193], v84 offset:0
  ds_read_b64_tr_b16 a[194:195], v84 offset:1024
  ds_read_b64_tr_b16 a[196:197], v85 offset:0
  v_mfma_f32_32x32x16_bf16 a[64:79], a[216:219], a[236:239], a[64:79]
  ds_read_b64_tr_b16 a[198:199], v85 offset:1024
  ds_read_b64_tr_b16 a[200:201], v86 offset:0
  ds_read_b64_tr_b16 a[202:203], v86 offset:1024
  v_mfma_f32_32x32x16_bf16 a[16:31], a[220:223], a[232:235], a[16:31]
  ds_read_b64_tr_b16 a[204:205], v87 offset:0
  ds_read_b64_tr_b16 a[206:207], v87 offset:1024
  ds_read_b128 a[208:211], v80 offset:0
  s_add_u32 m0, s34, 49152
  s_nop 0
  buffer_load_dwordx4 v20, s[12:15], s30 offen offset:0 lds
  v_mfma_f32_32x32x16_bf16 a[80:95], a[220:223], a[236:239], a[80:95]
  ds_read_b128 a[212:215], v80 offset:4096
  v_mfma_f32_32x32x16_bf16 a[32:47], a[224:227], a[232:235], a[32:47]
  buffer_load_dwordx4 v21, s[12:15], s30 offen offset:1024 lds
  v_mfma_f32_32x32x16_bf16 a[96:111], a[224:227], a[236:239], a[96:111]
  v_mfma_f32_32x32x16_bf16 a[48:63], a[228:231], a[232:235], a[48:63]
  buffer_load_dwordx4 v22, s[12:15], s30 offen offset:2048 lds
  v_mfma_f32_32x32x16_bf16 a[112:127], a[228:231], a[236:239], a[112:127]
  s_waitcnt lgkmcnt(0)
  v_mfma_f32_32x32x16_bf16 a[0:15], a[192:195], a[208:211], a[0:15]
  ds_read_b64_tr_b16 a[216:217], v84 offset:4096
  ds_read_b64_tr_b16 a[218:219], v84 offset:5120
  ds_read_b64_tr_b16 a[220:221], v85 offset:4096
  v_mfma_f32_32x32x16_bf16 a[64:79], a[192:195], a[212:215], a[64:79]
  ds_read_b64_tr_b16 a[222:223], v85 offset:5120
  ds_read_b64_tr_b16 a[224:225], v86 offset:4096
  ds_read_b64_tr_b16 a[226:227], v86 offset:5120
  v_mfma_f32_32x32x16_bf16 a[16:31], a[196:199], a[208:211], a[16:31]
  ds_read_b64_tr_b16 a[228:229], v87 offset:4096
  ds_read_b64_tr_b16 a[230:231], v87 offset:5120
  ds_read_b128 a[232:235], v81 offset:0
  buffer_load_dwordx4 v23, s[12:15], s30 offen offset:3072 lds
  s_add_u32 s30, s30, 16384
  v_mfma_f32_32x32x16_bf16 a[80:95], a[196:199], a[212:215], a[80:95]
  ds_read_b128 a[236:239], v81 offset:4096
  v_mfma_f32_32x32x16_bf16 a[32:47], a[200:203], a[208:211], a[32:47]
  s_add_u32 m0, s34, 65536
  s_nop 0
  buffer_load_dwordx4 v24, s[16:19], s31 offen offset:0 lds
  v_mfma_f32_32x32x16_bf16 a[96:111], a[200:203], a[212:215], a[96:111]
  v_mfma_f32_32x32x16_bf16 a[48:63], a[204:207], a[208:211], a[48:63]
  buffer_load_dwordx4 v24, s[16:19], s31 offen offset:1024 lds
  v_mfma_f32_32x32x16_bf16 a[112:127], a[204:207], a[212:215], a[112:127]
  s_waitcnt lgkmcnt(0)
  v_mfma_f32_32x32x16_bf16 a[0:15], a[216:219], a[232:235], a[0:15]
  ds_read_b64_tr_b16 a[192:193], v84 offset:8192
  ds_read_b64_tr_b16 a[194:195], v84 offset:9216
  ds_read_b64_tr_b16 a[196:197], v85 offset:8192
  v_mfma_f32_32x32x16_bf16 a[64:79], a[216:219], a[236:239], a[64:79]
  ds_read_b64_tr_b16 a[198:199], v85 offset:9216
  ds_read_b64_tr_b16 a[200:201], v86 offset:8192
  ds_read_b64_tr_b16 a[202:203], v86 offset:9216
  v_mfma_f32_32x32x16_bf16 a[16:31], a[220:223], a[232:235], a[16:31]
  ds_read_b64_tr_b16 a[204:205], v87 offset:8192
  ds_read_b64_tr_b16 a[206:207], v87 offset:9216
  ds_read_b128 a[208:211], v82 offset:0
  buffer_load_dwordx4 v24, s[16:19], s31 offen offset:2048 lds
  v_mfma_f32_32x32x16_bf16 a[80:95], a[220:223], a[236:239], a[80:95]
  ds_read_b128 a[212:215], v82 offset:4096
  v_mfma_f32_32x32x16_bf16 a[32:47], a[224:227], a[232:235], a[32:47]
  buffer_load_dwordx4 v24, s[16:19], s31 offen offset:3072 lds
  s_add_u32 s31, s31, 16384
  v_mfma_f32_32x32x16_bf16 a[96:111], a[224:227], a[236:239], a[96:111]
  v_mfma_f32_32x32x16_bf16 a[48:63], a[228:231], a[232:235], a[48:63]
  s_add_u32 m0, s34, 81920
  s_nop 0
  buffer_load_dwordx4 v24, s[16:19], s31 offen offset:0 lds
  v_mfma_f32_32x32x16_bf16 a[112:127], a[228:231], a[236:239], a[112:127]
  s_waitcnt lgkmcnt(0)
  v_mfma_f32_32x32x16_bf16 a[0:15], a[192:195], a[208:211], a[0:15]
  ds_read_b64_tr_b16 a[216:217], v84 offset:12288
  ds_read_b64_tr_b16 a[218:219], v84 offset:13312
  ds_read_b64_tr_b16 a[220:221], v85 offset:12288
  v_mfma_f32_32x32x16_bf16 a[64:79], a[192:195], a[212:215], a[64:79]
  ds_read_b64_tr_b16 a[222:223], v85 offset:13312
  ds_read_b64_tr_b16 a[224:225], v86 offset:12288
  ds_read_b64_tr_b16 a[226:227], v86 offset:13312
  v_mfma_f32_32x32x16_bf16 a[16:31], a[196:199], a[208:211], a[16:31]
  ds_read_b64_tr_b16 a[228:229], v87 offset:12288
  ds_read_b64_tr_b16 a[230:231], v87 offset:13312
  ds_read_b128 a[232:235], v83 offset:0
  buffer_load_dwordx4 v24, s[16:19], s31 offen offset:1024 lds
  v_mfma_f32_32x32x16_bf16 a[80:95], a[196:199], a[212:215], a[80:95]
  ds_read_b128 a[236:239], v83 offset:4096
  v_mfma_f32_32x32x16_bf16 a[32:47], a[200:203], a[208:211], a[32:47]
  buffer_load_dwordx4 v24, s[16:19], s31 offen offset:2048 lds
  v_mfma_f32_32x32x16_bf16 a[96:111], a[200:203], a[212:215], a[96:111]
  v_mfma_f32_32x32x16_bf16 a[48:63], a[204:207], a[208:211], a[48:63]
  buffer_load_dwordx4 v24, s[16:19], s31 offen offset:3072 lds
  s_add_u32 s31, s31, 16384
  v_mfma_f32_32x32x16_bf16 a[112:127], a[204:207], a[212:215], a[112:127]
  s_waitcnt lgkmcnt(0)
  v_mfma_f32_32x32x16_bf16 a[0:15], a[216:219], a[232:235], a[0:15]
  v_mfma_f32_32x32x16_bf16 a[64:79], a[216:219], a[236:239], a[64:79]
  v_mfma_f32_32x32x16_bf16 a[16:31], a[220:223], a[232:235], a[16:31]
  v_mfma_f32_32x32x16_bf16 a[80:95], a[220:223], a[236:239], a[80:95]
  v_mfma_f32_32x32x16_bf16 a[32:47], a[224:227], a[232:235], a[32:47]
  v_mfma_f32_32x32x16_bf16 a[96:111], a[224:227], a[236:239], a[96:111]
  v_mfma_f32_32x32x16_bf16 a[48:63], a[228:231], a[232:235], a[48:63]
  v_mfma_f32_32x32x16_bf16 a[112:127], a[228:231], a[236:239], a[112:127]
  s_nop 15
  v_accvgpr_read_b32 v128, a0
  v_accvgpr_read_b32 v129, a1
  v_accvgpr_read_b32 v130, a2
  v_accvgpr_read_b32 v131, a3
  v_accvgpr_read_b32 v132, a4
  v_accvgpr_read_b32 v133, a5
  v_accvgpr_read_b32 v134, a6
  v_accvgpr_read_b32 v135, a7
  v_accvgpr_read_b32 v136, a8
  v_accvgpr_read_b32 v137, a9
  v_accvgpr_read_b32 v138, a10
  v_accvgpr_read_b32 v139, a11
  v_accvgpr_read_b32 v140, a12
  v_accvgpr_read_b32 v141, a13
  v_accvgpr_read_b32 v142, a14
  v_accvgpr_read_b32 v143, a15
  v_mul_f32 v128, s28, v128
  v_mul_f32 v129, s28, v129
  v_mul_f32 v130, s28, v130
  v_mul_f32 v131, s28, v131
  v_mul_f32 v132, s28, v132
  v_mul_f32 v133, s28, v133
  v_mul_f32 v134, s28, v134
  v_mul_f32 v135, s28, v135
  v_mul_f32 v136, s28, v136
  v_mul_f32 v137, s28, v137
  v_mul_f32 v138, s28, v138
  v_mul_f32 v139, s28, v139
  v_mul_f32 v140, s28, v140
  v_mul_f32 v141, s28, v141
  v_mul_f32 v142, s28, v142
  v_mul_f32 v143, s28, v143
  v_cvt_pk_bf16_f32 v144, v128, v129
  v_cvt_pk_bf16_f32 v145, v130, v131
  v_cvt_pk_bf16_f32 v146, v132, v133
  v_cvt_pk_bf16_f32 v147, v134, v135
  v_cvt_pk_bf16_f32 v148, v136, v137
  v_cvt_pk_bf16_f32 v149, v138, v139
  v_cvt_pk_bf16_f32 v150, v140, v141
  v_cvt_pk_bf16_f32 v151, v142, v143
  s_nop 1
  v_permlane32_swap_b32 v144, v146
  v_permlane32_swap_b32 v145, v147
  v_permlane32_swap_b32 v148, v150
  v_permlane32_swap_b32 v149, v151
  v_accvgpr_write_b32 a128, v144
  v_accvgpr_write_b32 a129, v145
  v_accvgpr_write_b32 a130, v146
  v_accvgpr_write_b32 a131, v147
  v_accvgpr_write_b32 a132, v148
  v_accvgpr_write_b32 a133, v149
  v_accvgpr_write_b32 a134, v150
  v_accvgpr_write_b32 a135, v151
  v_accvgpr_read_b32 v152, a16
  v_accvgpr_read_b32 v153, a17
  v_accvgpr_read_b32 v154, a18
  v_accvgpr_read_b32 v155, a19
  v_accvgpr_read_b32 v156, a20
  v_accvgpr_read_b32 v157, a21
  v_accvgpr_read_b32 v158, a22
  v_accvgpr_read_b32 v159, a23
  v_accvgpr_read_b32 v160, a24
  v_accvgpr_read_b32 v161, a25
  v_accvgpr_read_b32 v162, a26
  v_accvgpr_read_b32 v163, a27
  v_accvgpr_read_b32 v164, a28
  v_accvgpr_read_b32 v165, a29
  v_accvgpr_read_b32 v166, a30
  v_accvgpr_read_b32 v167, a31
  v_mul_f32 v152, s28, v152
  v_mul_f32 v153, s28, v153
  v_mul_f32 v154, s28, v154
  v_mul_f32 v155, s28, v155
  v_mul_f32 v156, s28, v156
  v_mul_f32 v157, s28, v157
  v_mul_f32 v158, s28, v158
  v_mul_f32 v159, s28, v159
  v_mul_f32 v160, s28, v160
  v_mul_f32 v161, s28, v161
  v_mul_f32 v162, s28, v162
  v_mul_f32 v163, s28, v163
  v_mul_f32 v164, s28, v164
  v_mul_f32 v165, s28, v165
  v_mul_f32 v166, s28, v166
  v_mul_f32 v167, s28, v167
  v_cvt_pk_bf16_f32 v168, v152, v153
  v_cvt_pk_bf16_f32 v169, v154, v155
  v_cvt_pk_bf16_f32 v170, v156, v157
  v_cvt_pk_bf16_f32 v171, v158, v159
  v_cvt_pk_bf16_f32 v172, v160, v161
  v_cvt_pk_bf16_f32 v173, v162, v163
  v_cvt_pk_bf16_f32 v174, v164, v165
  v_cvt_pk_bf16_f32 v175, v166, v167
  s_nop 1
  v_permlane32_swap_b32 v168, v170
  v_permlane32_swap_b32 v169, v171
  v_permlane32_swap_b32 v172, v174
  v_permlane32_swap_b32 v173, v175
  v_accvgpr_write_b32 a136, v168
  v_accvgpr_write_b32 a137, v169
  v_accvgpr_write_b32 a138, v170
  v_accvgpr_write_b32 a139, v171
  v_accvgpr_write_b32 a140, v172
  v_accvgpr_write_b32 a141, v173
  v_accvgpr_write_b32 a142, v174
  v_accvgpr_write_b32 a143, v175
  v_accvgpr_read_b32 v128, a32
  v_accvgpr_read_b32 v129, a33
  v_accvgpr_read_b32 v130, a34
  v_accvgpr_read_b32 v131, a35
  v_accvgpr_read_b32 v132, a36
  v_accvgpr_read_b32 v133, a37
  v_accvgpr_read_b32 v134, a38
  v_accvgpr_read_b32 v135, a39
  v_accvgpr_read_b32 v136, a40
  v_accvgpr_read_b32 v137, a41
  v_accvgpr_read_b32 v138, a42
  v_accvgpr_read_b32 v139, a43
  v_accvgpr_read_b32 v140, a44
  v_accvgpr_read_b32 v141, a45
  v_accvgpr_read_b32 v142, a46
  v_accvgpr_read_b32 v143, a47
  v_mul_f32 v128, s28, v128
  v_mul_f32 v129, s28, v129
  v_mul_f32 v130, s28, v130
  v_mul_f32 v131, s28, v131
  v_mul_f32 v132, s28, v132
  v_mul_f32 v133, s28, v133
  v_mul_f32 v134, s28, v134
  v_mul_f32 v135, s28, v135
  v_mul_f32 v136, s28, v136
  v_mul_f32 v137, s28, v137
  v_mul_f32 v138, s28, v138
  v_mul_f32 v139, s28, v139
  v_mul_f32 v140, s28, v140
  v_mul_f32 v141, s28, v141
  v_mul_f32 v142, s28, v142
  v_mul_f32 v143, s28, v143
  v_cvt_pk_bf16_f32 v144, v128, v129
  v_cvt_pk_bf16_f32 v145, v130, v131
  v_cvt_pk_bf16_f32 v146, v132, v133
  v_cvt_pk_bf16_f32 v147, v134, v135
  v_cvt_pk_bf16_f32 v148, v136, v137
  v_cvt_pk_bf16_f32 v149, v138, v139
  v_cvt_pk_bf16_f32 v150, v140, v141
  v_cvt_pk_bf16_f32 v151, v142, v143
  s_nop 1
  v_permlane32_swap_b32 v144, v146
  v_permlane32_swap_b32 v145, v147
  v_permlane32_swap_b32 v148, v150
  v_permlane32_swap_b32 v149, v151
  v_accvgpr_write_b32 a144, v144
  v_accvgpr_write_b32 a145, v145
  v_accvgpr_write_b32 a146, v146
  v_accvgpr_write_b32 a147, v147
  v_accvgpr_write_b32 a148, v148
  v_accvgpr_write_b32 a149, v149
  v_accvgpr_write_b32 a150, v150
  v_accvgpr_write_b32 a151, v151
  v_accvgpr_read_b32 v152, a48
  v_accvgpr_read_b32 v153, a49
  v_accvgpr_read_b32 v154, a50
  v_accvgpr_read_b32 v155, a51
  v_accvgpr_read_b32 v156, a52
  v_accvgpr_read_b32 v157, a53
  v_accvgpr_read_b32 v158, a54
  v_accvgpr_read_b32 v159, a55
  v_accvgpr_read_b32 v160, a56
  v_accvgpr_read_b32 v161, a57
  v_accvgpr_read_b32 v162, a58
  v_accvgpr_read_b32 v163, a59
  v_accvgpr_read_b32 v164, a60
  v_accvgpr_read_b32 v165, a61
  v_accvgpr_read_b32 v166, a62
  v_accvgpr_read_b32 v167, a63
  v_mul_f32 v152, s28, v152
  v_mul_f32 v153, s28, v153
  v_mul_f32 v154, s28, v154
  v_mul_f32 v155, s28, v155
  v_mul_f32 v156, s28, v156
  v_mul_f32 v157, s28, v157
  v_mul_f32 v158, s28, v158
  v_mul_f32 v159, s28, v159
  v_mul_f32 v160, s28, v160
  v_mul_f32 v161, s28, v161
  v_mul_f32 v162, s28, v162
  v_mul_f32 v163, s28, v163
  v_mul_f32 v164, s28, v164
  v_mul_f32 v165, s28, v165
  v_mul_f32 v166, s28, v166
  v_mul_f32 v167, s28, v167
  v_cvt_pk_bf16_f32 v168, v152, v153
  v_cvt_pk_bf16_f32 v169, v154, v155
  v_cvt_pk_bf16_f32 v170, v156, v157
  v_cvt_pk_bf16_f32 v171, v158, v159
  v_cvt_pk_bf16_f32 v172, v160, v161
  v_cvt_pk_bf16_f32 v173, v162, v163
  v_cvt_pk_bf16_f32 v174, v164, v165
  v_cvt_pk_bf16_f32 v175, v166, v167
  s_nop 1
  v_permlane32_swap_b32 v168, v170
  v_permlane32_swap_b32 v169, v171
  v_permlane32_swap_b32 v172, v174
  v_permlane32_swap_b32 v173, v175
  v_accvgpr_write_b32 a152, v168
  v_accvgpr_write_b32 a153, v169
  v_accvgpr_write_b32 a154, v170
  v_accvgpr_write_b32 a155, v171
  v_accvgpr_write_b32 a156, v172
  v_accvgpr_write_b32 a157, v173
  v_accvgpr_write_b32 a158, v174
  v_accvgpr_write_b32 a159, v175
  v_accvgpr_read_b32 v128, a64
  v_accvgpr_read_b32 v129, a65
  v_accvgpr_read_b32 v130, a66
  v_accvgpr_read_b32 v131, a67
  v_accvgpr_read_b32 v132, a68
  v_accvgpr_read_b32 v133, a69
  v_accvgpr_read_b32 v134, a70
  v_accvgpr_read_b32 v135, a71
  v_accvgpr_read_b32 v136, a72
  v_accvgpr_read_b32 v137, a73
  v_accvgpr_read_b32 v138, a74
  v_accvgpr_read_b32 v139, a75
  v_accvgpr_read_b32 v140, a76
  v_accvgpr_read_b32 v141, a77
  v_accvgpr_read_b32 v142, a78
  v_accvgpr_read_b32 v143, a79
  v_mul_f32 v128, s28, v128
  v_mul_f32 v129, s28, v129
  v_mul_f32 v130, s28, v130
  v_mul_f32 v131, s28, v131
  v_mul_f32 v132, s28, v132
  v_mul_f32 v133, s28, v133
  v_mul_f32 v134, s28, v134
  v_mul_f32 v135, s28, v135
  v_mul_f32 v136, s28, v136
  v_mul_f32 v137, s28, v137
  v_mul_f32 v138, s28, v138
  v_mul_f32 v139, s28, v139
  v_mul_f32 v140, s28, v140
  v_mul_f32 v141, s28, v141
  v_mul_f32 v142, s28, v142
  v_mul_f32 v143, s28, v143
  v_cvt_pk_bf16_f32 v144, v128, v129
  v_cvt_pk_bf16_f32 v145, v130, v131
  v_cvt_pk_bf16_f32 v146, v132, v133
  v_cvt_pk_bf16_f32 v147, v134, v135
  v_cvt_pk_bf16_f32 v148, v136, v137
  v_cvt_pk_bf16_f32 v149, v138, v139
  v_cvt_pk_bf16_f32 v150, v140, v141
  v_cvt_pk_bf16_f32 v151, v142, v143
  s_nop 1
  v_permlane32_swap_b32 v144, v146
  v_permlane32_swap_b32 v145, v147
  v_permlane32_swap_b32 v148, v150
  v_permlane32_swap_b32 v149, v151
  v_accvgpr_write_b32 a160, v144
  v_accvgpr_write_b32 a161, v145
  v_accvgpr_write_b32 a162, v146
  v_accvgpr_write_b32 a163, v147
  v_accvgpr_write_b32 a164, v148
  v_accvgpr_write_b32 a165, v149
  v_accvgpr_write_b32 a166, v150
  v_accvgpr_write_b32 a167, v151
  v_accvgpr_read_b32 v152, a80
  v_accvgpr_read_b32 v153, a81
  v_accvgpr_read_b32 v154, a82
  v_accvgpr_read_b32 v155, a83
  v_accvgpr_read_b32 v156, a84
  v_accvgpr_read_b32 v157, a85
  v_accvgpr_read_b32 v158, a86
  v_accvgpr_read_b32 v159, a87
  v_accvgpr_read_b32 v160, a88
  v_accvgpr_read_b32 v161, a89
  v_accvgpr_read_b32 v162, a90
  v_accvgpr_read_b32 v163, a91
  v_accvgpr_read_b32 v164, a92
  v_accvgpr_read_b32 v165, a93
  v_accvgpr_read_b32 v166, a94
  v_accvgpr_read_b32 v167, a95
  v_mul_f32 v152, s28, v152
  v_mul_f32 v153, s28, v153
  v_mul_f32 v154, s28, v154
  v_mul_f32 v155, s28, v155
  v_mul_f32 v156, s28, v156
  v_mul_f32 v157, s28, v157
  v_mul_f32 v158, s28, v158
  v_mul_f32 v159, s28, v159
  v_mul_f32 v160, s28, v160
  v_mul_f32 v161, s28, v161
  v_mul_f32 v162, s28, v162
  v_mul_f32 v163, s28, v163
  v_mul_f32 v164, s28, v164
  v_mul_f32 v165, s28, v165
  v_mul_f32 v166, s28, v166
  v_mul_f32 v167, s28, v167
  v_cvt_pk_bf16_f32 v168, v152, v153
  v_cvt_pk_bf16_f32 v169, v154, v155
  v_cvt_pk_bf16_f32 v170, v156, v157
  v_cvt_pk_bf16_f32 v171, v158, v159
  v_cvt_pk_bf16_f32 v172, v160, v161
  v_cvt_pk_bf16_f32 v173, v162, v163
  v_cvt_pk_bf16_f32 v174, v164, v165
  v_cvt_pk_bf16_f32 v175, v166, v167
  s_nop 1
  v_permlane32_swap_b32 v168, v170
  v_permlane32_swap_b32 v169, v171
  v_permlane32_swap_b32 v172, v174
  v_permlane32_swap_b32 v173, v175
  v_accvgpr_write_b32 a168, v168
  v_accvgpr_write_b32 a169, v169
  v_accvgpr_write_b32 a170, v170
  v_accvgpr_write_b32 a171, v171
  v_accvgpr_write_b32 a172, v172
  v_accvgpr_write_b32 a173, v173
  v_accvgpr_write_b32 a174, v174
  v_accvgpr_write_b32 a175, v175
  v_accvgpr_read_b32 v128, a96
  v_accvgpr_read_b32 v129, a97
  v_accvgpr_read_b32 v130, a98
  v_accvgpr_read_b32 v131, a99
  v_accvgpr_read_b32 v132, a100
  v_accvgpr_read_b32 v133, a101
  v_accvgpr_read_b32 v134, a102
  v_accvgpr_read_b32 v135, a103
  v_accvgpr_read_b32 v136, a104
  v_accvgpr_read_b32 v137, a105
  v_accvgpr_read_b32 v138, a106
  v_accvgpr_read_b32 v139, a107
  v_accvgpr_read_b32 v140, a108
  v_accvgpr_read_b32 v141, a109
  v_accvgpr_read_b32 v142, a110
  v_accvgpr_read_b32 v143, a111
  v_mul_f32 v128, s28, v128
  v_mul_f32 v129, s28, v129
  v_mul_f32 v130, s28, v130
  v_mul_f32 v131, s28, v131
  v_mul_f32 v132, s28, v132
  v_mul_f32 v133, s28, v133
  v_mul_f32 v134, s28, v134
  v_mul_f32 v135, s28, v135
  v_mul_f32 v136, s28, v136
  v_mul_f32 v137, s28, v137
  v_mul_f32 v138, s28, v138
  v_mul_f32 v139, s28, v139
  v_mul_f32 v140, s28, v140
  v_mul_f32 v141, s28, v141
  v_mul_f32 v142, s28, v142
  v_mul_f32 v143, s28, v143
  v_cvt_pk_bf16_f32 v144, v128, v129
  v_cvt_pk_bf16_f32 v145, v130, v131
  v_cvt_pk_bf16_f32 v146, v132, v133
  v_cvt_pk_bf16_f32 v147, v134, v135
  v_cvt_pk_bf16_f32 v148, v136, v137
  v_cvt_pk_bf16_f32 v149, v138, v139
  v_cvt_pk_bf16_f32 v150, v140, v141
  v_cvt_pk_bf16_f32 v151, v142, v143
  s_nop 1
  v_permlane32_swap_b32 v144, v146
  v_permlane32_swap_b32 v145, v147
  v_permlane32_swap_b32 v148, v150
  v_permlane32_swap_b32 v149, v151
  v_accvgpr_write_b32 a176, v144
  v_accvgpr_write_b32 a177, v145
  v_accvgpr_write_b32 a178, v146
  v_accvgpr_write_b32 a179, v147
  v_accvgpr_write_b32 a180, v148
  v_accvgpr_write_b32 a181, v149
  v_accvgpr_write_b32 a182, v150
  v_accvgpr_write_b32 a183, v151
  v_accvgpr_read_b32 v152, a112
  v_accvgpr_read_b32 v153, a113
  v_accvgpr_read_b32 v154, a114
  v_accvgpr_read_b32 v155, a115
  v_accvgpr_read_b32 v156, a116
  v_accvgpr_read_b32 v157, a117
  v_accvgpr_read_b32 v158, a118
  v_accvgpr_read_b32 v159, a119
  v_accvgpr_read_b32 v160, a120
  v_accvgpr_read_b32 v161, a121
  v_accvgpr_read_b32 v162, a122
  v_accvgpr_read_b32 v163, a123
  v_accvgpr_read_b32 v164, a124
  v_accvgpr_read_b32 v165, a125
  v_accvgpr_read_b32 v166, a126
  v_accvgpr_read_b32 v167, a127
  v_mul_f32 v152, s28, v152
  v_mul_f32 v153, s28, v153
  v_mul_f32 v154, s28, v154
  v_mul_f32 v155, s28, v155
  v_mul_f32 v156, s28, v156
  v_mul_f32 v157, s28, v157
  v_mul_f32 v158, s28, v158
  v_mul_f32 v159, s28, v159
  v_mul_f32 v160, s28, v160
  v_mul_f32 v161, s28, v161
  v_mul_f32 v162, s28, v162
  v_mul_f32 v163, s28, v163
  v_mul_f32 v164, s28, v164
  v_mul_f32 v165, s28, v165
  v_mul_f32 v166, s28, v166
  v_mul_f32 v167, s28, v167
  v_cvt_pk_bf16_f32 v168, v152, v153
  v_cvt_pk_bf16_f32 v169, v154, v155
  v_cvt_pk_bf16_f32 v170, v156, v157
  v_cvt_pk_bf16_f32 v171, v158, v159
  v_cvt_pk_bf16_f32 v172, v160, v161
  v_cvt_pk_bf16_f32 v173, v162, v163
  v_cvt_pk_bf16_f32 v174, v164, v165
  v_cvt_pk_bf16_f32 v175, v166, v167
  s_nop 1
  v_permlane32_swap_b32 v168, v170
  v_permlane32_swap_b32 v169, v171
  v_permlane32_swap_b32 v172, v174
  v_permlane32_swap_b32 v173, v175
  v_accvgpr_write_b32 a184, v168
  v_accvgpr_write_b32 a185, v169
  v_accvgpr_write_b32 a186, v170
  v_accvgpr_write_b32 a187, v171
  v_accvgpr_write_b32 a188, v172
  v_accvgpr_write_b32 a189, v173
  v_accvgpr_write_b32 a190, v174
  v_accvgpr_write_b32 a191, v175
  v_accvgpr_write_b32 a0, 0
  v_accvgpr_write_b32 a1, 0
  v_accvgpr_write_b32 a2, 0
  v_accvgpr_write_b32 a3, 0
  v_accvgpr_write_b32 a4, 0
  v_accvgpr_write_b32 a5, 0
  v_accvgpr_write_b32 a6, 0
  v_accvgpr_write_b32 a7, 0
  v_accvgpr_write_b32 a8, 0
  v_accvgpr_write_b32 a9, 0
  v_accvgpr_write_b32 a10, 0
  v_accvgpr_write_b32 a11, 0
  v_accvgpr_write_b32 a12, 0
  v_accvgpr_write_b32 a13, 0
  v_accvgpr_write_b32 a14, 0
  v_accvgpr_write_b32 a15, 0
  v_accvgpr_write_b32 a16, 0
  v_accvgpr_write_b32 a17, 0
  v_accvgpr_write_b32 a18, 0
  v_accvgpr_write_b32 a19, 0
  v_accvgpr_write_b32 a20, 0
  v_accvgpr_write_b32 a21, 0
  v_accvgpr_write_b32 a22, 0
  v_accvgpr_write_b32 a23, 0
  v_accvgpr_write_b32 a24, 0
  v_accvgpr_write_b32 a25, 0
  v_accvgpr_write_b32 a26, 0
  v_accvgpr_write_b32 a27, 0
  v_accvgpr_write_b32 a28, 0
  v_accvgpr_write_b32 a29, 0
  v_accvgpr_write_b32 a30, 0
  v_accvgpr_write_b32 a31, 0
  v_accvgpr_write_b32 a32, 0
  v_accvgpr_write_b32 a33, 0
  v_accvgpr_write_b32 a34, 0
  v_accvgpr_write_b32 a35, 0
  v_accvgpr_write_b32 a36, 0
  v_accvgpr_write_b32 a37, 0
  v_accvgpr_write_b32 a38, 0
  v_accvgpr_write_b32 a39, 0
  v_accvgpr_write_b32 a40, 0
  v_accvgpr_write_b32 a41, 0
  v_accvgpr_write_b32 a42, 0
  v_accvgpr_write_b32 a43, 0
  v_accvgpr_write_b32 a44, 0
  v_accvgpr_write_b32 a45, 0
  v_accvgpr_write_b32 a46, 0
  v_accvgpr_write_b32 a47, 0
  v_accvgpr_write_b32 a48, 0
  v_accvgpr_write_b32 a49, 0
  v_accvgpr_write_b32 a50, 0
  v_accvgpr_write_b32 a51, 0
  v_accvgpr_write_b32 a52, 0
  v_accvgpr_write_b32 a53, 0
  v_accvgpr_write_b32 a54, 0
  v_accvgpr_write_b32 a55, 0
  v_accvgpr_write_b32 a56, 0
  v_accvgpr_write_b32 a57, 0
  v_accvgpr_write_b32 a58, 0
  v_accvgpr_write_b32 a59, 0
  v_accvgpr_write_b32 a60, 0
  v_accvgpr_write_b32 a61, 0
  v_accvgpr_write_b32 a62, 0
  v_accvgpr_write_b32 a63, 0
  v_accvgpr_write_b32 a64, 0
  v_accvgpr_write_b32 a65, 0
  v_accvgpr_write_b32 a66, 0
  v_accvgpr_write_b32 a67, 0
  v_accvgpr_write_b32 a68, 0
  v_accvgpr_write_b32 a69, 0
  v_accvgpr_write_b32 a70, 0
  v_accvgpr_write_b32 a71, 0
  v_accvgpr_write_b32 a72, 0
  v_accvgpr_write_b32 a73, 0
  v_accvgpr_write_b32 a74, 0
  v_accvgpr_write_b32 a75, 0
  v_accvgpr_write_b32 a76, 0
  v_accvgpr_write_b32 a77, 0
  v_accvgpr_write_b32 a78, 0
  v_accvgpr_write_b32 a79, 0
  v_accvgpr_write_b32 a80, 0
  v_accvgpr_write_b32 a81, 0
  v_accvgpr_write_b32 a82, 0
  v_accvgpr_write_b32 a83, 0
  v_accvgpr_write_b32 a84, 0
  v_accvgpr_write_b32 a85, 0
  v_accvgpr_write_b32 a86, 0
  v_accvgpr_write_b32 a87, 0
  v_accvgpr_write_b32 a88, 0
  v_accvgpr_write_b32 a89, 0
  v_accvgpr_write_b32 a90, 0
  v_accvgpr_write_b32 a91, 0
  v_accvgpr_write_b32 a92, 0
  v_accvgpr_write_b32 a93, 0
  v_accvgpr_write_b32 a94, 0
  v_accvgpr_write_b32 a95, 0
  v_accvgpr_write_b32 a96, 0
  v_accvgpr_write_b32 a97, 0
  v_accvgpr_write_b32 a98, 0
  v_accvgpr_write_b32 a99, 0
  v_accvgpr_write_b32 a100, 0
  v_accvgpr_write_b32 a101, 0
  v_accvgpr_write_b32 a102, 0
  v_accvgpr_write_b32 a103, 0
  v_accvgpr_write_b32 a104, 0
  v_accvgpr_write_b32 a105, 0
  v_accvgpr_write_b32 a106, 0
  v_accvgpr_write_b32 a107, 0
  v_accvgpr_write_b32 a108, 0
  v_accvgpr_write_b32 a109, 0
  v_accvgpr_write_b32 a110, 0
  v_accvgpr_write_b32 a111, 0
  v_accvgpr_write_b32 a112, 0
  v_accvgpr_write_b32 a113, 0
  v_accvgpr_write_b32 a114, 0
  v_accvgpr_write_b32 a115, 0
  v_accvgpr_write_b32 a116, 0
  v_accvgpr_write_b32 a117, 0
  v_accvgpr_write_b32 a118, 0
  v_accvgpr_write_b32 a119, 0
  v_accvgpr_write_b32 a120, 0
  v_accvgpr_write_b32 a121, 0
  v_accvgpr_write_b32 a122, 0
  v_accvgpr_write_b32 a123, 0
  v_accvgpr_write_b32 a124, 0
  v_accvgpr_write_b32 a125, 0
  v_accvgpr_write_b32 a126, 0
  v_accvgpr_write_b32 a127, 0
  s_mov_b32 s41, 0
  s_mov_b32 s42, 262144
  s_waitcnt vmcnt(20)
  s_barrier
  ds_read_b128 a[192:195], v8 offset:0
  ds_read_b128 a[196:199], v9 offset:0
  ds_read_b128 a[200:203], v10 offset:0
  ds_read_b128 a[204:207], v11 offset:0
  ds_read_b128 a[208:211], v12 offset:0
  s_waitcnt lgkmcnt(3)
  v_mfma_f32_32x32x16_bf16 v[128:143], a[192:195], a[128:131], 0
  ds_read_b128 a[212:215], v13 offset:0
  v_mfma_f32_32x32x16_bf16 v[160:175], a[192:195], a[160:163], 0
  v_mfma_f32_32x32x16_bf16 v[128:143], a[196:199], a[132:135], v[128:143]
  ds_read_b128 a[216:219], v14 offset:0
  v_mfma_f32_32x32x16_bf16 v[160:175], a[196:199], a[164:167], v[160:175]
  s_waitcnt lgkmcnt(3)
  v_mfma_f32_32x32x16_bf16 v[128:143], a[200:203], a[136:139], v[128:143]
  ds_read_b128 a[220:223], v15 offset:0
  v_mfma_f32_32x32x16_bf16 v[160:175], a[200:203], a[168:171], v[160:175]
  v_mfma_f32_32x32x16_bf16 v[128:143], a[204:207], a[140:143], v[128:143]
  ds_read_b128 a[224:227], v8 offset:8192
  v_mfma_f32_32x32x16_bf16 v[160:175], a[204:207], a[172:175], v[160:175]
  s_waitcnt lgkmcnt(3)
  v_mfma_f32_32x32x16_bf16 v[128:143], a[208:211], a[144:147], v[128:143]
  ds_read_b128 a[228:231], v9 offset:8192
  v_mfma_f32_32x32x16_bf16 v[160:175], a[208:211], a[176:179], v[160:175]
  v_mfma_f32_32x32x16_bf16 v[128:143], a[212:215], a[148:151], v[128:143]
  ds_read_b128 a[232:235], v10 offset:8192
  v_mfma_f32_32x32x16_bf16 v[160:175], a[212:215], a[180:183], v[160:175]
  s_waitcnt lgkmcnt(3)
  v_mfma_f32_32x32x16_bf16 v[128:143], a[216:219], a[152:155], v[128:143]
  ds_read_b128 a[236:239], v11 offset:8192
  v_mfma_f32_32x32x16_bf16 v[160:175], a[216:219], a[184:187], v[160:175]
  v_mfma_f32_32x32x16_bf16 v[128:143], a[220:223], a[156:159], v[128:143]
  ds_read_b128 a[240:243], v12 offset:8192
  v_mfma_f32_32x32x16_bf16 v[160:175], a[220:223], a[188:191], v[160:175]
  s_waitcnt lgkmcnt(3)
  v_mfma_f32_32x32x16_bf16 v[144:159], a[224:227], a[128:131], 0
  ds_read_b128 a[244:247], v13 offset:8192
  v_mfma_f32_32x32x16_bf16 v[176:191], a[224:227], a[160:163], 0
  v_mfma_f32_32x32x16_bf16 v[144:159], a[228:231], a[132:135], v[144:159]
  ds_read_b128 a[248:251], v14 offset:8192
  v_mfma_f32_32x32x16_bf16 v[176:191], a[228:231], a[164:167], v[176:191]
  s_waitcnt lgkmcnt(3)
  v_mfma_f32_32x32x16_bf16 v[144:159], a[232:235], a[136:139], v[144:159]
  ds_read_b128 a[252:255], v15 offset:8192
  v_mfma_f32_32x32x16_bf16 v[176:191], a[232:235], a[168:171], v[176:191]
  v_mfma_f32_32x32x16_bf16 v[144:159], a[236:239], a[140:143], v[144:159]
  v_mfma_f32_32x32x16_bf16 v[176:191], a[236:239], a[172:175], v[176:191]
  s_waitcnt lgkmcnt(2)
  v_mfma_f32_32x32x16_bf16 v[144:159], a[240:243], a[144:147], v[144:159]
  v_mfma_f32_32x32x16_bf16 v[176:191], a[240:243], a[176:179], v[176:191]
  v_mfma_f32_32x32x16_bf16 v[144:159], a[244:247], a[148:151], v[144:159]
  v_mfma_f32_32x32x16_bf16 v[176:191], a[244:247], a[180:183], v[176:191]
  s_waitcnt lgkmcnt(0)
  v_mfma_f32_32x32x16_bf16 v[144:159], a[248:251], a[152:155], v[144:159]
  v_mfma_f32_32x32x16_bf16 v[176:191], a[248:251], a[184:187], v[176:191]
  v_mfma_f32_32x32x16_bf16 v[144:159], a[252:255], a[156:159], v[144:159]
  v_mfma_f32_32x32x16_bf16 v[176:191], a[252:255], a[188:191], v[176:191]
  s_waitcnt vmcnt(4)
  s_barrier
  s_add_u32 m0, s34, 0
  s_nop 0
  buffer_load_dwordx4 v20, s[12:15], s30 offen lds
  buffer_load_dwordx4 v21, s[12:15], s30 offen offset:1024 lds
  s_nop 7
  v_max3_f32 v36, v128, v129, v130
  v_max3_f32 v38, v160, v161, v162
  v_max3_f32 v36, v36, v131, v132
  v_max3_f32 v38, v38, v163, v164
  v_max3_f32 v36, v36, v133, v134
  v_max3_f32 v38, v38, v165, v166
  v_max3_f32 v36, v36, v135, v136
  v_max3_f32 v38, v38, v167, v168
  v_max3_f32 v36, v36, v137, v138
  v_max3_f32 v38, v38, v169, v170
  v_max3_f32 v36, v36, v139, v140
  v_max3_f32 v38, v38, v171, v172
  v_max3_f32 v36, v36, v141, v142
  v_max3_f32 v38, v38, v173, v174
  v_max_f32 v36, v36, v143
  v_max_f32 v38, v38, v175
  v_max3_f32 v37, v144, v145, v146
  v_max3_f32 v39, v176, v177, v178
  v_max3_f32 v37, v37, v147, v148
  v_max3_f32 v39, v39, v179, v180
  v_max3_f32 v37, v37, v149, v150
  v_max3_f32 v39, v39, v181, v182
  v_max3_f32 v37, v37, v151, v152
  v_max3_f32 v39, v39, v183, v184
  v_max3_f32 v37, v37, v153, v154
  v_max3_f32 v39, v39, v185, v186
  v_max3_f32 v37, v37, v155, v156
  v_max3_f32 v39, v39, v187, v188
  v_max3_f32 v37, v37, v157, v158
  v_max3_f32 v39, v39, v189, v190
  v_max_f32 v37, v37, v159
  v_max_f32 v39, v39, v191
  v_max_f32 v34, v36, v37
  v_max_f32 v35, v38, v39
  v_mov_b32 v36, v34
  v_mov_b32 v37, v35
  s_nop 1
  v_permlane32_swap_b32 v34, v36
  v_permlane32_swap_b32 v35, v37
  v_max_f32 v34, v34, v36
  v_max_f32 v35, v35, v37
  v_sub_f32 v128, v128, v34
  v_sub_f32 v129, v129, v34
  v_sub_f32 v130, v130, v34
  v_sub_f32 v131, v131, v34
  v_sub_f32 v132, v132, v34
  v_sub_f32 v133, v133, v34
  v_sub_f32 v134, v134, v34
  v_sub_f32 v135, v135, v34
  v_sub_f32 v136, v136, v34
  v_sub_f32 v137, v137, v34
  v_sub_f32 v138, v138, v34
  v_sub_f32 v139, v139, v34
  v_sub_f32 v140, v140, v34
  v_sub_f32 v141, v141, v34
  v_sub_f32 v142, v142, v34
  v_sub_f32 v143, v143, v34
  v_sub_f32 v144, v144, v34
  v_sub_f32 v145, v145, v34
  v_sub_f32 v146, v146, v34
  v_sub_f32 v147, v147, v34
  v_sub_f32 v148, v148, v34
  v_sub_f32 v149, v149, v34
  v_sub_f32 v150, v150, v34
  v_sub_f32 v151, v151, v34
  v_sub_f32 v152, v152, v34
  v_sub_f32 v153, v153, v34
  v_sub_f32 v154, v154, v34
  v_sub_f32 v155, v155, v34
  v_sub_f32 v156, v156, v34
  v_sub_f32 v157, v157, v34
  v_sub_f32 v158, v158, v34
  v_sub_f32 v159, v159, v34
  v_sub_f32 v96, 0, v34
  v_sub_f32 v97, 0, v34
  v_sub_f32 v98, 0, v34
  v_sub_f32 v99, 0, v34
  v_sub_f32 v100, 0, v34
  v_sub_f32 v101, 0, v34
  v_sub_f32 v102, 0, v34
  v_sub_f32 v103, 0, v34
  v_sub_f32 v104, 0, v34
  v_sub_f32 v105, 0, v34
  v_sub_f32 v106, 0, v34
  v_sub_f32 v107, 0, v34
  v_sub_f32 v108, 0, v34
  v_sub_f32 v109, 0, v34
  v_sub_f32 v110, 0, v34
  v_sub_f32 v111, 0, v34
  v_sub_f32 v160, v160, v35
  v_sub_f32 v161, v161, v35
  v_sub_f32 v162, v162, v35
  v_sub_f32 v163, v163, v35
  v_sub_f32 v164, v164, v35
  v_sub_f32 v165, v165, v35
  v_sub_f32 v166, v166, v35
  v_sub_f32 v167, v167, v35
  v_sub_f32 v168, v168, v35
  v_sub_f32 v169, v169, v35
  v_sub_f32 v170, v170, v35
  v_sub_f32 v171, v171, v35
  v_sub_f32 v172, v172, v35
  v_sub_f32 v173, v173, v35
  v_sub_f32 v174, v174, v35
  v_sub_f32 v175, v175, v35
  v_sub_f32 v176, v176, v35
  v_sub_f32 v177, v177, v35
  v_sub_f32 v178, v178, v35
  v_sub_f32 v179, v179, v35
  v_sub_f32 v180, v180, v35
  v_sub_f32 v181, v181, v35
  v_sub_f32 v182, v182, v35
  v_sub_f32 v183, v183, v35
  v_sub_f32 v184, v184, v35
  v_sub_f32 v185, v185, v35
  v_sub_f32 v186, v186, v35
  v_sub_f32 v187, v187, v35
  v_sub_f32 v188, v188, v35
  v_sub_f32 v189, v189, v35
  v_sub_f32 v190, v190, v35
  v_sub_f32 v191, v191, v35
  v_sub_f32 v112, 0, v35
  v_sub_f32 v113, 0, v35
  v_sub_f32 v114, 0, v35
  v_sub_f32 v115, 0, v35
  v_sub_f32 v116, 0, v35
  v_sub_f32 v117, 0, v35
  v_sub_f32 v118, 0, v35
  v_sub_f32 v119, 0, v35
  v_sub_f32 v120, 0, v35
  v_sub_f32 v121, 0, v35
  v_sub_f32 v122, 0, v35
  v_sub_f32 v123, 0, v35
  v_sub_f32 v124, 0, v35
  v_sub_f32 v125, 0, v35
  v_sub_f32 v126, 0, v35
  v_sub_f32 v127, 0, v35
  v_exp_f32 v128, v128
  v_exp_f32 v129, v129
  v_exp_f32 v130, v130
  v_add_f32 v30, v30, v128
  v_exp_f32 v131, v131
  v_add_f32 v30, v30, v129
  v_cvt_pk_bf16_f32 v128, v128, v129
  v_exp_f32 v132, v132
  v_add_f32 v30, v30, v130
  v_exp_f32 v133, v133
  v_add_f32 v30, v30, v131
  v_cvt_pk_bf16_f32 v129, v130, v131
  v_exp_f32 v134, v134
  v_add_f32 v30, v30, v132
  v_exp_f32 v135, v135
  v_add_f32 v30, v30, v133
  v_cvt_pk_bf16_f32 v130, v132, v133
  v_exp_f32 v160, v160
  v_add_f32 v30, v30, v134
  v_exp_f32 v161, v161
  v_add_f32 v30, v30, v135
  v_cvt_pk_bf16_f32 v131, v134, v135
  v_exp_f32 v162, v162
  v_add_f32 v31, v31, v160
  v_exp_f32 v163, v163
  v_add_f32 v31, v31, v161
  v_cvt_pk_bf16_f32 v160, v160, v161
  v_exp_f32 v164, v164
  v_add_f32 v31, v31, v162
  v_exp_f32 v165, v165
  v_add_f32 v31, v31, v163
  v_cvt_pk_bf16_f32 v161, v162, v163
  v_exp_f32 v166, v166
  v_add_f32 v31, v31, v164
  v_exp_f32 v167, v167
  v_add_f32 v31, v31, v165
  v_cvt_pk_bf16_f32 v162, v164, v165
  v_exp_f32 v136, v136
  v_add_f32 v31, v31, v166
  v_exp_f32 v137, v137
  v_add_f32 v31, v31, v167
  v_cvt_pk_bf16_f32 v163, v166, v167
  v_exp_f32 v138, v138
  v_add_f32 v30, v30, v136
  v_exp_f32 v139, v139
  v_add_f32 v30, v30, v137
  v_cvt_pk_bf16_f32 v136, v136, v137
  v_exp_f32 v140, v140
  v_add_f32 v30, v30, v138
  v_exp_f32 v141, v141
  v_add_f32 v30, v30, v139
  v_cvt_pk_bf16_f32 v137, v138, v139
  v_exp_f32 v142, v142
  v_add_f32 v30, v30, v140
  v_exp_f32 v143, v143
  ds_read_b128 a[192:195], v8 offset:16384
  ds_read_b128 a[196:199], v9 offset:16384
  ds_read_b128 a[200:203], v10 offset:16384
  ds_read_b128 a[204:207], v11 offset:16384
  ds_read_b128 a[208:211], v12 offset:16384
  s_mov_b32 s32, 7
at_loop_5:
  s_waitcnt lgkmcnt(3)
  v_mfma_f32_32x32x16_bf16 v[192:207], a[192:195], a[128:131], v[96:111]
  ds_read_b128 a[212:215], v13 offset:16384
  v_add_f32 v30, v30, v141
  v_cvt_pk_bf16_f32 v138, v140, v141
  v_exp_f32 v168, v168
  v_add_f32 v30, v30, v142
  v_mfma_f32_32x32x16_bf16 v[224:239], a[192:195], a[160:163], v[112:127]
  v_exp_f32 v169, v169
  v_add_f32 v30, v30, v143
  v_cvt_pk_bf16_f32 v139, v142, v143
  v_exp_f32 v170, v170
  v_mfma_f32_32x32x16_bf16 v[192:207], a[196:199], a[132:135], v[192:207]
  ds_read_b128 a[216:219], v14 offset:16384
  v_add_f32 v31, v31, v168
  v_exp_f32 v171, v171
  v_add_f32 v31, v31, v169
  v_mfma_f32_32x32x16_bf16 v[224:239], a[196:199], a[164:167], v[224:239]
  buffer_load_dwordx4 v22, s[12:15], s30 offen offset:2048 lds
  v_cvt_pk_bf16_f32 v168, v168, v169
  s_waitcnt lgkmcnt(3)
  v_mfma_f32_32x32x16_bf16 v[192:207], a[200:203], a[136:139], v[192:207]
  ds_read_b128 a[220:223], v15 offset:16384
  v_exp_f32 v172, v172
  v_add_f32 v31, v31, v170
  v_exp_f32 v173, v173
  v_add_f32 v31, v31, v171
  v_mfma_f32_32x32x16_bf16 v[224:239], a[200:203], a[168:171], v[224:239]
  v_cvt_pk_bf16_f32 v169, v170, v171
  v_exp_f32 v174, v174
  v_add_f32 v31, v31, v172
  v_exp_f32 v175, v175
  v_mfma_f32_32x32x16_bf16 v[192:207], a[204:207], a[140:143], v[192:207]
  ds_read_b128 a[224:227], v8 offset:24576
  v_add_f32 v31, v31, v173
  v_cvt_pk_bf16_f32 v170, v172, v173
  v_exp_f32 v144, v144
  v_mfma_f32_32x32x16_bf16 v[224:239], a[204:207], a[172:175], v[224:239]
  v_add_f32 v31, v31, v174
  v_exp_f32 v145, v145
  v_add_f32 v31, v31, v175
  v_cvt_pk_bf16_f32 v171, v174, v175
  s_waitcnt lgkmcnt(3)
  v_mfma_f32_32x32x16_bf16 v[192:207], a[208:211], a[144:147], v[192:207]
  ds_read_b128 a[228:231], v9 offset:24576
  v_exp_f32 v146, v146
  v_add_f32 v30, v30, v144
  v_exp_f32 v147, v147
  v_mfma_f32_32x32x16_bf16 v[224:239], a[208:211], a[176:179], v[224:239]
  v_add_f32 v30, v30, v145
  v_cvt_pk_bf16_f32 v144, v144, v145
  v_exp_f32 v148, v148
  v_add_f32 v30, v30, v146
  v_exp_f32 v149, v149
  v_mfma_f32_32x32x16_bf16 v[192:207], a[212:215], a[148:151], v[192:207]
  ds_read_b128 a[232:235], v10 offset:24576
  v_add_f32 v30, v30, v147
  v_cvt_pk_bf16_f32 v145, v146, v147
  v_exp_f32 v150, v150
  v_mfma_f32_32x32x16_bf16 v[224:239], a[212:215], a[180:183], v[224:239]
  buffer_load_dwordx4 v23, s[12:15], s30 offen offset:3072 lds
  v_add_f32 v30, v30, v148
  s_waitcnt lgkmcnt(3)
  v_mfma_f32_32x32x16_bf16 v[192:207], a[216:219], a[152:155], v[192:207]
  ds_read_b128 a[236:239], v11 offset:24576
  v_exp_f32 v151, v151
  v_add_f32 v30, v30, v149
  v_cvt_pk_bf16_f32 v146, v148, v149
  v_exp_f32 v176, v176
  v_mfma_f32_32x32x16_bf16 v[224:239], a[216:219], a[184:187], v[224:239]
  v_add_f32 v30, v30, v150
  v_exp_f32 v177, v177
  v_add_f32 v30, v30, v151
  v_cvt_pk_bf16_f32 v147, v150, v151
  v_mfma_f32_32x32x16_bf16 v[192:207], a[220:223], a[156:159], v[192:207]
  ds_read_b128 a[240:243], v12 offset:24576
  v_exp_f32 v178, v178
  v_add_f32 v31, v31, v176
  v_exp_f32 v179, v179
  v_mfma_f32_32x32x16_bf16 v[224:239], a[220:223], a[188:191], v[224:239]
  v_add_f32 v31, v31, v177
  v_cvt_pk_bf16_f32 v176, v176, v177
  v_exp_f32 v180, v180
  v_add_f32 v31, v31, v178
  s_waitcnt lgkmcnt(3)
  v_mfma_f32_32x32x16_bf16 v[208:223], a[224:227], a[128:131], v[96:111]
  ds_read_b128 a[244:247], v13 offset:24576
  v_exp_f32 v181, v181
  v_add_f32 v31, v31, v179
  v_cvt_pk_bf16_f32 v177, v178, v179
  v_exp_f32 v182, v182
  v_mfma_f32_32x32x16_bf16 v[240:255], a[224:227], a[160:163], v[112:127]
  v_add_f32 v31, v31, v180
  v_exp_f32 v183, v183
  v_add_f32 v31, v31, v181
  v_cvt_pk_bf16_f32 v178, v180, v181
  v_mfma_f32_32x32x16_bf16 v[208:223], a[228:231], a[132:135], v[208:223]
  ds_read_b128 a[248:251], v14 offset:24576
  v_exp_f32 v152, v152
  v_add_f32 v31, v31, v182
  v_exp_f32 v153, v153
  v_mfma_f32_32x32x16_bf16 v[240:255], a[228:231], a[164:167], v[240:255]
  s_add_u32 m0, s34, 98304
  s_add_u32 s30, s30, 16384
  buffer_load_dwordx4 v24, s[16:19], s31 offen lds
  s_waitcnt lgkmcnt(3)
  v_mfma_f32_32x32x16_bf16 v[208:223], a[232:235], a[136:139], v[208:223]
  ds_read_b128 a[252:255], v15 offset:24576
  v_add_f32 v31, v31, v183
  v_cvt_pk_bf16_f32 v179, v182, v183
  v_exp_f32 v154, v154
  v_add_f32 v30, v30, v152
  v_mfma_f32_32x32x16_bf16 v[240:255], a[232:235], a[168:171], v[240:255]
  v_exp_f32 v155, v155
  v_add_f32 v30, v30, v153
  v_cvt_pk_bf16_f32 v152, v152, v153
  v_exp_f32 v156, v156
  v_mfma_f32_32x32x16_bf16 v[208:223], a[236:239], a[140:143], v[208:223]
  ds_read_b64_tr_b16 a[192:193], v16 offset:0
  v_add_f32 v30, v30, v154
  v_exp_f32 v157, v157
  v_add_f32 v30, v30, v155
  v_cvt_pk_bf16_f32 v153, v154, v155
  v_mfma_f32_32x32x16_bf16 v[240:255], a[236:239], a[172:175], v[240:255]
  ds_read_b64_tr_b16 a[194:195], v16 offset:2048
  v_exp_f32 v158, v158
  v_add_f32 v30, v30, v156
  v_exp_f32 v159, v159
  s_waitcnt lgkmcnt(4)
  v_mfma_f32_32x32x16_bf16 v[208:223], a[240:243], a[144:147], v[208:223]
  ds_read_b64_tr_b16 a[196:197], v17 offset:0
  v_add_f32 v30, v30, v157
  v_cvt_pk_bf16_f32 v154, v156, v157
  v_exp_f32 v184, v184
  v_mfma_f32_32x32x16_bf16 v[240:255], a[240:243], a[176:179], v[240:255]
  ds_read_b64_tr_b16 a[198:199], v17 offset:2048
  v_add_f32 v30, v30, v158
  v_exp_f32 v185, v185
  v_add_f32 v30, v30, v159
  v_cvt_pk_bf16_f32 v155, v158, v159
  v_mfma_f32_32x32x16_bf16 v[208:223], a[244:247], a[148:151], v[208:223]
  ds_read_b64_tr_b16 a[200:201], v18 offset:0
  v_exp_f32 v186, v186
  v_add_f32 v31, v31, v184
  v_exp_f32 v187, v187
  v_mfma_f32_32x32x16_bf16 v[240:255], a[244:247], a[180:183], v[240:255]
  ds_read_b64_tr_b16 a[202:203], v18 offset:2048
  buffer_load_dwordx4 v24, s[16:19], s31 offen offset:1024 lds
  s_waitcnt lgkmcnt(6)
  v_mfma_f32_32x32x16_bf16 v[208:223], a[248:251], a[152:155], v[208:223]
  ds_read_b64_tr_b16 a[204:205], v19 offset:0
  v_add_f32 v31, v31, v185
  v_cvt_pk_bf16_f32 v184, v184, v185
  v_exp_f32 v188, v188
  v_add_f32 v31, v31, v186
  v_mfma_f32_32x32x16_bf16 v[240:255], a[248:251], a[184:187], v[240:255]
  ds_read_b64_tr_b16 a[206:207], v19 offset:2048
  v_exp_f32 v189, v189
  v_add_f32 v31, v31, v187
  v_cvt_pk_bf16_f32 v185, v186, v187
  v_mfma_f32_32x32x16_bf16 v[208:223], a[252:255], a[156:159], v[208:223]
  ds_read_b64_tr_b16 a[208:209], v16 offset:4096
  v_exp_f32 v190, v190
  v_add_f32 v31, v31, v188
  v_exp_f32 v191, v191
  v_mfma_f32_32x32x16_bf16 v[240:255], a[252:255], a[188:191], v[240:255]
  ds_read_b64_tr_b16 a[210:211], v16 offset:6144
  v_add_f32 v31, v31, v189
  v_cvt_pk_bf16_f32 v186, v188, v189
  v_add_f32 v31, v31, v190
  v_add_f32 v31, v31, v191
  v_cvt_pk_bf16_f32 v187, v190, v191
  s_waitcnt lgkmcnt(6)
  v_mfma_f32_32x32x16_bf16 a[0:15], a[192:195], v[128:131], a[0:15]
  ds_read_b64_tr_b16 a[212:213], v17 offset:4096
  v_max3_f32 v36, v192, v193, v194
  v_max3_f32 v38, v224, v225, v226
  v_max3_f32 v36, v36, v195, v196
  v_max3_f32 v38, v38, v227, v228
  v_mfma_f32_32x32x16_bf16 a[64:79], a[192:195], v[160:163], a[64:79]
  ds_read_b64_tr_b16 a[214:215], v17 offset:6144
  v_max3_f32 v36, v36, v197, v198
  v_max3_f32 v38, v38, v229, v230
  v_max3_f32 v36, v36, v199, v200
  v_max3_f32 v38, v38, v231, v232
  v_mfma_f32_32x32x16_bf16 a[16:31], a[196:199], v[128:131], a[16:31]
  ds_read_b64_tr_b16 a[216:217], v18 offset:4096
  v_max3_f32 v36, v36, v201, v202
  v_max3_f32 v38, v38, v233, v234
  v_max3_f32 v36, v36, v203, v204
  v_max3_f32 v38, v38, v235, v236
  v_max3_f32 v36, v36, v205, v206
  v_mfma_f32_32x32x16_bf16 a[80:95], a[196:199], v[160:163], a[80:95]
  ds_read_b64_tr_b16 a[218:219], v18 offset:6144
  buffer_load_dwordx4 v24, s[16:19], s31 offen offset:2048 lds
  s_waitcnt lgkmcnt(6)
  v_mfma_f32_32x32x16_bf16 a[32:47], a[200:203], v[128:131], a[32:47]
  ds_read_b64_tr_b16 a[220:221], v19 offset:4096
  v_max3_f32 v38, v38, v237, v238
  v_max_f32 v36, v36, v207
  v_max_f32 v38, v38, v239
  v_max3_f32 v37, v208, v209, v210
  v_mfma_f32_32x32x16_bf16 a[96:111], a[200:203], v[160:163], a[96:111]
  ds_read_b64_tr_b16 a[222:223], v19 offset:6144
  v_max3_f32 v39, v240, v241, v242
  v_max3_f32 v37, v37, v211, v212
  v_max3_f32 v39, v39, v243, v244
  v_max3_f32 v37, v37, v213, v214
  v_mfma_f32_32x32x16_bf16 a[48:63], a[204:207], v[128:131], a[48:63]
  ds_read_b64_tr_b16 a[224:225], v16 offset:8192
  v_max3_f32 v39, v39, v245, v246
  v_max3_f32 v37, v37, v215, v216
  v_max3_f32 v39, v39, v247, v248
  v_max3_f32 v37, v37, v217, v218
  v_max3_f32 v39, v39, v249, v250
  v_mfma_f32_32x32x16_bf16 a[112:127], a[204:207], v[160:163], a[112:127]
  ds_read_b64_tr_b16 a[226:227], v16 offset:10240
  v_max3_f32 v37, v37, v219, v220
  v_max3_f32 v39, v39, v251, v252
  v_max3_f32 v37, v37, v221, v222
  v_max3_f32 v39, v39, v253, v254
  s_waitcnt lgkmcnt(6)
  v_mfma_f32_32x32x16_bf16 a[0:15], a[208:211], v[136:139], a[0:15]
  ds_read_b64_tr_b16 a[228:229], v17 offset:8192
  v_max_f32 v37, v37, v223
  v_max_f32 v39, v39, v255
  v_max_f32 v34, v36, v37
  v_max_f32 v35, v38, v39
  v_mfma_f32_32x32x16_bf16 a[64:79], a[208:211], v[168:171], a[64:79]
  ds_read_b64_tr_b16 a[230:231], v17 offset:10240
  v_mov_b32 v36, v34
  v_mov_b32 v37, v35
  s_nop 1
  v_permlane32_swap_b32 v34, v36
  v_permlane32_swap_b32 v35, v37
  v_mfma_f32_32x32x16_bf16 a[16:31], a[212:215], v[136:139], a[16:31]
  ds_read_b64_tr_b16 a[232:233], v18 offset:8192
  v_max_f32 v34, v34, v36
  v_max_f32 v35, v35, v37
  v_max_f32 v36, v34, v35
  v_cmp_lt_f32 vcc, s29, v36
  v_mfma_f32_32x32x16_bf16 a[80:95], a[212:215], v[168:171], a[80:95]
  ds_read_b64_tr_b16 a[234:235], v18 offset:10240
  buffer_load_dwordx4 v24, s[16:19], s31 offen offset:3072 lds
  s_add_u32 s31, s31, 16384
  s_waitcnt lgkmcnt(6)
  v_mfma_f32_32x32x16_bf16 a[32:47], a[216:219], v[136:139], a[32:47]
  ds_read_b64_tr_b16 a[236:237], v19 offset:8192
  s_cbranch_vccnz stub_6
ret_7:
  v_exp_f32 v192, v192
  v_exp_f32 v193, v193
  v_mfma_f32_32x32x16_bf16 a[96:111], a[216:219], v[168:171], a[96:111]
  ds_read_b64_tr_b16 a[238:239], v19 offset:10240
  v_exp_f32 v194, v194
  v_add_f32 v30, v30, v192
  v_mfma_f32_32x32x16_bf16 a[48:63], a[220:223], v[136:139], a[48:63]
  ds_read_b64_tr_b16 a[240:241], v16 offset:12288
  v_exp_f32 v195, v195
  v_add_f32 v30, v30, v193
  v_cvt_pk_bf16_f32 v192, v192, v193
  v_exp_f32 v196, v196
  v_mfma_f32_32x32x16_bf16 a[112:127], a[220:223], v[168:171], a[112:127]
  ds_read_b64_tr_b16 a[242:243], v16 offset:14336
  v_add_f32 v30, v30, v194
  v_exp_f32 v197, v197
  s_waitcnt lgkmcnt(6)
  v_mfma_f32_32x32x16_bf16 a[0:15], a[224:227], v[144:147], a[0:15]
  ds_read_b64_tr_b16 a[244:245], v17 offset:12288
  v_add_f32 v30, v30, v195
  v_cvt_pk_bf16_f32 v193, v194, v195
  v_exp_f32 v198, v198
  v_mfma_f32_32x32x16_bf16 a[64:79], a[224:227], v[176:179], a[64:79]
  ds_read_b64_tr_b16 a[246:247], v17 offset:14336
  s_waitcnt vmcnt(8)
  s_barrier
  v_add_f32 v30, v30, v196
  v_exp_f32 v199, v199
  v_add_f32 v30, v30, v197
  v_mfma_f32_32x32x16_bf16 a[16:31], a[228:231], v[144:147], a[16:31]
  ds_read_b64_tr_b16 a[248:249], v18 offset:12288
  v_cvt_pk_bf16_f32 v194, v196, v197
  v_exp_f32 v224, v224
  v_add_f32 v30, v30, v198
  v_mfma_f32_32x32x16_bf16 a[80:95], a[228:231], v[176:179], a[80:95]
  ds_read_b64_tr_b16 a[250:251], v18 offset:14336
  s_add_u32 m0, s34, 16384
  s_nop 0
  buffer_load_dwordx4 v20, s[12:15], s30 offen lds
  s_waitcnt lgkmcnt(6)
  v_mfma_f32_32x32x16_bf16 a[32:47], a[232:235], v[144:147], a[32:47]
  ds_read_b64_tr_b16 a[252:253], v19 offset:12288
  v_exp_f32 v225, v225
  v_add_f32 v30, v30, v199
  v_mfma_f32_32x32x16_bf16 a[96:111], a[232:235], v[176:179], a[96:111]
  ds_read_b64_tr_b16 a[254:255], v19 offset:14336
  v_cvt_pk_bf16_f32 v195, v198, v199
  v_exp_f32 v226, v226
  v_add_f32 v31, v31, v224
  v_mfma_f32_32x32x16_bf16 a[48:63], a[236:239], v[144:147], a[48:63]
  ds_read_b128 a[192:195], v8 offset:32768
  v_exp_f32 v227, v227
  v_add_f32 v31, v31, v225
  v_cvt_pk_bf16_f32 v224, v224, v225
  v_mfma_f32_32x32x16_bf16 a[112:127], a[236:239], v[176:179], a[112:127]
  v_exp_f32 v228, v228
  v_add_f32 v31, v31, v226
  v_exp_f32 v229, v229
  v_add_f32 v31, v31, v227
  s_waitcnt lgkmcnt(5)
  v_mfma_f32_32x32x16_bf16 a[0:15], a[240:243], v[152:155], a[0:15]
  ds_read_b128 a[196:199], v9 offset:32768
  v_cvt_pk_bf16_f32 v225, v226, v227
  v_exp_f32 v230, v230
  v_add_f32 v31, v31, v228
  v_mfma_f32_32x32x16_bf16 a[64:79], a[240:243], v[184:187], a[64:79]
  v_exp_f32 v231, v231
  v_add_f32 v31, v31, v229
  v_cvt_pk_bf16_f32 v226, v228, v229
  v_exp_f32 v200, v200
  v_mfma_f32_32x32x16_bf16 a[16:31], a[244:247], v[152:155], a[16:31]
  ds_read_b128 a[200:203], v10 offset:32768
  v_add_f32 v31, v31, v230
  v_exp_f32 v201, v201
  v_add_f32 v31, v31, v231
  v_mfma_f32_32x32x16_bf16 a[80:95], a[244:247], v[184:187], a[80:95]
  buffer_load_dwordx4 v21, s[12:15], s30 offen offset:1024 lds
  v_cvt_pk_bf16_f32 v227, v230, v231
  s_waitcnt lgkmcnt(3)
  v_mfma_f32_32x32x16_bf16 a[32:47], a[248:251], v[152:155], a[32:47]
  ds_read_b128 a[204:207], v11 offset:32768
  v_exp_f32 v202, v202
  v_add_f32 v30, v30, v200
  v_exp_f32 v203, v203
  v_mfma_f32_32x32x16_bf16 a[96:111], a[248:251], v[184:187], a[96:111]
  v_add_f32 v30, v30, v201
  v_cvt_pk_bf16_f32 v200, v200, v201
  v_exp_f32 v204, v204
  v_add_f32 v30, v30, v202
  v_mfma_f32_32x32x16_bf16 a[48:63], a[252:255], v[152:155], a[48:63]
  ds_read_b128 a[208:211], v12 offset:32768
  v_exp_f32 v205, v205
  v_add_f32 v30, v30, v203
  v_cvt_pk_bf16_f32 v201, v202, v203
  v_mfma_f32_32x32x16_bf16 a[112:127], a[252:255], v[184:187], a[112:127]
  v_exp_f32 v206, v206
  v_add_f32 v30, v30, v204
  v_exp_f32 v207, v207
  s_cmp_lg_u32 s33, 0
  s_cbranch_scc1 rs_stub_8
rs_ret_9:
  s_waitcnt lgkmcnt(3)
  v_mfma_f32_32x32x16_bf16 v[128:143], a[192:195], a[128:131], v[96:111]
  ds_read_b128 a[212:215], v13 offset:32768
  v_add_f32 v30, v30, v205
  v_cvt_pk_bf16_f32 v202, v204, v205
  v_exp_f32 v232, v232
  v_add_f32 v30, v30, v206
  v_mfma_f32_32x32x16_bf16 v[160:175], a[192:195], a[160:163], v[112:127]
  v_exp_f32 v233, v233
  v_add_f32 v30, v30, v207
  v_cvt_pk_bf16_f32 v203, v206, v207
  v_exp_f32 v234, v234
  v_mfma_f32_32x32x16_bf16 v[128:143], a[196:199], a[132:135], v[128:143]
  ds_read_b128 a[216:219], v14 offset:32768
  v_add_f32 v31, v31, v232
  v_exp_f32 v235, v235
  v_add_f32 v31, v31, v233
  v_mfma_f32_32x32x16_bf16 v[160:175], a[196:199], a[164:167], v[160:175]
  buffer_load_dwordx4 v22, s[12:15], s30 offen offset:2048 lds
  v_cvt_pk_bf16_f32 v232, v232, v233
  s_waitcnt lgkmcnt(3)
  v_mfma_f32_32x32x16_bf16 v[128:143], a[200:203], a[136:139], v[128:143]
  ds_read_b128 a[220:223], v15 offset:32768
  v_exp_f32 v236, v236
  v_add_f32 v31, v31, v234
  v_exp_f32 v237, v237
  v_add_f32 v31, v31, v235
  v_mfma_f32_32x32x16_bf16 v[160:175], a[200:203], a[168:171], v[160:175]
  v_cvt_pk_bf16_f32 v233, v234, v235
  v_exp_f32 v238, v238
  v_add_f32 v31, v31, v236
  v_exp_f32 v239, v239
  v_mfma_f32_32x32x16_bf16 v[128:143], a[204:207], a[140:143], v[128:143]
  ds_read_b128 a[224:227], v8 offset:40960
  v_add_f32 v31, v31, v237
  v_cvt_pk_bf16_f32 v234, v236, v237
  v_exp_f32 v208, v208
  v_mfma_f32_32x32x16_bf16 v[160:175], a[204:207], a[172:175], v[160:175]
  v_add_f32 v31, v31, v238
  v_exp_f32 v209, v209
  v_add_f32 v31, v31, v239
  v_cvt_pk_bf16_f32 v235, v238, v239
  s_waitcnt lgkmcnt(3)
  v_mfma_f32_32x32x16_bf16 v[128:143], a[208:211], a[144:147], v[128:143]
  ds_read_b128 a[228:231], v9 offset:40960
  v_exp_f32 v210, v210
  v_add_f32 v30, v30, v208
  v_exp_f32 v211, v211
  v_mfma_f32_32x32x16_bf16 v[160:175], a[208:211], a[176:179], v[160:175]
  v_add_f32 v30, v30, v209
  v_cvt_pk_bf16_f32 v208, v208, v209
  v_exp_f32 v212, v212
  v_add_f32 v30, v30, v210
  v_exp_f32 v213, v213
  v_mfma_f32_32x32x16_bf16 v[128:143], a[212:215], a[148:151], v[128:143]
  ds_read_b128 a[232:235], v10 offset:40960
  v_add_f32 v30, v30, v211
  v_cvt_pk_bf16_f32 v209, v210, v211
  v_exp_f32 v214, v214
  v_mfma_f32_32x32x16_bf16 v[160:175], a[212:215], a[180:183], v[160:175]
  buffer_load_dwordx4 v23, s[12:15], s30 offen offset:3072 lds
  v_add_f32 v30, v30, v212
  s_waitcnt lgkmcnt(3)
  v_mfma_f32_32x32x16_bf16 v[128:143], a[216:219], a[152:155], v[128:143]
  ds_read_b128 a[236:239], v11 offset:40960
  v_exp_f32 v215, v215
  v_add_f32 v30, v30, v213
  v_cvt_pk_bf16_f32 v210, v212, v213
  v_exp_f32 v240, v240
  v_mfma_f32_32x32x16_bf16 v[160:175], a[216:219], a[184:187], v[160:175]
  v_add_f32 v30, v30, v214
  v_exp_f32 v241, v241
  v_add_f32 v30, v30, v215
  v_cvt_pk_bf16_f32 v211, v214, v215
  v_mfma_f32_32x32x16_bf16 v[128:143], a[220:223], a[156:159], v[128:143]
  ds_read_b128 a[240:243], v12 offset:40960
  v_exp_f32 v242, v242
  v_add_f32 v31, v31, v240
  v_exp_f32 v243, v243
  v_mfma_f32_32x32x16_bf16 v[160:175], a[220:223], a[188:191], v[160:175]
  v_add_f32 v31, v31, v241
  v_cvt_pk_bf16_f32 v240, v240, v241
  v_exp_f32 v244, v244
  v_add_f32 v31, v31, v242
  s_waitcnt lgkmcnt(3)
  v_mfma_f32_32x32x16_bf16 v[144:159], a[224:227], a[128:131], v[96:111]
  ds_read_b128 a[244:247], v13 offset:40960
  v_exp_f32 v245, v245
  v_add_f32 v31, v31, v243
  v_cvt_pk_bf16_f32 v241, v242, v243
  v_exp_f32 v246, v246
  v_mfma_f32_32x32x16_bf16 v[176:191], a[224:227], a[160:163], v[112:127]
  v_add_f32 v31, v31, v244
  v_exp_f32 v247, v247
  v_add_f32 v31, v31, v245
  v_cvt_pk_bf16_f32 v242, v244, v245
  v_mfma_f32_32x32x16_bf16 v[144:159], a[228:231], a[132:135], v[144:159]
  ds_read_b128 a[248:251], v14 offset:40960
  v_exp_f32 v216, v216
  v_add_f32 v31, v31, v246
  v_exp_f32 v217, v217
  v_mfma_f32_32x32x16_bf16 v[176:191], a[228:231], a[164:167], v[176:191]
  s_add_u32 m0, s34, 114688
  s_add_u32 s30, s30, 16384
  buffer_load_dwordx4 v24, s[16:19], s31 offen lds
  s_waitcnt lgkmcnt(3)
  v_mfma_f32_32x32x16_bf16 v[144:159], a[232:235], a[136:139], v[144:159]
  ds_read_b128 a[252:255], v15 offset:40960
  v_add_f32 v31, v31, v247
  v_cvt_pk_bf16_f32 v243, v246, v247
  v_exp_f32 v218, v218
  v_add_f32 v30, v30, v216
  v_mfma_f32_32x32x16_bf16 v[176:191], a[232:235], a[168:171], v[176:191]
  v_exp_f32 v219, v219
  v_add_f32 v30, v30, v217
  v_cvt_pk_bf16_f32 v216, v216, v217
  v_exp_f32 v220, v220
  v_mfma_f32_32x32x16_bf16 v[144:159], a[236:239], a[140:143], v[144:159]
  ds_read_b64_tr_b16 a[192:193], v16 offset:16384
  v_add_f32 v30, v30, v218
  v_exp_f32 v221, v221
  v_add_f32 v30, v30, v219
  v_cvt_pk_bf16_f32 v217, v218, v219
  v_mfma_f32_32x32x16_bf16 v[176:191], a[236:239], a[172:175], v[176:191]
  ds_read_b64_tr_b16 a[194:195], v16 offset:18432
  v_exp_f32 v222, v222
  v_add_f32 v30, v30, v220
  v_exp_f32 v223, v223
  s_waitcnt lgkmcnt(4)
  v_mfma_f32_32x32x16_bf16 v[144:159], a[240:243], a[144:147], v[144:159]
  ds_read_b64_tr_b16 a[196:197], v17 offset:16384
  v_add_f32 v30, v30, v221
  v_cvt_pk_bf16_f32 v218, v220, v221
  v_exp_f32 v248, v248
  v_mfma_f32_32x32x16_bf16 v[176:191], a[240:243], a[176:179], v[176:191]
  ds_read_b64_tr_b16 a[198:199], v17 offset:18432
  v_add_f32 v30, v30, v222
  v_exp_f32 v249, v249
  v_add_f32 v30, v30, v223
  v_cvt_pk_bf16_f32 v219, v222, v223
  v_mfma_f32_32x32x16_bf16 v[144:159], a[244:247], a[148:151], v[144:159]
  ds_read_b64_tr_b16 a[200:201], v18 offset:16384
  v_exp_f32 v250, v250
  v_add_f32 v31, v31, v248
  v_exp_f32 v251, v251
  v_mfma_f32_32x32x16_bf16 v[176:191], a[244:247], a[180:183], v[176:191]
  ds_read_b64_tr_b16 a[202:203], v18 offset:18432
  buffer_load_dwordx4 v24, s[16:19], s31 offen offset:1024 lds
  s_waitcnt lgkmcnt(6)
  v_mfma_f32_32x32x16_bf16 v[144:159], a[248:251], a[152:155], v[144:159]
  ds_read_b64_tr_b16 a[204:205], v19 offset:16384
  v_add_f32 v31, v31, v249
  v_cvt_pk_bf16_f32 v248, v248, v249
  v_exp_f32 v252, v252
  v_add_f32 v31, v31, v250
  v_mfma_f32_32x32x16_bf16 v[176:191], a[248:251], a[184:187], v[176:191]
  ds_read_b64_tr_b16 a[206:207], v19 offset:18432
  v_exp_f32 v253, v253
  v_add_f32 v31, v31, v251
  v_cvt_pk_bf16_f32 v249, v250, v251
  v_mfma_f32_32x32x16_bf16 v[144:159], a[252:255], a[156:159], v[144:159]
  ds_read_b64_tr_b16 a[208:209], v16 offset:20480
  v_exp_f32 v254, v254
  v_add_f32 v31, v31, v252
  v_exp_f32 v255, v255
  v_mfma_f32_32x32x16_bf16 v[176:191], a[252:255], a[188:191], v[176:191]
  ds_read_b64_tr_b16 a[210:211], v16 offset:22528
  v_add_f32 v31, v31, v253
  v_cvt_pk_bf16_f32 v250, v252, v253
  v_add_f32 v31, v31, v254
  v_add_f32 v31, v31, v255
  v_cvt_pk_bf16_f32 v251, v254, v255
  s_waitcnt lgkmcnt(6)
  v_mfma_f32_32x32x16_bf16 a[0:15], a[192:195], v[192:195], a[0:15]
  ds_read_b64_tr_b16 a[212:213], v17 offset:20480
  v_max3_f32 v36, v128, v129, v130
  v_max3_f32 v38, v160, v161, v162
  v_max3_f32 v36, v36, v131, v132
  v_max3_f32 v38, v38, v163, v164
  v_mfma_f32_32x32x16_bf16 a[64:79], a[192:195], v[224:227], a[64:79]
  ds_read_b64_tr_b16 a[214:215], v17 offset:22528
  v_max3_f32 v36, v36, v133, v134
  v_max3_f32 v38, v38, v165, v166
  v_max3_f32 v36, v36, v135, v136
  v_max3_f32 v38, v38, v167, v168
  v_mfma_f32_32x32x16_bf16 a[16:31], a[196:199], v[192:195], a[16:31]
  ds_read_b64_tr_b16 a[216:217], v18 offset:20480
  v_max3_f32 v36, v36, v137, v138
  v_max3_f32 v38, v38, v169, v170
  v_max3_f32 v36, v36, v139, v140
  v_max3_f32 v38, v38, v171, v172
  v_max3_f32 v36, v36, v141, v142
  v_mfma_f32_32x32x16_bf16 a[80:95], a[196:199], v[224:227], a[80:95]
  ds_read_b64_tr_b16 a[218:219], v18 offset:22528
  buffer_load_dwordx4 v24, s[16:19], s31 offen offset:2048 lds
  s_waitcnt lgkmcnt(6)
  v_mfma_f32_32x32x16_bf16 a[32:47], a[200:203], v[192:195], a[32:47]
  ds_read_b64_tr_b16 a[220:221], v19 offset:20480
  v_max3_f32 v38, v38, v173, v174
  v_max_f32 v36, v36, v143
  v_max_f32 v38, v38, v175
  v_max3_f32 v37, v144, v145, v146
  v_mfma_f32_32x32x16_bf16 a[96:111], a[200:203], v[224:227], a[96:111]
  ds_read_b64_tr_b16 a[222:223], v19 offset:22528
  v_max3_f32 v39, v176, v177, v178
  v_max3_f32 v37, v37, v147, v148
  v_max3_f32 v39, v39, v179, v180
  v_max3_f32 v37, v37, v149, v150
  v_mfma_f32_32x32x16_bf16 a[48:63], a[204:207], v[192:195], a[48:63]
  ds_read_b64_tr_b16 a[224:225], v16 offset:24576
  v_max3_f32 v39, v39, v181, v182
  v_max3_f32 v37, v37, v151, v152
  v_max3_f32 v39, v39, v183, v184
  v_max3_f32 v37, v37, v153, v154
  v_max3_f32 v39, v39, v185, v186
  v_mfma_f32_32x32x16_bf16 a[112:127], a[204:207], v[224:227], a[112:127]
  ds_read_b64_tr_b16 a[226:227], v16 offset:26624
  v_max3_f32 v37, v37, v155, v156
  v_max3_f32 v39, v39, v187, v188
  v_max3_f32 v37, v37, v157, v158
  v_max3_f32 v39, v39, v189, v190
  s_waitcnt lgkmcnt(6)
  v_mfma_f32_32x32x16_bf16 a[0:15], a[208:211], v[200:203], a[0:15]
  ds_read_b64_tr_b16 a[228:229], v17 offset:24576
  v_max_f32 v37, v37, v159
  v_max_f32 v39, v39, v191
  v_max_f32 v34, v36, v37
  v_max_f32 v35, v38, v39
  v_mfma_f32_32x32x16_bf16 a[64:79], a[208:211], v[232:235], a[64:79]
  ds_read_b64_tr_b16 a[230:231], v17 offset:26624
  v_mov_b32 v36, v34
  v_mov_b32 v37, v35
  s_nop 1
  v_permlane32_swap_b32 v34, v36
  v_permlane32_swap_b32 v35, v37
  v_mfma_f32_32x32x16_bf16 a[16:31], a[212:215], v[200:203], a[16:31]
  ds_read_b64_tr_b16 a[232:233], v18 offset:24576
  v_max_f32 v34, v34, v36
  v_max_f32 v35, v35, v37
  v_max_f32 v36, v34, v35
  v_cmp_lt_f32 vcc, s29, v36
  v_mfma_f32_32x32x16_bf16 a[80:95], a[212:215], v[232:235], a[80:95]
  ds_read_b64_tr_b16 a[234:235], v18 offset:26624
  buffer_load_dwordx4 v24, s[16:19], s31 offen offset:3072 lds
  s_add_u32 s31, s31, 16384
  s_waitcnt lgkmcnt(6)
  v_mfma_f32_32x32x16_bf16 a[32:47], a[216:219], v[200:203], a[32:47]
  ds_read_b64_tr_b16 a[236:237], v19 offset:24576
  s_cbranch_vccnz stub_10
ret_11:
  v_exp_f32 v128, v128
  v_exp_f32 v129, v129
  v_mfma_f32_32x32x16_bf16 a[96:111], a[216:219], v[232:235], a[96:111]
  ds_read_b64_tr_b16 a[238:239], v19 offset:26624
  v_exp_f32 v130, v130
  v_add_f32 v30, v30, v128
  v_mfma_f32_32x32x16_bf16 a[48:63], a[220:223], v[200:203], a[48:63]
  ds_read_b64_tr_b16 a[240:241], v16 offset:28672
  v_exp_f32 v131, v131
  v_add_f32 v30, v30, v129
  v_cvt_pk_bf16_f32 v128, v128, v129
  v_exp_f32 v132, v132
  v_mfma_f32_32x32x16_bf16 a[112:127], a[220:223], v[232:235], a[112:127]
  ds_read_b64_tr_b16 a[242:243], v16 offset:30720
  v_add_f32 v30, v30, v130
  v_exp_f32 v133, v133
  s_waitcnt lgkmcnt(6)
  v_mfma_f32_32x32x16_bf16 a[0:15], a[224:227], v[208:211], a[0:15]
  ds_read_b64_tr_b16 a[244:245], v17 offset:28672
  v_add_f32 v30, v30, v131
  v_cvt_pk_bf16_f32 v129, v130, v131
  v_exp_f32 v134, v134
  v_mfma_f32_32x32x16_bf16 a[64:79], a[224:227], v[240:243], a[64:79]
  ds_read_b64_tr_b16 a[246:247], v17 offset:30720
  s_waitcnt vmcnt(8)
  s_barrier
  v_add_f32 v30, v30, v132
  v_exp_f32 v135, v135
  v_add_f32 v30, v30, v133
  v_mfma_f32_32x32x16_bf16 a[16:31], a[228:231], v[208:211], a[16:31]
  ds_read_b64_tr_b16 a[248:249], v18 offset:28672
  v_cvt_pk_bf16_f32 v130, v132, v133
  v_exp_f32 v160, v160
  v_add_f32 v30, v30, v134
  v_mfma_f32_32x32x16_bf16 a[80:95], a[228:231], v[240:243], a[80:95]
  ds_read_b64_tr_b16 a[250:251], v18 offset:30720
  s_add_u32 m0, s34, 32768
  s_nop 0
  buffer_load_dwordx4 v20, s[12:15], s30 offen lds
  s_waitcnt lgkmcnt(6)
  v_mfma_f32_32x32x16_bf16 a[32:47], a[232:235], v[208:211], a[32:47]
  ds_read_b64_tr_b16 a[252:253], v19 offset:28672
  v_exp_f32 v161, v161
  v_add_f32 v30, v30, v135
  v_mfma_f32_32x32x16_bf16 a[96:111], a[232:235], v[240:243], a[96:111]
  ds_read_b64_tr_b16 a[254:255], v19 offset:30720
  v_cvt_pk_bf16_f32 v131, v134, v135
  v_exp_f32 v162, v162
  v_add_f32 v31, v31, v160
  v_mfma_f32_32x32x16_bf16 a[48:63], a[236:239], v[208:211], a[48:63]
  ds_read_b128 a[192:195], v8 offset:49152
  v_exp_f32 v163, v163
  v_add_f32 v31, v31, v161
  v_cvt_pk_bf16_f32 v160, v160, v161
  v_mfma_f32_32x32x16_bf16 a[112:127], a[236:239], v[240:243], a[112:127]
  v_exp_f32 v164, v164
  v_add_f32 v31, v31, v162
  v_exp_f32 v165, v165
  v_add_f32 v31, v31, v163
  s_waitcnt lgkmcnt(5)
  v_mfma_f32_32x32x16_bf16 a[0:15], a[240:243], v[216:219], a[0:15]
  ds_read_b128 a[196:199], v9 offset:49152
  v_cvt_pk_bf16_f32 v161, v162, v163
  v_exp_f32 v166, v166
  v_add_f32 v31, v31, v164
  v_mfma_f32_32x32x16_bf16 a[64:79], a[240:243], v[248:251], a[64:79]
  v_exp_f32 v167, v167
  v_add_f32 v31, v31, v165
  v_cvt_pk_bf16_f32 v162, v164, v165
  v_exp_f32 v136, v136
  v_mfma_f32_32x32x16_bf16 a[16:31], a[244:247], v[216:219], a[16:31]
  ds_read_b128 a[200:203], v10 offset:49152
  v_add_f32 v31, v31, v166
  v_exp_f32 v137, v137
  v_add_f32 v31, v31, v167
  v_mfma_f32_32x32x16_bf16 a[80:95], a[244:247], v[248:251], a[80:95]
  buffer_load_dwordx4 v21, s[12:15], s30 offen offset:1024 lds
  v_cvt_pk_bf16_f32 v163, v166, v167
  s_waitcnt lgkmcnt(3)
  v_mfma_f32_32x32x16_bf16 a[32:47], a[248:251], v[216:219], a[32:47]
  ds_read_b128 a[204:207], v11 offset:49152
  v_exp_f32 v138, v138
  v_add_f32 v30, v30, v136
  v_exp_f32 v139, v139
  v_mfma_f32_32x32x16_bf16 a[96:111], a[248:251], v[248:251], a[96:111]
  v_add_f32 v30, v30, v137
  v_cvt_pk_bf16_f32 v136, v136, v137
  v_exp_f32 v140, v140
  v_add_f32 v30, v30, v138
  v_mfma_f32_32x32x16_bf16 a[48:63], a[252:255], v[216:219], a[48:63]
  ds_read_b128 a[208:211], v12 offset:49152
  v_exp_f32 v141, v141
  v_add_f32 v30, v30, v139
  v_cvt_pk_bf16_f32 v137, v138, v139
  v_mfma_f32_32x32x16_bf16 a[112:127], a[252:255], v[248:251], a[112:127]
  v_exp_f32 v142, v142
  v_add_f32 v30, v30, v140
  v_exp_f32 v143, v143
  s_cmp_lg_u32 s33, 0
  s_cbranch_scc1 rs_stub_12
rs_ret_13:
  s_waitcnt lgkmcnt(3)
  v_mfma_f32_32x32x16_bf16 v[192:207], a[192:195], a[128:131], v[96:111]
  ds_read_b128 a[212:215], v13 offset:49152
  v_add_f32 v30, v30, v141
  v_cvt_pk_bf16_f32 v138, v140, v141
  v_exp_f32 v168, v168
  v_add_f32 v30, v30, v142
  v_mfma_f32_32x32x16_bf16 v[224:239], a[192:195], a[160:163], v[112:127]
  v_exp_f32 v169, v169
  v_add_f32 v30, v30, v143
  v_cvt_pk_bf16_f32 v139, v142, v143
  v_exp_f32 v170, v170
  v_mfma_f32_32x32x16_bf16 v[192:207], a[196:199], a[132:135], v[192:207]
  ds_read_b128 a[216:219], v14 offset:49152
  v_add_f32 v31, v31, v168
  v_exp_f32 v171, v171
  v_add_f32 v31, v31, v169
  v_mfma_f32_32x32x16_bf16 v[224:239], a[196:199], a[164:167], v[224:239]
  buffer_load_dwordx4 v22, s[12:15], s30 offen offset:2048 lds
  v_cvt_pk_bf16_f32 v168, v168, v169
  s_waitcnt lgkmcnt(3)
  v_mfma_f32_32x32x16_bf16 v[192:207], a[200:203], a[136:139], v[192:207]
  ds_read_b128 a[220:223], v15 offset:49152
  v_exp_f32 v172, v172
  v_add_f32 v31, v31, v170
  v_exp_f32 v173, v173
  v_add_f32 v31, v31, v171
  v_mfma_f32_32x32x16_bf16 v[224:239], a[200:203], a[168:171], v[224:239]
  v_cvt_pk_bf16_f32 v169, v170, v171
  v_exp_f32 v174, v174
  v_add_f32 v31, v31, v172
  v_exp_f32 v175, v175
  v_mfma_f32_32x32x16_bf16 v[192:207], a[204:207], a[140:143], v[192:207]
  ds_read_b128 a[224:227], v8 offset:57344
  v_add_f32 v31, v31, v173
  v_cvt_pk_bf16_f32 v170, v172, v173
  v_exp_f32 v144, v144
  v_mfma_f32_32x32x16_bf16 v[224:239], a[204:207], a[172:175], v[224:239]
  v_add_f32 v31, v31, v174
  v_exp_f32 v145, v145
  v_add_f32 v31, v31, v175
  v_cvt_pk_bf16_f32 v171, v174, v175
  s_waitcnt lgkmcnt(3)
  v_mfma_f32_32x32x16_bf16 v[192:207], a[208:211], a[144:147], v[192:207]
  ds_read_b128 a[228:231], v9 offset:57344
  v_exp_f32 v146, v146
  v_add_f32 v30, v30, v144
  v_exp_f32 v147, v147
  v_mfma_f32_32x32x16_bf16 v[224:239], a[208:211], a[176:179], v[224:239]
  v_add_f32 v30, v30, v145
  v_cvt_pk_bf16_f32 v144, v144, v145
  v_exp_f32 v148, v148
  v_add_f32 v30, v30, v146
  v_exp_f32 v149, v149
  v_mfma_f32_32x32x16_bf16 v[192:207], a[212:215], a[148:151], v[192:207]
  ds_read_b128 a[232:235], v10 offset:57344
  v_add_f32 v30, v30, v147
  v_cvt_pk_bf16_f32 v145, v146, v147
  v_exp_f32 v150, v150
  v_mfma_f32_32x32x16_bf16 v[224:239], a[212:215], a[180:183], v[224:239]
  buffer_load_dwordx4 v23, s[12:15], s30 offen offset:3072 lds
  v_add_f32 v30, v30, v148
  s_waitcnt lgkmcnt(3)
  v_mfma_f32_32x32x16_bf16 v[192:207], a[216:219], a[152:155], v[192:207]
  ds_read_b128 a[236:239], v11 offset:57344
  v_exp_f32 v151, v151
  v_add_f32 v30, v30, v149
  v_cvt_pk_bf16_f32 v146, v148, v149
  v_exp_f32 v176, v176
  v_mfma_f32_32x32x16_bf16 v[224:239], a[216:219], a[184:187], v[224:239]
  v_add_f32 v30, v30, v150
  v_exp_f32 v177, v177
  v_add_f32 v30, v30, v151
  v_cvt_pk_bf16_f32 v147, v150, v151
  v_mfma_f32_32x32x16_bf16 v[192:207], a[220:223], a[156:159], v[192:207]
  ds_read_b128 a[240:243], v12 offset:57344
  v_exp_f32 v178, v178
  v_add_f32 v31, v31, v176
  v_exp_f32 v179, v179
  v_mfma_f32_32x32x16_bf16 v[224:239], a[220:223], a[188:191], v[224:239]
  v_add_f32 v31, v31, v177
  v_cvt_pk_bf16_f32 v176, v176, v177
  v_exp_f32 v180, v180
  v_add_f32 v31, v31, v178
  s_waitcnt lgkmcnt(3)
  v_mfma_f32_32x32x16_bf16 v[208:223], a[224:227], a[128:131], v[96:111]
  ds_read_b128 a[244:247], v13 offset:57344
  v_exp_f32 v181, v181
  v_add_f32 v31, v31, v179
  v_cvt_pk_bf16_f32 v177, v178, v179
  v_exp_f32 v182, v182
  v_mfma_f32_32x32x16_bf16 v[240:255], a[224:227], a[160:163], v[112:127]
  v_add_f32 v31, v31, v180
  v_exp_f32 v183, v183
  v_add_f32 v31, v31, v181
  v_cvt_pk_bf16_f32 v178, v180, v181
  v_mfma_f32_32x32x16_bf16 v[208:223], a[228:231], a[132:135], v[208:223]
  ds_read_b128 a[248:251], v14 offset:57344
  v_exp_f32 v152, v152
  v_add_f32 v31, v31, v182
  v_exp_f32 v153, v153
  v_mfma_f32_32x32x16_bf16 v[240:255], a[228:231], a[164:167], v[240:255]
  s_add_u32 m0, s34, 65536
  s_add_u32 s30, s30, 16384
  buffer_load_dwordx4 v24, s[16:19], s31 offen lds
  s_waitcnt lgkmcnt(3)
  v_mfma_f32_32x32x16_bf16 v[208:223], a[232:235], a[136:139], v[208:223]
  ds_read_b128 a[252:255], v15 offset:57344
  v_add_f32 v31, v31, v183
  v_cvt_pk_bf16_f32 v179, v182, v183
  v_exp_f32 v154, v154
  v_add_f32 v30, v30, v152
  v_mfma_f32_32x32x16_bf16 v[240:255], a[232:235], a[168:171], v[240:255]
  v_exp_f32 v155, v155
  v_add_f32 v30, v30, v153
  v_cvt_pk_bf16_f32 v152, v152, v153
  v_exp_f32 v156, v156
  v_mfma_f32_32x32x16_bf16 v[208:223], a[236:239], a[140:143], v[208:223]
  ds_read_b64_tr_b16 a[192:193], v16 offset:32768
  v_add_f32 v30, v30, v154
  v_exp_f32 v157, v157
  v_add_f32 v30, v30, v155
  v_cvt_pk_bf16_f32 v153, v154, v155
  v_mfma_f32_32x32x16_bf16 v[240:255], a[236:239], a[172:175], v[240:255]
  ds_read_b64_tr_b16 a[194:195], v16 offset:34816
  v_exp_f32 v158, v158
  v_add_f32 v30, v30, v156
  v_exp_f32 v159, v159
  s_waitcnt lgkmcnt(4)
  v_mfma_f32_32x32x16_bf16 v[208:223], a[240:243], a[144:147], v[208:223]
  ds_read_b64_tr_b16 a[196:197], v17 offset:32768
  v_add_f32 v30, v30, v157
  v_cvt_pk_bf16_f32 v154, v156, v157
  v_exp_f32 v184, v184
  v_mfma_f32_32x32x16_bf16 v[240:255], a[240:243], a[176:179], v[240:255]
  ds_read_b64_tr_b16 a[198:199], v17 offset:34816
  v_add_f32 v30, v30, v158
  v_exp_f32 v185, v185
  v_add_f32 v30, v30, v159
  v_cvt_pk_bf16_f32 v155, v158, v159
  v_mfma_f32_32x32x16_bf16 v[208:223], a[244:247], a[148:151], v[208:223]
  ds_read_b64_tr_b16 a[200:201], v18 offset:32768
  v_exp_f32 v186, v186
  v_add_f32 v31, v31, v184
  v_exp_f32 v187, v187
  v_mfma_f32_32x32x16_bf16 v[240:255], a[244:247], a[180:183], v[240:255]
  ds_read_b64_tr_b16 a[202:203], v18 offset:34816
  buffer_load_dwordx4 v24, s[16:19], s31 offen offset:1024 lds
  s_waitcnt lgkmcnt(6)
  v_mfma_f32_32x32x16_bf16 v[208:223], a[248:251], a[152:155], v[208:223]
  ds_read_b64_tr_b16 a[204:205], v19 offset:32768
  v_add_f32 v31, v31, v185
  v_cvt_pk_bf16_f32 v184, v184, v185
  v_exp_f32 v188, v188
  v_add_f32 v31, v31, v186
  v_mfma_f32_32x32x16_bf16 v[240:255], a[248:251], a[184:187], v[240:255]
  ds_read_b64_tr_b16 a[206:207], v19 offset:34816
  v_exp_f32 v189, v189
  v_add_f32 v31, v31, v187
  v_cvt_pk_bf16_f32 v185, v186, v187
  v_mfma_f32_32x32x16_bf16 v[208:223], a[252:255], a[156:159], v[208:223]
  ds_read_b64_tr_b16 a[208:209], v16 offset:36864
  v_exp_f32 v190, v190
  v_add_f32 v31, v31, v188
  v_exp_f32 v191, v191
  v_mfma_f32_32x32x16_bf16 v[240:255], a[252:255], a[188:191], v[240:255]
  ds_read_b64_tr_b16 a[210:211], v16 offset:38912
  v_add_f32 v31, v31, v189
  v_cvt_pk_bf16_f32 v186, v188, v189
  v_add_f32 v31, v31, v190
  v_add_f32 v31, v31, v191
  v_cvt_pk_bf16_f32 v187, v190, v191
  s_waitcnt lgkmcnt(6)
  v_mfma_f32_32x32x16_bf16 a[0:15], a[192:195], v[128:131], a[0:15]
  ds_read_b64_tr_b16 a[212:213], v17 offset:36864
  v_max3_f32 v36, v192, v193, v194
  v_max3_f32 v38, v224, v225, v226
  v_max3_f32 v36, v36, v195, v196
  v_max3_f32 v38, v38, v227, v228
  v_mfma_f32_32x32x16_bf16 a[64:79], a[192:195], v[160:163], a[64:79]
  ds_read_b64_tr_b16 a[214:215], v17 offset:38912
  v_max3_f32 v36, v36, v197, v198
  v_max3_f32 v38, v38, v229, v230
  v_max3_f32 v36, v36, v199, v200
  v_max3_f32 v38, v38, v231, v232
  v_mfma_f32_32x32x16_bf16 a[16:31], a[196:199], v[128:131], a[16:31]
  ds_read_b64_tr_b16 a[216:217], v18 offset:36864
  v_max3_f32 v36, v36, v201, v202
  v_max3_f32 v38, v38, v233, v234
  v_max3_f32 v36, v36, v203, v204
  v_max3_f32 v38, v38, v235, v236
  v_max3_f32 v36, v36, v205, v206
  v_mfma_f32_32x32x16_bf16 a[80:95], a[196:199], v[160:163], a[80:95]
  ds_read_b64_tr_b16 a[218:219], v18 offset:38912
  buffer_load_dwordx4 v24, s[16:19], s31 offen offset:2048 lds
  s_waitcnt lgkmcnt(6)
  v_mfma_f32_32x32x16_bf16 a[32:47], a[200:203], v[128:131], a[32:47]
  ds_read_b64_tr_b16 a[220:221], v19 offset:36864
  v_max3_f32 v38, v38, v237, v238
  v_max_f32 v36, v36, v207
  v_max_f32 v38, v38, v239
  v_max3_f32 v37, v208, v209, v210
  v_mfma_f32_32x32x16_bf16 a[96:111], a[200:203], v[160:163], a[96:111]
  ds_read_b64_tr_b16 a[222:223], v19 offset:38912
  v_max3_f32 v39, v240, v241, v242
  v_max3_f32 v37, v37, v211, v212
  v_max3_f32 v39, v39, v243, v244
  v_max3_f32 v37, v37, v213, v214
  v_mfma_f32_32x32x16_bf16 a[48:63], a[204:207], v[128:131], a[48:63]
  ds_read_b64_tr_b16 a[224:225], v16 offset:40960
  v_max3_f32 v39, v39, v245, v246
  v_max3_f32 v37, v37, v215, v216
  v_max3_f32 v39, v39, v247, v248
  v_max3_f32 v37, v37, v217, v218
  v_max3_f32 v39, v39, v249, v250
  v_mfma_f32_32x32x16_bf16 a[112:127], a[204:207], v[160:163], a[112:127]
  ds_read_b64_tr_b16 a[226:227], v16 offset:43008
  v_max3_f32 v37, v37, v219, v220
  v_max3_f32 v39, v39, v251, v252
  v_max3_f32 v37, v37, v221, v222
  v_max3_f32 v39, v39, v253, v254
  s_waitcnt lgkmcnt(6)
  v_mfma_f32_32x32x16_bf16 a[0:15], a[208:211], v[136:139], a[0:15]
  ds_read_b64_tr_b16 a[228:229], v17 offset:40960
  v_max_f32 v37, v37, v223
  v_max_f32 v39, v39, v255
  v_max_f32 v34, v36, v37
  v_max_f32 v35, v38, v39
  v_mfma_f32_32x32x16_bf16 a[64:79], a[208:211], v[168:171], a[64:79]
  ds_read_b64_tr_b16 a[230:231], v17 offset:43008
  v_mov_b32 v36, v34
  v_mov_b32 v37, v35
  s_nop 1
  v_permlane32_swap_b32 v34, v36
  v_permlane32_swap_b32 v35, v37
  v_mfma_f32_32x32x16_bf16 a[16:31], a[212:215], v[136:139], a[16:31]
  ds_read_b64_tr_b16 a[232:233], v18 offset:40960
  v_max_f32 v34, v34, v36
  v_max_f32 v35, v35, v37
  v_max_f32 v36, v34, v35
  v_cmp_lt_f32 vcc, s29, v36
  v_mfma_f32_32x32x16_bf16 a[80:95], a[212:215], v[168:171], a[80:95]
  ds_read_b64_tr_b16 a[234:235], v18 offset:43008
  buffer_load_dwordx4 v24, s[16:19], s31 offen offset:3072 lds
  s_add_u32 s31, s31, 16384
  s_waitcnt lgkmcnt(6)
  v_mfma_f32_32x32x16_bf16 a[32:47], a[216:219], v[136:139], a[32:47]
  ds_read_b64_tr_b16 a[236:237], v19 offset:40960
  s_cbranch_vccnz stub_14
ret_15:
  v_exp_f32 v192, v192
  v_exp_f32 v193, v193
  v_mfma_f32_32x32x16_bf16 a[96:111], a[216:219], v[168:171], a[96:111]
  ds_read_b64_tr_b16 a[238:239], v19 offset:43008
  v_exp_f32 v194, v194
  v_add_f32 v30, v30, v192
  v_mfma_f32_32x32x16_bf16 a[48:63], a[220:223], v[136:139], a[48:63]
  ds_read_b64_tr_b16 a[240:241], v16 offset:45056
  v_exp_f32 v195, v195
  v_add_f32 v30, v30, v193
  v_cvt_pk_bf16_f32 v192, v192, v193
  v_exp_f32 v196, v196
  v_mfma_f32_32x32x16_bf16 a[112:127], a[220:223], v[168:171], a[112:127]
  ds_read_b64_tr_b16 a[242:243], v16 offset:47104
  v_add_f32 v30, v30, v194
  v_exp_f32 v197, v197
  s_waitcnt lgkmcnt(6)
  v_mfma_f32_32x32x16_bf16 a[0:15], a[224:227], v[144:147], a[0:15]
  ds_read_b64_tr_b16 a[244:245], v17 offset:45056
  v_add_f32 v30, v30, v195
  v_cvt_pk_bf16_f32 v193, v194, v195
  v_exp_f32 v198, v198
  v_mfma_f32_32x32x16_bf16 a[64:79], a[224:227], v[176:179], a[64:79]
  ds_read_b64_tr_b16 a[246:247], v17 offset:47104
  s_waitcnt vmcnt(8)
  s_barrier
  v_add_f32 v30, v30, v196
  v_exp_f32 v199, v199
  v_add_f32 v30, v30, v197
  v_mfma_f32_32x32x16_bf16 a[16:31], a[228:231], v[144:147], a[16:31]
  ds_read_b64_tr_b16 a[248:249], v18 offset:45056
  v_cvt_pk_bf16_f32 v194, v196, v197
  v_exp_f32 v224, v224
  v_add_f32 v30, v30, v198
  v_mfma_f32_32x32x16_bf16 a[80:95], a[228:231], v[176:179], a[80:95]
  ds_read_b64_tr_b16 a[250:251], v18 offset:47104
  s_add_u32 m0, s34, 49152
  s_nop 0
  buffer_load_dwordx4 v20, s[12:15], s30 offen lds
  s_waitcnt lgkmcnt(6)
  v_mfma_f32_32x32x16_bf16 a[32:47], a[232:235], v[144:147], a[32:47]
  ds_read_b64_tr_b16 a[252:253], v19 offset:45056
  v_exp_f32 v225, v225
  v_add_f32 v30, v30, v199
  v_mfma_f32_32x32x16_bf16 a[96:111], a[232:235], v[176:179], a[96:111]
  ds_read_b64_tr_b16 a[254:255], v19 offset:47104
  v_cvt_pk_bf16_f32 v195, v198, v199
  v_exp_f32 v226, v226
  v_add_f32 v31, v31, v224
  v_mfma_f32_32x32x16_bf16 a[48:63], a[236:239], v[144:147], a[48:63]
  ds_read_b128 a[192:195], v8 offset:0
  v_exp_f32 v227, v227
  v_add_f32 v31, v31, v225
  v_cvt_pk_bf16_f32 v224, v224, v225
  v_mfma_f32_32x32x16_bf16 a[112:127], a[236:239], v[176:179], a[112:127]
  v_exp_f32 v228, v228
  v_add_f32 v31, v31, v226
  v_exp_f32 v229, v229
  v_add_f32 v31, v31, v227
  s_waitcnt lgkmcnt(5)
  v_mfma_f32_32x32x16_bf16 a[0:15], a[240:243], v[152:155], a[0:15]
  ds_read_b128 a[196:199], v9 offset:0
  v_cvt_pk_bf16_f32 v225, v226, v227
  v_exp_f32 v230, v230
  v_add_f32 v31, v31, v228
  v_mfma_f32_32x32x16_bf16 a[64:79], a[240:243], v[184:187], a[64:79]
  v_exp_f32 v231, v231
  v_add_f32 v31, v31, v229
  v_cvt_pk_bf16_f32 v226, v228, v229
  v_exp_f32 v200, v200
  v_mfma_f32_32x32x16_bf16 a[16:31], a[244:247], v[152:155], a[16:31]
  ds_read_b128 a[200:203], v10 offset:0
  v_add_f32 v31, v31, v230
  v_exp_f32 v201, v201
  v_add_f32 v31, v31, v231
  v_mfma_f32_32x32x16_bf16 a[80:95], a[244:247], v[184:187], a[80:95]
  buffer_load_dwordx4 v21, s[12:15], s30 offen offset:1024 lds
  v_cvt_pk_bf16_f32 v227, v230, v231
  s_waitcnt lgkmcnt(3)
  v_mfma_f32_32x32x16_bf16 a[32:47], a[248:251], v[152:155], a[32:47]
  ds_read_b128 a[204:207], v11 offset:0
  v_exp_f32 v202, v202
  v_add_f32 v30, v30, v200
  v_exp_f32 v203, v203
  v_mfma_f32_32x32x16_bf16 a[96:111], a[248:251], v[184:187], a[96:111]
  v_add_f32 v30, v30, v201
  v_cvt_pk_bf16_f32 v200, v200, v201
  v_exp_f32 v204, v204
  v_add_f32 v30, v30, v202
  v_mfma_f32_32x32x16_bf16 a[48:63], a[252:255], v[152:155], a[48:63]
  ds_read_b128 a[208:211], v12 offset:0
  v_exp_f32 v205, v205
  v_add_f32 v30, v30, v203
  v_cvt_pk_bf16_f32 v201, v202, v203
  v_mfma_f32_32x32x16_bf16 a[112:127], a[252:255], v[184:187], a[112:127]
  v_exp_f32 v206, v206
  v_add_f32 v30, v30, v204
  v_exp_f32 v207, v207
  s_cmp_lg_u32 s33, 0
  s_cbranch_scc1 rs_stub_16
rs_ret_17:
  s_waitcnt lgkmcnt(3)
  v_mfma_f32_32x32x16_bf16 v[128:143], a[192:195], a[128:131], v[96:111]
  ds_read_b128 a[212:215], v13 offset:0
  v_add_f32 v30, v30, v205
  v_cvt_pk_bf16_f32 v202, v204, v205
  v_exp_f32 v232, v232
  v_add_f32 v30, v30, v206
  v_mfma_f32_32x32x16_bf16 v[160:175], a[192:195], a[160:163], v[112:127]
  v_exp_f32 v233, v233
  v_add_f32 v30, v30, v207
  v_cvt_pk_bf16_f32 v203, v206, v207
  v_exp_f32 v234, v234
  v_mfma_f32_32x32x16_bf16 v[128:143], a[196:199], a[132:135], v[128:143]
  ds_read_b128 a[216:219], v14 offset:0
  v_add_f32 v31, v31, v232
  v_exp_f32 v235, v235
  v_add_f32 v31, v31, v233
  v_mfma_f32_32x32x16_bf16 v[160:175], a[196:199], a[164:167], v[160:175]
  buffer_load_dwordx4 v22, s[12:15], s30 offen offset:2048 lds
  v_cvt_pk_bf16_f32 v232, v232, v233
  s_waitcnt lgkmcnt(3)
  v_mfma_f32_32x32x16_bf16 v[128:143], a[200:203], a[136:139], v[128:143]
  ds_read_b128 a[220:223], v15 offset:0
  v_exp_f32 v236, v236
  v_add_f32 v31, v31, v234
  v_exp_f32 v237, v237
  v_add_f32 v31, v31, v235
  v_mfma_f32_32x32x16_bf16 v[160:175], a[200:203], a[168:171], v[160:175]
  v_cvt_pk_bf16_f32 v233, v234, v235
  v_exp_f32 v238, v238
  v_add_f32 v31, v31, v236
  v_exp_f32 v239, v239
  v_mfma_f32_32x32x16_bf16 v[128:143], a[204:207], a[140:143], v[128:143]
  ds_read_b128 a[224:227], v8 offset:8192
  v_add_f32 v31, v31, v237
  v_cvt_pk_bf16_f32 v234, v236, v237
  v_exp_f32 v208, v208
  v_mfma_f32_32x32x16_bf16 v[160:175], a[204:207], a[172:175], v[160:175]
  v_add_f32 v31, v31, v238
  v_exp_f32 v209, v209
  v_add_f32 v31, v31, v239
  v_cvt_pk_bf16_f32 v235, v238, v239
  s_waitcnt lgkmcnt(3)
  v_mfma_f32_32x32x16_bf16 v[128:143], a[208:211], a[144:147], v[128:143]
  ds_read_b128 a[228:231], v9 offset:8192
  v_exp_f32 v210, v210
  v_add_f32 v30, v30, v208
  v_exp_f32 v211, v211
  v_mfma_f32_32x32x16_bf16 v[160:175], a[208:211], a[176:179], v[160:175]
  v_add_f32 v30, v30, v209
  v_cvt_pk_bf16_f32 v208, v208, v209
  v_exp_f32 v212, v212
  v_add_f32 v30, v30, v210
  v_exp_f32 v213, v213
  v_mfma_f32_32x32x16_bf16 v[128:143], a[212:215], a[148:151], v[128:143]
  ds_read_b128 a[232:235], v10 offset:8192
  v_add_f32 v30, v30, v211
  v_cvt_pk_bf16_f32 v209, v210, v211
  v_exp_f32 v214, v214
  v_mfma_f32_32x32x16_bf16 v[160:175], a[212:215], a[180:183], v[160:175]
  buffer_load_dwordx4 v23, s[12:15], s30 offen offset:3072 lds
  v_add_f32 v30, v30, v212
  s_waitcnt lgkmcnt(3)
  v_mfma_f32_32x32x16_bf16 v[128:143], a[216:219], a[152:155], v[128:143]
  ds_read_b128 a[236:239], v11 offset:8192
  v_exp_f32 v215, v215
  v_add_f32 v30, v30, v213
  v_cvt_pk_bf16_f32 v210, v212, v213
  v_exp_f32 v240, v240
  v_mfma_f32_32x32x16_bf16 v[160:175], a[216:219], a[184:187], v[160:175]
  v_add_f32 v30, v30, v214
  v_exp_f32 v241, v241
  v_add_f32 v30, v30, v215
  v_cvt_pk_bf16_f32 v211, v214, v215
  v_mfma_f32_32x32x16_bf16 v[128:143], a[220:223], a[156:159], v[128:143]
  ds_read_b128 a[240:243], v12 offset:8192
  v_exp_f32 v242, v242
  v_add_f32 v31, v31, v240
  v_exp_f32 v243, v243
  v_mfma_f32_32x32x16_bf16 v[160:175], a[220:223], a[188:191], v[160:175]
  v_add_f32 v31, v31, v241
  v_cvt_pk_bf16_f32 v240, v240, v241
  v_exp_f32 v244, v244
  v_add_f32 v31, v31, v242
  s_waitcnt lgkmcnt(3)
  v_mfma_f32_32x32x16_bf16 v[144:159], a[224:227], a[128:131], v[96:111]
  ds_read_b128 a[244:247], v13 offset:8192
  v_exp_f32 v245, v245
  v_add_f32 v31, v31, v243
  v_cvt_pk_bf16_f32 v241, v242, v243
  v_exp_f32 v246, v246
  v_mfma_f32_32x32x16_bf16 v[176:191], a[224:227], a[160:163], v[112:127]
  v_add_f32 v31, v31, v244
  v_exp_f32 v247, v247
  v_add_f32 v31, v31, v245
  v_cvt_pk_bf16_f32 v242, v244, v245
  v_mfma_f32_32x32x16_bf16 v[144:159], a[228:231], a[132:135], v[144:159]
  ds_read_b128 a[248:251], v14 offset:8192
  v_exp_f32 v216, v216
  v_add_f32 v31, v31, v246
  v_exp_f32 v217, v217
  v_mfma_f32_32x32x16_bf16 v[176:191], a[228:231], a[164:167], v[176:191]
  s_add_u32 m0, s34, 81920
  s_add_u32 s30, s30, 16384
  buffer_load_dwordx4 v24, s[16:19], s31 offen lds
  s_waitcnt lgkmcnt(3)
  v_mfma_f32_32x32x16_bf16 v[144:159], a[232:235], a[136:139], v[144:159]
  ds_read_b128 a[252:255], v15 offset:8192
  v_add_f32 v31, v31, v247
  v_cvt_pk_bf16_f32 v243, v246, v247
  v_exp_f32 v218, v218
  v_add_f32 v30, v30, v216
  v_mfma_f32_32x32x16_bf16 v[176:191], a[232:235], a[168:171], v[176:191]
  v_exp_f32 v219, v219
  v_add_f32 v30, v30, v217
  v_cvt_pk_bf16_f32 v216, v216, v217
  v_exp_f32 v220, v220
  v_mfma_f32_32x32x16_bf16 v[144:159], a[236:239], a[140:143], v[144:159]
  ds_read_b64_tr_b16 a[192:193], v16 offset:49152
  v_add_f32 v30, v30, v218
  v_exp_f32 v221, v221
  v_add_f32 v30, v30, v219
  v_cvt_pk_bf16_f32 v217, v218, v219
  v_mfma_f32_32x32x16_bf16 v[176:191], a[236:239], a[172:175], v[176:191]
  ds_read_b64_tr_b16 a[194:195], v16 offset:51200
  v_exp_f32 v222, v222
  v_add_f32 v30, v30, v220
  v_exp_f32 v223, v223
  s_waitcnt lgkmcnt(4)
  v_mfma_f32_32x32x16_bf16 v[144:159], a[240:243], a[144:147], v[144:159]
  ds_read_b64_tr_b16 a[196:197], v17 offset:49152
  v_add_f32 v30, v30, v221
  v_cvt_pk_bf16_f32 v218, v220, v221
  v_exp_f32 v248, v248
  v_mfma_f32_32x32x16_bf16 v[176:191], a[240:243], a[176:179], v[176:191]
  ds_read_b64_tr_b16 a[198:199], v17 offset:51200
  v_add_f32 v30, v30, v222
  v_exp_f32 v249, v249
  v_add_f32 v30, v30, v223
  v_cvt_pk_bf16_f32 v219, v222, v223
  v_mfma_f32_32x32x16_bf16 v[144:159], a[244:247], a[148:151], v[144:159]
  ds_read_b64_tr_b16 a[200:201], v18 offset:49152
  v_exp_f32 v250, v250
  v_add_f32 v31, v31, v248
  v_exp_f32 v251, v251
  v_mfma_f32_32x32x16_bf16 v[176:191], a[244:247], a[180:183], v[176:191]
  ds_read_b64_tr_b16 a[202:203], v18 offset:51200
  buffer_load_dwordx4 v24, s[16:19], s31 offen offset:1024 lds
  s_waitcnt lgkmcnt(6)
  v_mfma_f32_32x32x16_bf16 v[144:159], a[248:251], a[152:155], v[144:159]
  ds_read_b64_tr_b16 a[204:205], v19 offset:49152
  v_add_f32 v31, v31, v249
  v_cvt_pk_bf16_f32 v248, v248, v249
  v_exp_f32 v252, v252
  v_add_f32 v31, v31, v250
  v_mfma_f32_32x32x16_bf16 v[176:191], a[248:251], a[184:187], v[176:191]
  ds_read_b64_tr_b16 a[206:207], v19 offset:51200
  v_exp_f32 v253, v253
  v_add_f32 v31, v31, v251
  v_cvt_pk_bf16_f32 v249, v250, v251
  v_mfma_f32_32x32x16_bf16 v[144:159], a[252:255], a[156:159], v[144:159]
  ds_read_b64_tr_b16 a[208:209], v16 offset:53248
  v_exp_f32 v254, v254
  v_add_f32 v31, v31, v252
  v_exp_f32 v255, v255
  v_mfma_f32_32x32x16_bf16 v[176:191], a[252:255], a[188:191], v[176:191]
  ds_read_b64_tr_b16 a[210:211], v16 offset:55296
  v_add_f32 v31, v31, v253
  v_cvt_pk_bf16_f32 v250, v252, v253
  v_add_f32 v31, v31, v254
  v_add_f32 v31, v31, v255
  v_cvt_pk_bf16_f32 v251, v254, v255
  s_waitcnt lgkmcnt(6)
  v_mfma_f32_32x32x16_bf16 a[0:15], a[192:195], v[192:195], a[0:15]
  ds_read_b64_tr_b16 a[212:213], v17 offset:53248
  v_max3_f32 v36, v128, v129, v130
  v_max3_f32 v38, v160, v161, v162
  v_max3_f32 v36, v36, v131, v132
  v_max3_f32 v38, v38, v163, v164
  v_mfma_f32_32x32x16_bf16 a[64:79], a[192:195], v[224:227], a[64:79]
  ds_read_b64_tr_b16 a[214:215], v17 offset:55296
  v_max3_f32 v36, v36, v133, v134
  v_max3_f32 v38, v38, v165, v166
  v_max3_f32 v36, v36, v135, v136
  v_max3_f32 v38, v38, v167, v168
  v_mfma_f32_32x32x16_bf16 a[16:31], a[196:199], v[192:195], a[16:31]
  ds_read_b64_tr_b16 a[216:217], v18 offset:53248
  v_max3_f32 v36, v36, v137, v138
  v_max3_f32 v38, v38, v169, v170
  v_max3_f32 v36, v36, v139, v140
  v_max3_f32 v38, v38, v171, v172
  v_max3_f32 v36, v36, v141, v142
  v_mfma_f32_32x32x16_bf16 a[80:95], a[196:199], v[224:227], a[80:95]
  ds_read_b64_tr_b16 a[218:219], v18 offset:55296
  buffer_load_dwordx4 v24, s[16:19], s31 offen offset:2048 lds
  s_waitcnt lgkmcnt(6)
  v_mfma_f32_32x32x16_bf16 a[32:47], a[200:203], v[192:195], a[32:47]
  ds_read_b64_tr_b16 a[220:221], v19 offset:53248
  v_max3_f32 v38, v38, v173, v174
  v_max_f32 v36, v36, v143
  v_max_f32 v38, v38, v175
  v_max3_f32 v37, v144, v145, v146
  v_mfma_f32_32x32x16_bf16 a[96:111], a[200:203], v[224:227], a[96:111]
  ds_read_b64_tr_b16 a[222:223], v19 offset:55296
  v_max3_f32 v39, v176, v177, v178
  v_max3_f32 v37, v37, v147, v148
  v_max3_f32 v39, v39, v179, v180
  v_max3_f32 v37, v37, v149, v150
  v_mfma_f32_32x32x16_bf16 a[48:63], a[204:207], v[192:195], a[48:63]
  ds_read_b64_tr_b16 a[224:225], v16 offset:57344
  v_max3_f32 v39, v39, v181, v182
  v_max3_f32 v37, v37, v151, v152
  v_max3_f32 v39, v39, v183, v184
  v_max3_f32 v37, v37, v153, v154
  v_max3_f32 v39, v39, v185, v186
  v_mfma_f32_32x32x16_bf16 a[112:127], a[204:207], v[224:227], a[112:127]
  ds_read_b64_tr_b16 a[226:227], v16 offset:59392
  v_max3_f32 v37, v37, v155, v156
  v_max3_f32 v39, v39, v187, v188
  v_max3_f32 v37, v37, v157, v158
  v_max3_f32 v39, v39, v189, v190
  s_waitcnt lgkmcnt(6)
  v_mfma_f32_32x32x16_bf16 a[0:15], a[208:211], v[200:203], a[0:15]
  ds_read_b64_tr_b16 a[228:229], v17 offset:57344
  v_max_f32 v37, v37, v159
  v_max_f32 v39, v39, v191
  v_max_f32 v34, v36, v37
  v_max_f32 v35, v38, v39
  v_mfma_f32_32x32x16_bf16 a[64:79], a[208:211], v[232:235], a[64:79]
  ds_read_b64_tr_b16 a[230:231], v17 offset:59392
  v_mov_b32 v36, v34
  v_mov_b32 v37, v35
  s_nop 1
  v_permlane32_swap_b32 v34, v36
  v_permlane32_swap_b32 v35, v37
  v_mfma_f32_32x32x16_bf16 a[16:31], a[212:215], v[200:203], a[16:31]
  ds_read_b64_tr_b16 a[232:233], v18 offset:57344
  v_max_f32 v34, v34, v36
  v_max_f32 v35, v35, v37
  v_max_f32 v36, v34, v35
  v_cmp_lt_f32 vcc, s29, v36
  v_mfma_f32_32x32x16_bf16 a[80:95], a[212:215], v[232:235], a[80:95]
  ds_read_b64_tr_b16 a[234:235], v18 offset:59392
  buffer_load_dwordx4 v24, s[16:19], s31 offen offset:3072 lds
  s_add_u32 s31, s31, 16384
  s_waitcnt lgkmcnt(6)
  v_mfma_f32_32x32x16_bf16 a[32:47], a[216:219], v[200:203], a[32:47]
  ds_read_b64_tr_b16 a[236:237], v19 offset:57344
  s_cbranch_vccnz stub_18
ret_19:
  v_exp_f32 v128, v128
  v_exp_f32 v129, v129
  v_mfma_f32_32x32x16_bf16 a[96:111], a[216:219], v[232:235], a[96:111]
  ds_read_b64_tr_b16 a[238:239], v19 offset:59392
  v_exp_f32 v130, v130
  v_add_f32 v30, v30, v128
  v_mfma_f32_32x32x16_bf16 a[48:63], a[220:223], v[200:203], a[48:63]
  ds_read_b64_tr_b16 a[240:241], v16 offset:61440
  v_exp_f32 v131, v131
  v_add_f32 v30, v30, v129
  v_cvt_pk_bf16_f32 v128, v128, v129
  v_exp_f32 v132, v132
  v_mfma_f32_32x32x16_bf16 a[112:127], a[220:223], v[232:235], a[112:127]
  ds_read_b64_tr_b16 a[242:243], v16 offset:63488
  v_add_f32 v30, v30, v130
  v_exp_f32 v133, v133
  s_waitcnt lgkmcnt(6)
  v_mfma_f32_32x32x16_bf16 a[0:15], a[224:227], v[208:211], a[0:15]
  ds_read_b64_tr_b16 a[244:245], v17 offset:61440
  v_add_f32 v30, v30, v131
  v_cvt_pk_bf16_f32 v129, v130, v131
  v_exp_f32 v134, v134
  v_mfma_f32_32x32x16_bf16 a[64:79], a[224:227], v[240:243], a[64:79]
  ds_read_b64_tr_b16 a[246:247], v17 offset:63488
  s_waitcnt vmcnt(8)
  s_barrier
  v_add_f32 v30, v30, v132
  v_exp_f32 v135, v135
  v_add_f32 v30, v30, v133
  v_mfma_f32_32x32x16_bf16 a[16:31], a[228:231], v[208:211], a[16:31]
  ds_read_b64_tr_b16 a[248:249], v18 offset:61440
  v_cvt_pk_bf16_f32 v130, v132, v133
  v_exp_f32 v160, v160
  v_add_f32 v30, v30, v134
  v_mfma_f32_32x32x16_bf16 a[80:95], a[228:231], v[240:243], a[80:95]
  ds_read_b64_tr_b16 a[250:251], v18 offset:63488
  s_add_u32 m0, s34, 0
  s_nop 0
  buffer_load_dwordx4 v20, s[12:15], s30 offen lds
  s_waitcnt lgkmcnt(6)
  v_mfma_f32_32x32x16_bf16 a[32:47], a[232:235], v[208:211], a[32:47]
  ds_read_b64_tr_b16 a[252:253], v19 offset:61440
  v_exp_f32 v161, v161
  v_add_f32 v30, v30, v135
  v_mfma_f32_32x32x16_bf16 a[96:111], a[232:235], v[240:243], a[96:111]
  ds_read_b64_tr_b16 a[254:255], v19 offset:63488
  v_cvt_pk_bf16_f32 v131, v134, v135
  v_exp_f32 v162, v162
  v_add_f32 v31, v31, v160
  v_mfma_f32_32x32x16_bf16 a[48:63], a[236:239], v[208:211], a[48:63]
  ds_read_b128 a[192:195], v8 offset:16384
  v_exp_f32 v163, v163
  v_add_f32 v31, v31, v161
  v_cvt_pk_bf16_f32 v160, v160, v161
  v_mfma_f32_32x32x16_bf16 a[112:127], a[236:239], v[240:243], a[112:127]
  v_exp_f32 v164, v164
  v_add_f32 v31, v31, v162
  v_exp_f32 v165, v165
  v_add_f32 v31, v31, v163
  s_waitcnt lgkmcnt(5)
  v_mfma_f32_32x32x16_bf16 a[0:15], a[240:243], v[216:219], a[0:15]
  ds_read_b128 a[196:199], v9 offset:16384
  v_cvt_pk_bf16_f32 v161, v162, v163
  v_exp_f32 v166, v166
  v_add_f32 v31, v31, v164
  v_mfma_f32_32x32x16_bf16 a[64:79], a[240:243], v[248:251], a[64:79]
  v_exp_f32 v167, v167
  v_add_f32 v31, v31, v165
  v_cvt_pk_bf16_f32 v162, v164, v165
  v_exp_f32 v136, v136
  v_mfma_f32_32x32x16_bf16 a[16:31], a[244:247], v[216:219], a[16:31]
  ds_read_b128 a[200:203], v10 offset:16384
  v_add_f32 v31, v31, v166
  v_exp_f32 v137, v137
  v_add_f32 v31, v31, v167
  v_mfma_f32_32x32x16_bf16 a[80:95], a[244:247], v[248:251], a[80:95]
  buffer_load_dwordx4 v21, s[12:15], s30 offen offset:1024 lds
  v_cvt_pk_bf16_f32 v163, v166, v167
  s_waitcnt lgkmcnt(3)
  v_mfma_f32_32x32x16_bf16 a[32:47], a[248:251], v[216:219], a[32:47]
  ds_read_b128 a[204:207], v11 offset:16384
  v_exp_f32 v138, v138
  v_add_f32 v30, v30, v136
  v_exp_f32 v139, v139
  v_mfma_f32_32x32x16_bf16 a[96:111], a[248:251], v[248:251], a[96:111]
  v_add_f32 v30, v30, v137
  v_cvt_pk_bf16_f32 v136, v136, v137
  v_exp_f32 v140, v140
  v_add_f32 v30, v30, v138
  v_mfma_f32_32x32x16_bf16 a[48:63], a[252:255], v[216:219], a[48:63]
  ds_read_b128 a[208:211], v12 offset:16384
  v_exp_f32 v141, v141
  v_add_f32 v30, v30, v139
  v_cvt_pk_bf16_f32 v137, v138, v139
  v_mfma_f32_32x32x16_bf16 a[112:127], a[252:255], v[248:251], a[112:127]
  v_exp_f32 v142, v142
  v_add_f32 v30, v30, v140
  v_exp_f32 v143, v143
  s_cmp_lg_u32 s33, 0
  s_cbranch_scc1 rs_stub_20
rs_ret_21:
  s_sub_u32 s32, s32, 1
  s_cmp_lg_u32 s32, 0
  s_cbranch_scc1 at_loop_5
  s_waitcnt lgkmcnt(3)
  v_mfma_f32_32x32x16_bf16 v[192:207], a[192:195], a[128:131], v[96:111]
  ds_read_b128 a[212:215], v13 offset:16384
  v_add_f32 v30, v30, v141
  v_cvt_pk_bf16_f32 v138, v140, v141
  v_exp_f32 v168, v168
  v_add_f32 v30, v30, v142
  v_mfma_f32_32x32x16_bf16 v[224:239], a[192:195], a[160:163], v[112:127]
  v_exp_f32 v169, v169
  v_add_f32 v30, v30, v143
  v_cvt_pk_bf16_f32 v139, v142, v143
  v_exp_f32 v170, v170
  v_mfma_f32_32x32x16_bf16 v[192:207], a[196:199], a[132:135], v[192:207]
  ds_read_b128 a[216:219], v14 offset:16384
  v_add_f32 v31, v31, v168
  v_exp_f32 v171, v171
  v_add_f32 v31, v31, v169
  v_mfma_f32_32x32x16_bf16 v[224:239], a[196:199], a[164:167], v[224:239]
  buffer_load_dwordx4 v22, s[12:15], s30 offen offset:2048 lds
  v_cvt_pk_bf16_f32 v168, v168, v169
  s_waitcnt lgkmcnt(3)
  v_mfma_f32_32x32x16_bf16 v[192:207], a[200:203], a[136:139], v[192:207]
  ds_read_b128 a[220:223], v15 offset:16384
  v_exp_f32 v172, v172
  v_add_f32 v31, v31, v170
  v_exp_f32 v173, v173
  v_add_f32 v31, v31, v171
  v_mfma_f32_32x32x16_bf16 v[224:239], a[200:203], a[168:171], v[224:239]
  v_cvt_pk_bf16_f32 v169, v170, v171
  v_exp_f32 v174, v174
  v_add_f32 v31, v31, v172
  v_exp_f32 v175, v175
  v_mfma_f32_32x32x16_bf16 v[192:207], a[204:207], a[140:143], v[192:207]
  ds_read_b128 a[224:227], v8 offset:24576
  v_add_f32 v31, v31, v173
  v_cvt_pk_bf16_f32 v170, v172, v173
  v_exp_f32 v144, v144
  v_mfma_f32_32x32x16_bf16 v[224:239], a[204:207], a[172:175], v[224:239]
  v_add_f32 v31, v31, v174
  v_exp_f32 v145, v145
  v_add_f32 v31, v31, v175
  v_cvt_pk_bf16_f32 v171, v174, v175
  s_waitcnt lgkmcnt(3)
  v_mfma_f32_32x32x16_bf16 v[192:207], a[208:211], a[144:147], v[192:207]
  ds_read_b128 a[228:231], v9 offset:24576
  v_exp_f32 v146, v146
  v_add_f32 v30, v30, v144
  v_exp_f32 v147, v147
  v_mfma_f32_32x32x16_bf16 v[224:239], a[208:211], a[176:179], v[224:239]
  v_add_f32 v30, v30, v145
  v_cvt_pk_bf16_f32 v144, v144, v145
  v_exp_f32 v148, v148
  v_add_f32 v30, v30, v146
  v_exp_f32 v149, v149
  v_mfma_f32_32x32x16_bf16 v[192:207], a[212:215], a[148:151], v[192:207]
  ds_read_b128 a[232:235], v10 offset:24576
  v_add_f32 v30, v30, v147
  v_cvt_pk_bf16_f32 v145, v146, v147
  v_exp_f32 v150, v150
  v_mfma_f32_32x32x16_bf16 v[224:239], a[212:215], a[180:183], v[224:239]
  buffer_load_dwordx4 v23, s[12:15], s30 offen offset:3072 lds
  v_add_f32 v30, v30, v148
  s_waitcnt lgkmcnt(3)
  v_mfma_f32_32x32x16_bf16 v[192:207], a[216:219], a[152:155], v[192:207]
  ds_read_b128 a[236:239], v11 offset:24576
  v_exp_f32 v151, v151
  v_add_f32 v30, v30, v149
  v_cvt_pk_bf16_f32 v146, v148, v149
  v_exp_f32 v176, v176
  v_mfma_f32_32x32x16_bf16 v[224:239], a[216:219], a[184:187], v[224:239]
  v_add_f32 v30, v30, v150
  v_exp_f32 v177, v177
  v_add_f32 v30, v30, v151
  v_cvt_pk_bf16_f32 v147, v150, v151
  v_mfma_f32_32x32x16_bf16 v[192:207], a[220:223], a[156:159], v[192:207]
  ds_read_b128 a[240:243], v12 offset:24576
  v_exp_f32 v178, v178
  v_add_f32 v31, v31, v176
  v_exp_f32 v179, v179
  v_mfma_f32_32x32x16_bf16 v[224:239], a[220:223], a[188:191], v[224:239]
  v_add_f32 v31, v31, v177
  v_cvt_pk_bf16_f32 v176, v176, v177
  v_exp_f32 v180, v180
  v_add_f32 v31, v31, v178
  s_waitcnt lgkmcnt(3)
  v_mfma_f32_32x32x16_bf16 v[208:223], a[224:227], a[128:131], v[96:111]
  ds_read_b128 a[244:247], v13 offset:24576
  v_exp_f32 v181, v181
  v_add_f32 v31, v31, v179
  v_cvt_pk_bf16_f32 v177, v178, v179
  v_exp_f32 v182, v182
  v_mfma_f32_32x32x16_bf16 v[240:255], a[224:227], a[160:163], v[112:127]
  v_add_f32 v31, v31, v180
  v_exp_f32 v183, v183
  v_add_f32 v31, v31, v181
  v_cvt_pk_bf16_f32 v178, v180, v181
  v_mfma_f32_32x32x16_bf16 v[208:223], a[228:231], a[132:135], v[208:223]
  ds_read_b128 a[248:251], v14 offset:24576
  v_exp_f32 v152, v152
  v_add_f32 v31, v31, v182
  v_exp_f32 v153, v153
  v_mfma_f32_32x32x16_bf16 v[240:255], a[228:231], a[164:167], v[240:255]
  s_add_u32 m0, s34, 98304
  s_add_u32 s30, s30, 16384
  buffer_load_dwordx4 v24, s[16:19], s31 offen lds
  s_waitcnt lgkmcnt(3)
  v_mfma_f32_32x32x16_bf16 v[208:223], a[232:235], a[136:139], v[208:223]
  ds_read_b128 a[252:255], v15 offset:24576
  v_add_f32 v31, v31, v183
  v_cvt_pk_bf16_f32 v179, v182, v183
  v_exp_f32 v154, v154
  v_add_f32 v30, v30, v152
  v_mfma_f32_32x32x16_bf16 v[240:255], a[232:235], a[168:171], v[240:255]
  v_exp_f32 v155, v155
  v_add_f32 v30, v30, v153
  v_cvt_pk_bf16_f32 v152, v152, v153
  v_exp_f32 v156, v156
  v_mfma_f32_32x32x16_bf16 v[208:223], a[236:239], a[140:143], v[208:223]
  ds_read_b64_tr_b16 a[192:193], v16 offset:0
  v_add_f32 v30, v30, v154
  v_exp_f32 v157, v157
  v_add_f32 v30, v30, v155
  v_cvt_pk_bf16_f32 v153, v154, v155
  v_mfma_f32_32x32x16_bf16 v[240:255], a[236:239], a[172:175], v[240:255]
  ds_read_b64_tr_b16 a[194:195], v16 offset:2048
  v_exp_f32 v158, v158
  v_add_f32 v30, v30, v156
  v_exp_f32 v159, v159
  s_waitcnt lgkmcnt(4)
  v_mfma_f32_32x32x16_bf16 v[208:223], a[240:243], a[144:147], v[208:223]
  ds_read_b64_tr_b16 a[196:197], v17 offset:0
  v_add_f32 v30, v30, v157
  v_cvt_pk_bf16_f32 v154, v156, v157
  v_exp_f32 v184, v184
  v_mfma_f32_32x32x16_bf16 v[240:255], a[240:243], a[176:179], v[240:255]
  ds_read_b64_tr_b16 a[198:199], v17 offset:2048
  v_add_f32 v30, v30, v158
  v_exp_f32 v185, v185
  v_add_f32 v30, v30, v159
  v_cvt_pk_bf16_f32 v155, v158, v159
  v_mfma_f32_32x32x16_bf16 v[208:223], a[244:247], a[148:151], v[208:223]
  ds_read_b64_tr_b16 a[200:201], v18 offset:0
  v_exp_f32 v186, v186
  v_add_f32 v31, v31, v184
  v_exp_f32 v187, v187
  v_mfma_f32_32x32x16_bf16 v[240:255], a[244:247], a[180:183], v[240:255]
  ds_read_b64_tr_b16 a[202:203], v18 offset:2048
  buffer_load_dwordx4 v24, s[16:19], s31 offen offset:1024 lds
  s_waitcnt lgkmcnt(6)
  v_mfma_f32_32x32x16_bf16 v[208:223], a[248:251], a[152:155], v[208:223]
  ds_read_b64_tr_b16 a[204:205], v19 offset:0
  v_add_f32 v31, v31, v185
  v_cvt_pk_bf16_f32 v184, v184, v185
  v_exp_f32 v188, v188
  v_add_f32 v31, v31, v186
  v_mfma_f32_32x32x16_bf16 v[240:255], a[248:251], a[184:187], v[240:255]
  ds_read_b64_tr_b16 a[206:207], v19 offset:2048
  v_exp_f32 v189, v189
  v_add_f32 v31, v31, v187
  v_cvt_pk_bf16_f32 v185, v186, v187
  v_mfma_f32_32x32x16_bf16 v[208:223], a[252:255], a[156:159], v[208:223]
  ds_read_b64_tr_b16 a[208:209], v16 offset:4096
  v_exp_f32 v190, v190
  v_add_f32 v31, v31, v188
  v_exp_f32 v191, v191
  v_mfma_f32_32x32x16_bf16 v[240:255], a[252:255], a[188:191], v[240:255]
  ds_read_b64_tr_b16 a[210:211], v16 offset:6144
  v_add_f32 v31, v31, v189
  v_cvt_pk_bf16_f32 v186, v188, v189
  v_add_f32 v31, v31, v190
  v_add_f32 v31, v31, v191
  v_cvt_pk_bf16_f32 v187, v190, v191
  s_waitcnt lgkmcnt(6)
  v_mfma_f32_32x32x16_bf16 a[0:15], a[192:195], v[128:131], a[0:15]
  ds_read_b64_tr_b16 a[212:213], v17 offset:4096
  v_max3_f32 v36, v192, v193, v194
  v_max3_f32 v38, v224, v225, v226
  v_max3_f32 v36, v36, v195, v196
  v_max3_f32 v38, v38, v227, v228
  v_mfma_f32_32x32x16_bf16 a[64:79], a[192:195], v[160:163], a[64:79]
  ds_read_b64_tr_b16 a[214:215], v17 offset:6144
  v_max3_f32 v36, v36, v197, v198
  v_max3_f32 v38, v38, v229, v230
  v_max3_f32 v36, v36, v199, v200
  v_max3_f32 v38, v38, v231, v232
  v_max3_f32 v36, v36, v201, v202
  v_mfma_f32_32x32x16_bf16 a[16:31], a[196:199], v[128:131], a[16:31]
  ds_read_b64_tr_b16 a[216:217], v18 offset:4096
  v_max3_f32 v38, v38, v233, v234
  v_max3_f32 v36, v36, v203, v204
  v_max3_f32 v38, v38, v235, v236
  v_max3_f32 v36, v36, v205, v206
  v_mfma_f32_32x32x16_bf16 a[80:95], a[196:199], v[160:163], a[80:95]
  ds_read_b64_tr_b16 a[218:219], v18 offset:6144
  buffer_load_dwordx4 v24, s[16:19], s31 offen offset:2048 lds
  s_waitcnt lgkmcnt(6)
  v_mfma_f32_32x32x16_bf16 a[32:47], a[200:203], v[128:131], a[32:47]
  ds_read_b64_tr_b16 a[220:221], v19 offset:4096
  v_max3_f32 v38, v38, v237, v238
  v_max_f32 v36, v36, v207
  v_max_f32 v38, v38, v239
  v_max3_f32 v37, v208, v209, v210
  v_mfma_f32_32x32x16_bf16 a[96:111], a[200:203], v[160:163], a[96:111]
  ds_read_b64_tr_b16 a[222:223], v19 offset:6144
  v_max3_f32 v39, v240, v241, v242
  v_max3_f32 v37, v37, v211, v212
  v_max3_f32 v39, v39, v243, v244
  v_max3_f32 v37, v37, v213, v214
  v_max3_f32 v39, v39, v245, v246
  v_mfma_f32_32x32x16_bf16 a[48:63], a[204:207], v[128:131], a[48:63]
  ds_read_b64_tr_b16 a[224:225], v16 offset:8192
  v_max3_f32 v37, v37, v215, v216
  v_max3_f32 v39, v39, v247, v248
  v_max3_f32 v37, v37, v217, v218
  v_max3_f32 v39, v39, v249, v250
  v_mfma_f32_32x32x16_bf16 a[112:127], a[204:207], v[160:163], a[112:127]
  ds_read_b64_tr_b16 a[226:227], v16 offset:10240
  v_max3_f32 v37, v37, v219, v220
  v_max3_f32 v39, v39, v251, v252
  v_max3_f32 v37, v37, v221, v222
  v_max3_f32 v39, v39, v253, v254
  s_waitcnt lgkmcnt(6)
  v_mfma_f32_32x32x16_bf16 a[0:15], a[208:211], v[136:139], a[0:15]
  ds_read_b64_tr_b16 a[228:229], v17 offset:8192
  v_max_f32 v37, v37, v223
  v_max_f32 v39, v39, v255
  v_max_f32 v34, v36, v37
  v_max_f32 v35, v38, v39
  v_mfma_f32_32x32x16_bf16 a[64:79], a[208:211], v[168:171], a[64:79]
  ds_read_b64_tr_b16 a[230:231], v17 offset:10240
  v_mov_b32 v36, v34
  v_mov_b32 v37, v35
  s_nop 1
  v_permlane32_swap_b32 v34, v36
  v_permlane32_swap_b32 v35, v37
  v_mfma_f32_32x32x16_bf16 a[16:31], a[212:215], v[136:139], a[16:31]
  ds_read_b64_tr_b16 a[232:233], v18 offset:8192
  v_max_f32 v34, v34, v36
  v_max_f32 v35, v35, v37
  v_max_f32 v36, v34, v35
  v_cmp_lt_f32 vcc, s29, v36
  s_cbranch_vccnz stub_22
ret_23:
  v_mfma_f32_32x32x16_bf16 a[80:95], a[212:215], v[168:171], a[80:95]
  ds_read_b64_tr_b16 a[234:235], v18 offset:10240
  buffer_load_dwordx4 v24, s[16:19], s31 offen offset:3072 lds
  s_add_u32 s31, s31, 16384
  s_waitcnt lgkmcnt(6)
  v_mfma_f32_32x32x16_bf16 a[32:47], a[216:219], v[136:139], a[32:47]
  ds_read_b64_tr_b16 a[236:237], v19 offset:8192
  v_exp_f32 v192, v192
  v_exp_f32 v193, v193
  v_mfma_f32_32x32x16_bf16 a[96:111], a[216:219], v[168:171], a[96:111]
  ds_read_b64_tr_b16 a[238:239], v19 offset:10240
  v_exp_f32 v194, v194
  v_add_f32 v30, v30, v192
  v_exp_f32 v195, v195
  v_mfma_f32_32x32x16_bf16 a[48:63], a[220:223], v[136:139], a[48:63]
  ds_read_b64_tr_b16 a[240:241], v16 offset:12288
  v_add_f32 v30, v30, v193
  v_cvt_pk_bf16_f32 v192, v192, v193
  v_exp_f32 v196, v196
  v_mfma_f32_32x32x16_bf16 a[112:127], a[220:223], v[168:171], a[112:127]
  ds_read_b64_tr_b16 a[242:243], v16 offset:14336
  v_add_f32 v30, v30, v194
  v_exp_f32 v197, v197
  v_add_f32 v30, v30, v195
  s_waitcnt lgkmcnt(6)
  v_mfma_f32_32x32x16_bf16 a[0:15], a[224:227], v[144:147], a[0:15]
  ds_read_b64_tr_b16 a[244:245], v17 offset:12288
  v_cvt_pk_bf16_f32 v193, v194, v195
  v_exp_f32 v198, v198
  v_add_f32 v30, v30, v196
  v_mfma_f32_32x32x16_bf16 a[64:79], a[224:227], v[176:179], a[64:79]
  ds_read_b64_tr_b16 a[246:247], v17 offset:14336
  s_waitcnt vmcnt(8)
  s_barrier
  v_exp_f32 v199, v199
  v_add_f32 v30, v30, v197
  v_mfma_f32_32x32x16_bf16 a[16:31], a[228:231], v[144:147], a[16:31]
  ds_read_b64_tr_b16 a[248:249], v18 offset:12288
  v_cvt_pk_bf16_f32 v194, v196, v197
  v_exp_f32 v224, v224
  v_add_f32 v30, v30, v198
  v_mfma_f32_32x32x16_bf16 a[80:95], a[228:231], v[176:179], a[80:95]
  ds_read_b64_tr_b16 a[250:251], v18 offset:14336
  s_add_u32 m0, s34, 147456
  s_mov_b32 s94, 0
  buffer_load_dwordx4 v91, s[76:79], s94 offen lds
  s_waitcnt lgkmcnt(6)
  v_mfma_f32_32x32x16_bf16 a[32:47], a[232:235], v[144:147], a[32:47]
  ds_read_b64_tr_b16 a[252:253], v19 offset:12288
  v_exp_f32 v225, v225
  v_add_f32 v30, v30, v199
  v_cvt_pk_bf16_f32 v195, v198, v199
  v_mfma_f32_32x32x16_bf16 a[96:111], a[232:235], v[176:179], a[96:111]
  ds_read_b64_tr_b16 a[254:255], v19 offset:14336
  v_exp_f32 v226, v226
  v_add_f32 v31, v31, v224
  v_exp_f32 v227, v227
  v_mfma_f32_32x32x16_bf16 a[48:63], a[236:239], v[144:147], a[48:63]
  ds_read_b128 a[192:195], v8 offset:32768
  v_add_f32 v31, v31, v225
  v_cvt_pk_bf16_f32 v224, v224, v225
  v_exp_f32 v228, v228
  v_mfma_f32_32x32x16_bf16 a[112:127], a[236:239], v[176:179], a[112:127]
  v_add_f32 v31, v31, v226
  v_exp_f32 v229, v229
  v_add_f32 v31, v31, v227
  v_cvt_pk_bf16_f32 v225, v226, v227
  s_waitcnt lgkmcnt(5)
  v_mfma_f32_32x32x16_bf16 a[0:15], a[240:243], v[152:155], a[0:15]
  ds_read_b128 a[196:199], v9 offset:32768
  v_exp_f32 v230, v230
  v_add_f32 v31, v31, v228
  v_mfma_f32_32x32x16_bf16 a[64:79], a[240:243], v[184:187], a[64:79]
  v_exp_f32 v231, v231
  v_add_f32 v31, v31, v229
  v_cvt_pk_bf16_f32 v226, v228, v229
  v_exp_f32 v200, v200
  v_mfma_f32_32x32x16_bf16 a[16:31], a[244:247], v[152:155], a[16:31]
  ds_read_b128 a[200:203], v10 offset:32768
  v_add_f32 v31, v31, v230
  v_exp_f32 v201, v201
  v_add_f32 v31, v31, v231
  v_mfma_f32_32x32x16_bf16 a[80:95], a[244:247], v[184:187], a[80:95]
  s_mov_b32 s94, 1024
  buffer_load_dwordx4 v91, s[76:79], s94 offen lds
  v_cvt_pk_bf16_f32 v227, v230, v231
  s_waitcnt lgkmcnt(3)
  v_mfma_f32_32x32x16_bf16 a[32:47], a[248:251], v[152:155], a[32:47]
  ds_read_b128 a[204:207], v11 offset:32768
  v_exp_f32 v202, v202
  v_add_f32 v30, v30, v200
  v_exp_f32 v203, v203
  v_mfma_f32_32x32x16_bf16 a[96:111], a[248:251], v[184:187], a[96:111]
  v_add_f32 v30, v30, v201
  v_cvt_pk_bf16_f32 v200, v200, v201
  v_exp_f32 v204, v204
  v_add_f32 v30, v30, v202
  v_mfma_f32_32x32x16_bf16 a[48:63], a[252:255], v[152:155], a[48:63]
  ds_read_b128 a[208:211], v12 offset:32768
  v_exp_f32 v205, v205
  v_add_f32 v30, v30, v203
  v_cvt_pk_bf16_f32 v201, v202, v203
  v_mfma_f32_32x32x16_bf16 a[112:127], a[252:255], v[184:187], a[112:127]
  v_exp_f32 v206, v206
  v_add_f32 v30, v30, v204
  v_exp_f32 v207, v207
  s_cmp_lg_u32 s33, 0
  s_cbranch_scc1 rs_stub_24
rs_ret_25:
  s_waitcnt lgkmcnt(3)
  v_mfma_f32_32x32x16_bf16 v[128:143], a[192:195], a[128:131], v[96:111]
  ds_read_b128 a[212:215], v13 offset:32768
  v_add_f32 v30, v30, v205
  v_cvt_pk_bf16_f32 v202, v204, v205
  v_exp_f32 v232, v232
  v_add_f32 v30, v30, v206
  v_mfma_f32_32x32x16_bf16 v[160:175], a[192:195], a[160:163], v[112:127]
  v_exp_f32 v233, v233
  v_add_f32 v30, v30, v207
  v_cvt_pk_bf16_f32 v203, v206, v207
  v_exp_f32 v234, v234
  v_mfma_f32_32x32x16_bf16 v[128:143], a[196:199], a[132:135], v[128:143]
  ds_read_b128 a[216:219], v14 offset:32768
  v_add_f32 v31, v31, v232
  v_exp_f32 v235, v235
  v_add_f32 v31, v31, v233
  v_mfma_f32_32x32x16_bf16 v[160:175], a[196:199], a[164:167], v[160:175]
  s_mov_b32 s94, 2048
  buffer_load_dwordx4 v91, s[76:79], s94 offen lds
  v_cvt_pk_bf16_f32 v232, v232, v233
  s_waitcnt lgkmcnt(3)
  v_mfma_f32_32x32x16_bf16 v[128:143], a[200:203], a[136:139], v[128:143]
  ds_read_b128 a[220:223], v15 offset:32768
  v_exp_f32 v236, v236
  v_add_f32 v31, v31, v234
  v_exp_f32 v237, v237
  v_mfma_f32_32x32x16_bf16 v[160:175], a[200:203], a[168:171], v[160:175]
  v_add_f32 v31, v31, v235
  v_cvt_pk_bf16_f32 v233, v234, v235
  v_exp_f32 v238, v238
  v_add_f32 v31, v31, v236
  v_exp_f32 v239, v239
  v_mfma_f32_32x32x16_bf16 v[128:143], a[204:207], a[140:143], v[128:143]
  ds_read_b128 a[224:227], v8 offset:40960
  v_add_f32 v31, v31, v237
  v_cvt_pk_bf16_f32 v234, v236, v237
  v_exp_f32 v208, v208
  v_mfma_f32_32x32x16_bf16 v[160:175], a[204:207], a[172:175], v[160:175]
  v_add_f32 v31, v31, v238
  v_exp_f32 v209, v209
  v_add_f32 v31, v31, v239
  v_cvt_pk_bf16_f32 v235, v238, v239
  s_waitcnt lgkmcnt(3)
  v_mfma_f32_32x32x16_bf16 v[128:143], a[208:211], a[144:147], v[128:143]
  ds_read_b128 a[228:231], v9 offset:40960
  v_exp_f32 v210, v210
  v_add_f32 v30, v30, v208
  v_exp_f32 v211, v211
  v_mfma_f32_32x32x16_bf16 v[160:175], a[208:211], a[176:179], v[160:175]
  v_add_f32 v30, v30, v209
  v_cvt_pk_bf16_f32 v208, v208, v209
  v_exp_f32 v212, v212
  v_add_f32 v30, v30, v210
  v_exp_f32 v213, v213
  v_mfma_f32_32x32x16_bf16 v[128:143], a[212:215], a[148:151], v[128:143]
  ds_read_b128 a[232:235], v10 offset:40960
  v_add_f32 v30, v30, v211
  v_cvt_pk_bf16_f32 v209, v210, v211
  v_exp_f32 v214, v214
  v_mfma_f32_32x32x16_bf16 v[160:175], a[212:215], a[180:183], v[160:175]
  s_mov_b32 s94, 3072
  buffer_load_dwordx4 v91, s[76:79], s94 offen lds
  v_add_f32 v30, v30, v212
  s_waitcnt lgkmcnt(3)
  v_mfma_f32_32x32x16_bf16 v[128:143], a[216:219], a[152:155], v[128:143]
  ds_read_b128 a[236:239], v11 offset:40960
  v_exp_f32 v215, v215
  v_add_f32 v30, v30, v213
  v_cvt_pk_bf16_f32 v210, v212, v213
  v_mfma_f32_32x32x16_bf16 v[160:175], a[216:219], a[184:187], v[160:175]
  v_exp_f32 v240, v240
  v_add_f32 v30, v30, v214
  v_exp_f32 v241, v241
  v_add_f32 v30, v30, v215
  v_cvt_pk_bf16_f32 v211, v214, v215
  v_mfma_f32_32x32x16_bf16 v[128:143], a[220:223], a[156:159], v[128:143]
  ds_read_b128 a[240:243], v12 offset:40960
  v_exp_f32 v242, v242
  v_add_f32 v31, v31, v240
  v_exp_f32 v243, v243
  v_mfma_f32_32x32x16_bf16 v[160:175], a[220:223], a[188:191], v[160:175]
  v_add_f32 v31, v31, v241
  v_cvt_pk_bf16_f32 v240, v240, v241
  v_exp_f32 v244, v244
  v_add_f32 v31, v31, v242
  s_waitcnt lgkmcnt(3)
  v_mfma_f32_32x32x16_bf16 v[144:159], a[224:227], a[128:131], v[96:111]
  ds_read_b128 a[244:247], v13 offset:40960
  v_exp_f32 v245, v245
  v_add_f32 v31, v31, v243
  v_cvt_pk_bf16_f32 v241, v242, v243
  v_mfma_f32_32x32x16_bf16 v[176:191], a[224:227], a[160:163], v[112:127]
  v_exp_f32 v246, v246
  v_add_f32 v31, v31, v244
  v_exp_f32 v247, v247
  v_add_f32 v31, v31, v245
  v_cvt_pk_bf16_f32 v242, v244, v245
  v_mfma_f32_32x32x16_bf16 v[144:159], a[228:231], a[132:135], v[144:159]
  ds_read_b128 a[248:251], v14 offset:40960
  v_exp_f32 v216, v216
  v_add_f32 v31, v31, v246
  v_exp_f32 v217, v217
  v_mfma_f32_32x32x16_bf16 v[176:191], a[228:231], a[164:167], v[176:191]
  s_add_u32 m0, s34, 114688
  s_add_u32 s30, s30, 16384
  buffer_load_dwordx4 v24, s[16:19], s31 offen lds
  s_waitcnt lgkmcnt(3)
  v_mfma_f32_32x32x16_bf16 v[144:159], a[232:235], a[136:139], v[144:159]
  ds_read_b128 a[252:255], v15 offset:40960
  v_add_f32 v31, v31, v247
  v_cvt_pk_bf16_f32 v243, v246, v247
  v_exp_f32 v218, v218
  v_add_f32 v30, v30, v216
  v_mfma_f32_32x32x16_bf16 v[176:191], a[232:235], a[168:171], v[176:191]
  v_exp_f32 v219, v219
  v_add_f32 v30, v30, v217
  v_cvt_pk_bf16_f32 v216, v216, v217
  v_exp_f32 v220, v220
  v_mfma_f32_32x32x16_bf16 v[144:159], a[236:239], a[140:143], v[144:159]
  ds_read_b64_tr_b16 a[192:193], v16 offset:16384
  v_add_f32 v30, v30, v218
  v_exp_f32 v221, v221
  v_add_f32 v30, v30, v219
  v_mfma_f32_32x32x16_bf16 v[176:191], a[236:239], a[172:175], v[176:191]
  ds_read_b64_tr_b16 a[194:195], v16 offset:18432
  v_cvt_pk_bf16_f32 v217, v218, v219
  v_exp_f32 v222, v222
  v_add_f32 v30, v30, v220
  v_exp_f32 v223, v223
  s_waitcnt lgkmcnt(4)
  v_mfma_f32_32x32x16_bf16 v[144:159], a[240:243], a[144:147], v[144:159]
  ds_read_b64_tr_b16 a[196:197], v17 offset:16384
  v_add_f32 v30, v30, v221
  v_cvt_pk_bf16_f32 v218, v220, v221
  v_exp_f32 v248, v248
  v_mfma_f32_32x32x16_bf16 v[176:191], a[240:243], a[176:179], v[176:191]
  ds_read_b64_tr_b16 a[198:199], v17 offset:18432
  v_add_f32 v30, v30, v222
  v_exp_f32 v249, v249
  v_add_f32 v30, v30, v223
  v_cvt_pk_bf16_f32 v219, v222, v223
  v_mfma_f32_32x32x16_bf16 v[144:159], a[244:247], a[148:151], v[144:159]
  ds_read_b64_tr_b16 a[200:201], v18 offset:16384
  v_exp_f32 v250, v250
  v_add_f32 v31, v31, v248
  v_exp_f32 v251, v251
  v_mfma_f32_32x32x16_bf16 v[176:191], a[244:247], a[180:183], v[176:191]
  ds_read_b64_tr_b16 a[202:203], v18 offset:18432
  buffer_load_dwordx4 v24, s[16:19], s31 offen offset:1024 lds
  s_waitcnt lgkmcnt(6)
  v_mfma_f32_32x32x16_bf16 v[144:159], a[248:251], a[152:155], v[144:159]
  ds_read_b64_tr_b16 a[204:205], v19 offset:16384
  v_add_f32 v31, v31, v249
  v_cvt_pk_bf16_f32 v248, v248, v249
  v_exp_f32 v252, v252
  v_add_f32 v31, v31, v250
  v_mfma_f32_32x32x16_bf16 v[176:191], a[248:251], a[184:187], v[176:191]
  ds_read_b64_tr_b16 a[206:207], v19 offset:18432
  v_exp_f32 v253, v253
  v_add_f32 v31, v31, v251
  v_cvt_pk_bf16_f32 v249, v250, v251
  v_mfma_f32_32x32x16_bf16 v[144:159], a[252:255], a[156:159], v[144:159]
  ds_read_b64_tr_b16 a[208:209], v16 offset:20480
  v_exp_f32 v254, v254
  v_add_f32 v31, v31, v252
  v_exp_f32 v255, v255
  v_mfma_f32_32x32x16_bf16 v[176:191], a[252:255], a[188:191], v[176:191]
  ds_read_b64_tr_b16 a[210:211], v16 offset:22528
  v_add_f32 v31, v31, v253
  v_cvt_pk_bf16_f32 v250, v252, v253
  v_add_f32 v31, v31, v254
  v_add_f32 v31, v31, v255
  v_cvt_pk_bf16_f32 v251, v254, v255
  s_waitcnt lgkmcnt(6)
  v_mfma_f32_32x32x16_bf16 a[0:15], a[192:195], v[192:195], a[0:15]
  ds_read_b64_tr_b16 a[212:213], v17 offset:20480
  v_max3_f32 v36, v128, v129, v130
  v_max3_f32 v38, v160, v161, v162
  v_max3_f32 v36, v36, v131, v132
  v_max3_f32 v38, v38, v163, v164
  v_mfma_f32_32x32x16_bf16 a[64:79], a[192:195], v[224:227], a[64:79]
  ds_read_b64_tr_b16 a[214:215], v17 offset:22528
  v_max3_f32 v36, v36, v133, v134
  v_max3_f32 v38, v38, v165, v166
  v_max3_f32 v36, v36, v135, v136
  v_max3_f32 v38, v38, v167, v168
  v_max3_f32 v36, v36, v137, v138
  v_mfma_f32_32x32x16_bf16 a[16:31], a[196:199], v[192:195], a[16:31]
  ds_read_b64_tr_b16 a[216:217], v18 offset:20480
  v_max3_f32 v38, v38, v169, v170
  v_max3_f32 v36, v36, v139, v140
  v_max3_f32 v38, v38, v171, v172
  v_max3_f32 v36, v36, v141, v142
  v_mfma_f32_32x32x16_bf16 a[80:95], a[196:199], v[224:227], a[80:95]
  ds_read_b64_tr_b16 a[218:219], v18 offset:22528
  buffer_load_dwordx4 v24, s[16:19], s31 offen offset:2048 lds
  s_waitcnt lgkmcnt(6)
  v_mfma_f32_32x32x16_bf16 a[32:47], a[200:203], v[192:195], a[32:47]
  ds_read_b64_tr_b16 a[220:221], v19 offset:20480
  v_max3_f32 v38, v38, v173, v174
  v_max_f32 v36, v36, v143
  v_max_f32 v38, v38, v175
  v_max3_f32 v37, v144, v145, v146
  v_mfma_f32_32x32x16_bf16 a[96:111], a[200:203], v[224:227], a[96:111]
  ds_read_b64_tr_b16 a[222:223], v19 offset:22528
  v_max3_f32 v39, v176, v177, v178
  v_max3_f32 v37, v37, v147, v148
  v_max3_f32 v39, v39, v179, v180
  v_max3_f32 v37, v37, v149, v150
  v_max3_f32 v39, v39, v181, v182
  v_mfma_f32_32x32x16_bf16 a[48:63], a[204:207], v[192:195], a[48:63]
  ds_read_b64_tr_b16 a[224:225], v16 offset:24576
  v_max3_f32 v37, v37, v151, v152
  v_max3_f32 v39, v39, v183, v184
  v_max3_f32 v37, v37, v153, v154
  v_max3_f32 v39, v39, v185, v186
  v_mfma_f32_32x32x16_bf16 a[112:127], a[204:207], v[224:227], a[112:127]
  ds_read_b64_tr_b16 a[226:227], v16 offset:26624
  v_max3_f32 v37, v37, v155, v156
  v_max3_f32 v39, v39, v187, v188
  v_max3_f32 v37, v37, v157, v158
  v_max3_f32 v39, v39, v189, v190
  s_waitcnt lgkmcnt(6)
  v_mfma_f32_32x32x16_bf16 a[0:15], a[208:211], v[200:203], a[0:15]
  ds_read_b64_tr_b16 a[228:229], v17 offset:24576
  v_max_f32 v37, v37, v159
  v_max_f32 v39, v39, v191
  v_max_f32 v34, v36, v37
  v_max_f32 v35, v38, v39
  v_mfma_f32_32x32x16_bf16 a[64:79], a[208:211], v[232:235], a[64:79]
  ds_read_b64_tr_b16 a[230:231], v17 offset:26624
  v_mov_b32 v36, v34
  v_mov_b32 v37, v35
  s_nop 1
  v_permlane32_swap_b32 v34, v36
  v_permlane32_swap_b32 v35, v37
  v_mfma_f32_32x32x16_bf16 a[16:31], a[212:215], v[200:203], a[16:31]
  ds_read_b64_tr_b16 a[232:233], v18 offset:24576
  v_max_f32 v34, v34, v36
  v_max_f32 v35, v35, v37
  v_max_f32 v36, v34, v35
  v_cmp_lt_f32 vcc, s29, v36
  s_cbranch_vccnz stub_26
ret_27:
  v_mfma_f32_32x32x16_bf16 a[80:95], a[212:215], v[232:235], a[80:95]
  ds_read_b64_tr_b16 a[234:235], v18 offset:26624
  buffer_load_dwordx4 v24, s[16:19], s31 offen offset:3072 lds
  s_add_u32 s31, s31, 16384
  s_waitcnt lgkmcnt(6)
  v_mfma_f32_32x32x16_bf16 a[32:47], a[216:219], v[200:203], a[32:47]
  ds_read_b64_tr_b16 a[236:237], v19 offset:24576
  v_exp_f32 v128, v128
  v_exp_f32 v129, v129
  v_mfma_f32_32x32x16_bf16 a[96:111], a[216:219], v[232:235], a[96:111]
  ds_read_b64_tr_b16 a[238:239], v19 offset:26624
  v_exp_f32 v130, v130
  v_add_f32 v30, v30, v128
  v_exp_f32 v131, v131
  v_mfma_f32_32x32x16_bf16 a[48:63], a[220:223], v[200:203], a[48:63]
  ds_read_b64_tr_b16 a[240:241], v16 offset:28672
  v_add_f32 v30, v30, v129
  v_cvt_pk_bf16_f32 v128, v128, v129
  v_exp_f32 v132, v132
  v_mfma_f32_32x32x16_bf16 a[112:127], a[220:223], v[232:235], a[112:127]
  ds_read_b64_tr_b16 a[242:243], v16 offset:30720
  v_add_f32 v30, v30, v130
  v_exp_f32 v133, v133
  v_add_f32 v30, v30, v131
  s_waitcnt lgkmcnt(6)
  v_mfma_f32_32x32x16_bf16 a[0:15], a[224:227], v[208:211], a[0:15]
  ds_read_b64_tr_b16 a[244:245], v17 offset:28672
  v_cvt_pk_bf16_f32 v129, v130, v131
  v_exp_f32 v134, v134
  v_add_f32 v30, v30, v132
  v_mfma_f32_32x32x16_bf16 a[64:79], a[224:227], v[240:243], a[64:79]
  ds_read_b64_tr_b16 a[246:247], v17 offset:30720
  s_waitcnt vmcnt(8)
  s_barrier
  v_exp_f32 v135, v135
  v_add_f32 v30, v30, v133
  v_mfma_f32_32x32x16_bf16 a[16:31], a[228:231], v[208:211], a[16:31]
  ds_read_b64_tr_b16 a[248:249], v18 offset:28672
  v_cvt_pk_bf16_f32 v130, v132, v133
  v_exp_f32 v160, v160
  v_add_f32 v30, v30, v134
  v_mfma_f32_32x32x16_bf16 a[80:95], a[228:231], v[240:243], a[80:95]
  ds_read_b64_tr_b16 a[250:251], v18 offset:30720
  s_add_u32 m0, s34, 147456
  s_mov_b32 s94, 4096
  buffer_load_dwordx4 v91, s[76:79], s94 offen lds
  s_waitcnt lgkmcnt(6)
  v_mfma_f32_32x32x16_bf16 a[32:47], a[232:235], v[208:211], a[32:47]
  ds_read_b64_tr_b16 a[252:253], v19 offset:28672
  v_exp_f32 v161, v161
  v_add_f32 v30, v30, v135
  v_cvt_pk_bf16_f32 v131, v134, v135
  v_mfma_f32_32x32x16_bf16 a[96:111], a[232:235], v[240:243], a[96:111]
  ds_read_b64_tr_b16 a[254:255], v19 offset:30720
  v_exp_f32 v162, v162
  v_add_f32 v31, v31, v160
  v_exp_f32 v163, v163
  v_mfma_f32_32x32x16_bf16 a[48:63], a[236:239], v[208:211], a[48:63]
  ds_read_b128 a[192:195], v8 offset:49152
  v_add_f32 v31, v31, v161
  v_cvt_pk_bf16_f32 v160, v160, v161
  v_exp_f32 v164, v164
  v_mfma_f32_32x32x16_bf16 a[112:127], a[236:239], v[240:243], a[112:127]
  v_add_f32 v31, v31, v162
  v_exp_f32 v165, v165
  v_add_f32 v31, v31, v163
  v_cvt_pk_bf16_f32 v161, v162, v163
  s_waitcnt lgkmcnt(5)
  v_mfma_f32_32x32x16_bf16 a[0:15], a[240:243], v[216:219], a[0:15]
  ds_read_b128 a[196:199], v9 offset:49152
  v_exp_f32 v166, v166
  v_add_f32 v31, v31, v164
  v_mfma_f32_32x32x16_bf16 a[64:79], a[240:243], v[248:251], a[64:79]
  v_exp_f32 v167, v167
  v_add_f32 v31, v31, v165
  v_cvt_pk_bf16_f32 v162, v164, v165
  v_exp_f32 v136, v136
  v_mfma_f32_32x32x16_bf16 a[16:31], a[244:247], v[216:219], a[16:31]
  ds_read_b128 a[200:203], v10 offset:49152
  v_add_f32 v31, v31, v166
  v_exp_f32 v137, v137
  v_add_f32 v31, v31, v167
  v_mfma_f32_32x32x16_bf16 a[80:95], a[244:247], v[248:251], a[80:95]
  s_mov_b32 s94, 0
  buffer_load_dwordx4 v92, s[80:83], s94 offen lds
  v_cvt_pk_bf16_f32 v163, v166, v167
  s_waitcnt lgkmcnt(3)
  v_mfma_f32_32x32x16_bf16 a[32:47], a[248:251], v[216:219], a[32:47]
  ds_read_b128 a[204:207], v11 offset:49152
  v_exp_f32 v138, v138
  v_add_f32 v30, v30, v136
  v_exp_f32 v139, v139
  v_mfma_f32_32x32x16_bf16 a[96:111], a[248:251], v[248:251], a[96:111]
  v_add_f32 v30, v30, v137
  v_cvt_pk_bf16_f32 v136, v136, v137
  v_exp_f32 v140, v140
  v_add_f32 v30, v30, v138
  v_mfma_f32_32x32x16_bf16 a[48:63], a[252:255], v[216:219], a[48:63]
  ds_read_b128 a[208:211], v12 offset:49152
  v_exp_f32 v141, v141
  v_add_f32 v30, v30, v139
  v_cvt_pk_bf16_f32 v137, v138, v139
  v_mfma_f32_32x32x16_bf16 a[112:127], a[252:255], v[248:251], a[112:127]
  v_exp_f32 v142, v142
  v_add_f32 v30, v30, v140
  v_exp_f32 v143, v143
  s_cmp_lg_u32 s33, 0
  s_cbranch_scc1 rs_stub_28
rs_ret_29:
  s_waitcnt lgkmcnt(3)
  v_mfma_f32_32x32x16_bf16 v[192:207], a[192:195], a[128:131], v[96:111]
  ds_read_b128 a[212:215], v13 offset:49152
  v_add_f32 v30, v30, v141
  v_cvt_pk_bf16_f32 v138, v140, v141
  v_exp_f32 v168, v168
  v_add_f32 v30, v30, v142
  v_mfma_f32_32x32x16_bf16 v[224:239], a[192:195], a[160:163], v[112:127]
  v_exp_f32 v169, v169
  v_add_f32 v30, v30, v143
  v_cvt_pk_bf16_f32 v139, v142, v143
  v_exp_f32 v170, v170
  v_mfma_f32_32x32x16_bf16 v[192:207], a[196:199], a[132:135], v[192:207]
  ds_read_b128 a[216:219], v14 offset:49152
  v_add_f32 v31, v31, v168
  v_exp_f32 v171, v171
  v_add_f32 v31, v31, v169
  v_mfma_f32_32x32x16_bf16 v[224:239], a[196:199], a[164:167], v[224:239]
  s_mov_b32 s94, 1024
  buffer_load_dwordx4 v92, s[80:83], s94 offen lds
  v_cvt_pk_bf16_f32 v168, v168, v169
  s_waitcnt lgkmcnt(3)
  v_mfma_f32_32x32x16_bf16 v[192:207], a[200:203], a[136:139], v[192:207]
  ds_read_b128 a[220:223], v15 offset:49152
  v_exp_f32 v172, v172
  v_add_f32 v31, v31, v170
  v_exp_f32 v173, v173
  v_mfma_f32_32x32x16_bf16 v[224:239], a[200:203], a[168:171], v[224:239]
  v_add_f32 v31, v31, v171
  v_cvt_pk_bf16_f32 v169, v170, v171
  v_exp_f32 v174, v174
  v_add_f32 v31, v31, v172
  v_exp_f32 v175, v175
  v_mfma_f32_32x32x16_bf16 v[192:207], a[204:207], a[140:143], v[192:207]
  ds_read_b128 a[224:227], v8 offset:57344
  v_add_f32 v31, v31, v173
  v_cvt_pk_bf16_f32 v170, v172, v173
  v_exp_f32 v144, v144
  v_mfma_f32_32x32x16_bf16 v[224:239], a[204:207], a[172:175], v[224:239]
  v_add_f32 v31, v31, v174
  v_exp_f32 v145, v145
  v_add_f32 v31, v31, v175
  v_cvt_pk_bf16_f32 v171, v174, v175
  s_waitcnt lgkmcnt(3)
  v_mfma_f32_32x32x16_bf16 v[192:207], a[208:211], a[144:147], v[192:207]
  ds_read_b128 a[228:231], v9 offset:57344
  v_exp_f32 v146, v146
  v_add_f32 v30, v30, v144
  v_exp_f32 v147, v147
  v_mfma_f32_32x32x16_bf16 v[224:239], a[208:211], a[176:179], v[224:239]
  v_add_f32 v30, v30, v145
  v_cvt_pk_bf16_f32 v144, v144, v145
  v_exp_f32 v148, v148
  v_add_f32 v30, v30, v146
  v_exp_f32 v149, v149
  v_mfma_f32_32x32x16_bf16 v[192:207], a[212:215], a[148:151], v[192:207]
  ds_read_b128 a[232:235], v10 offset:57344
  v_add_f32 v30, v30, v147
  v_cvt_pk_bf16_f32 v145, v146, v147
  v_exp_f32 v150, v150
  v_mfma_f32_32x32x16_bf16 v[224:239], a[212:215], a[180:183], v[224:239]
  s_mov_b32 s94, 2048
  buffer_load_dwordx4 v92, s[80:83], s94 offen lds
  v_add_f32 v30, v30, v148
  s_waitcnt lgkmcnt(3)
  v_mfma_f32_32x32x16_bf16 v[192:207], a[216:219], a[152:155], v[192:207]
  ds_read_b128 a[236:239], v11 offset:57344
  v_exp_f32 v151, v151
  v_add_f32 v30, v30, v149
  v_cvt_pk_bf16_f32 v146, v148, v149
  v_mfma_f32_32x32x16_bf16 v[224:239], a[216:219], a[184:187], v[224:239]
  v_exp_f32 v176, v176
  v_add_f32 v30, v30, v150
  v_exp_f32 v177, v177
  v_add_f32 v30, v30, v151
  v_cvt_pk_bf16_f32 v147, v150, v151
  v_mfma_f32_32x32x16_bf16 v[192:207], a[220:223], a[156:159], v[192:207]
  ds_read_b128 a[240:243], v12 offset:57344
  v_exp_f32 v178, v178
  v_add_f32 v31, v31, v176
  v_exp_f32 v179, v179
  v_mfma_f32_32x32x16_bf16 v[224:239], a[220:223], a[188:191], v[224:239]
  v_add_f32 v31, v31, v177
  v_cvt_pk_bf16_f32 v176, v176, v177
  v_exp_f32 v180, v180
  v_add_f32 v31, v31, v178
  s_waitcnt lgkmcnt(3)
  v_mfma_f32_32x32x16_bf16 v[208:223], a[224:227], a[128:131], v[96:111]
  ds_read_b128 a[244:247], v13 offset:57344
  v_exp_f32 v181, v181
  v_add_f32 v31, v31, v179
  v_cvt_pk_bf16_f32 v177, v178, v179
  v_exp_f32 v182, v182
  v_mfma_f32_32x32x16_bf16 v[240:255], a[224:227], a[160:163], v[112:127]
  v_add_f32 v31, v31, v180
  v_exp_f32 v183, v183
  v_add_f32 v31, v31, v181
  v_cvt_pk_bf16_f32 v178, v180, v181
  v_mfma_f32_32x32x16_bf16 v[208:223], a[228:231], a[132:135], v[208:223]
  ds_read_b128 a[248:251], v14 offset:57344
  v_exp_f32 v152, v152
  v_add_f32 v31, v31, v182
  v_exp_f32 v153, v153
  v_mfma_f32_32x32x16_bf16 v[240:255], a[228:231], a[164:167], v[240:255]
  s_add_u32 m0, s34, 147456
  s_mov_b32 s94, 3072
  buffer_load_dwordx4 v92, s[80:83], s94 offen lds
  s_waitcnt lgkmcnt(3)
  v_mfma_f32_32x32x16_bf16 v[208:223], a[232:235], a[136:139], v[208:223]
  ds_read_b128 a[252:255], v15 offset:57344
  v_add_f32 v31, v31, v183
  v_cvt_pk_bf16_f32 v179, v182, v183
  v_exp_f32 v154, v154
  v_add_f32 v30, v30, v152
  v_mfma_f32_32x32x16_bf16 v[240:255], a[232:235], a[168:171], v[240:255]
  v_exp_f32 v155, v155
  v_add_f32 v30, v30, v153
  v_cvt_pk_bf16_f32 v152, v152, v153
  v_exp_f32 v156, v156
  v_mfma_f32_32x32x16_bf16 v[208:223], a[236:239], a[140:143], v[208:223]
  ds_read_b64_tr_b16 a[192:193], v16 offset:32768
  v_add_f32 v30, v30, v154
  v_exp_f32 v157, v157
  v_add_f32 v30, v30, v155
  v_cvt_pk_bf16_f32 v153, v154, v155
  v_mfma_f32_32x32x16_bf16 v[240:255], a[236:239], a[172:175], v[240:255]
  ds_read_b64_tr_b16 a[194:195], v16 offset:34816
  v_exp_f32 v158, v158
  v_add_f32 v30, v30, v156
  v_exp_f32 v159, v159
  s_waitcnt lgkmcnt(4)
  v_mfma_f32_32x32x16_bf16 v[208:223], a[240:243], a[144:147], v[208:223]
  ds_read_b64_tr_b16 a[196:197], v17 offset:32768
  v_add_f32 v30, v30, v157
  v_cvt_pk_bf16_f32 v154, v156, v157
  v_exp_f32 v184, v184
  v_mfma_f32_32x32x16_bf16 v[240:255], a[240:243], a[176:179], v[240:255]
  ds_read_b64_tr_b16 a[198:199], v17 offset:34816
  v_add_f32 v30, v30, v158
  v_exp_f32 v185, v185
  v_add_f32 v30, v30, v159
  v_cvt_pk_bf16_f32 v155, v158, v159
  v_mfma_f32_32x32x16_bf16 v[208:223], a[244:247], a[148:151], v[208:223]
  ds_read_b64_tr_b16 a[200:201], v18 offset:32768
  v_exp_f32 v186, v186
  v_add_f32 v31, v31, v184
  v_exp_f32 v187, v187
  v_mfma_f32_32x32x16_bf16 v[240:255], a[244:247], a[180:183], v[240:255]
  ds_read_b64_tr_b16 a[202:203], v18 offset:34816
  s_mov_b32 s94, 4096
  buffer_load_dwordx4 v92, s[80:83], s94 offen lds
  s_waitcnt lgkmcnt(6)
  v_mfma_f32_32x32x16_bf16 v[208:223], a[248:251], a[152:155], v[208:223]
  ds_read_b64_tr_b16 a[204:205], v19 offset:32768
  v_add_f32 v31, v31, v185
  v_cvt_pk_bf16_f32 v184, v184, v185
  v_exp_f32 v188, v188
  v_add_f32 v31, v31, v186
  v_mfma_f32_32x32x16_bf16 v[240:255], a[248:251], a[184:187], v[240:255]
  ds_read_b64_tr_b16 a[206:207], v19 offset:34816
  v_exp_f32 v189, v189
  v_add_f32 v31, v31, v187
  v_cvt_pk_bf16_f32 v185, v186, v187
  v_mfma_f32_32x32x16_bf16 v[208:223], a[252:255], a[156:159], v[208:223]
  ds_read_b64_tr_b16 a[208:209], v16 offset:36864
  v_exp_f32 v190, v190
  v_add_f32 v31, v31, v188
  v_exp_f32 v191, v191
  v_mfma_f32_32x32x16_bf16 v[240:255], a[252:255], a[188:191], v[240:255]
  ds_read_b64_tr_b16 a[210:211], v16 offset:38912
  v_add_f32 v31, v31, v189
  v_cvt_pk_bf16_f32 v186, v188, v189
  v_add_f32 v31, v31, v190
  v_add_f32 v31, v31, v191
  v_cvt_pk_bf16_f32 v187, v190, v191
  s_waitcnt lgkmcnt(6)
  v_mfma_f32_32x32x16_bf16 a[0:15], a[192:195], v[128:131], a[0:15]
  ds_read_b64_tr_b16 a[212:213], v17 offset:36864
  v_max3_f32 v36, v192, v193, v194
  v_max3_f32 v38, v224, v225, v226
  v_max3_f32 v36, v36, v195, v196
  v_max3_f32 v38, v38, v227, v228
  v_mfma_f32_32x32x16_bf16 a[64:79], a[192:195], v[160:163], a[64:79]
  ds_read_b64_tr_b16 a[214:215], v17 offset:38912
  v_max3_f32 v36, v36, v197, v198
  v_max3_f32 v38, v38, v229, v230
  v_max3_f32 v36, v36, v199, v200
  v_max3_f32 v38, v38, v231, v232
  v_mfma_f32_32x32x16_bf16 a[16:31], a[196:199], v[128:131], a[16:31]
  ds_read_b64_tr_b16 a[216:217], v18 offset:36864
  v_max3_f32 v36, v36, v201, v202
  v_max3_f32 v38, v38, v233, v234
  v_max3_f32 v36, v36, v203, v204
  v_max3_f32 v38, v38, v235, v236
  v_mfma_f32_32x32x16_bf16 a[80:95], a[196:199], v[160:163], a[80:95]
  ds_read_b64_tr_b16 a[218:219], v18 offset:38912
  s_mov_b32 s94, 5120
  buffer_load_dwordx4 v92, s[80:83], s94 offen lds
  s_waitcnt lgkmcnt(6)
  v_mfma_f32_32x32x16_bf16 a[32:47], a[200:203], v[128:131], a[32:47]
  ds_read_b64_tr_b16 a[220:221], v19 offset:36864
  v_max3_f32 v36, v36, v205, v206
  v_max3_f32 v38, v38, v237, v238
  v_max_f32 v36, v36, v207
  v_max_f32 v38, v38, v239
  v_mfma_f32_32x32x16_bf16 a[96:111], a[200:203], v[160:163], a[96:111]
  ds_read_b64_tr_b16 a[222:223], v19 offset:38912
  v_max3_f32 v37, v208, v209, v210
  v_max3_f32 v39, v240, v241, v242
  v_max3_f32 v37, v37, v211, v212
  v_max3_f32 v39, v39, v243, v244
  v_mfma_f32_32x32x16_bf16 a[48:63], a[204:207], v[128:131], a[48:63]
  ds_read_b64_tr_b16 a[224:225], v16 offset:40960
  v_max3_f32 v37, v37, v213, v214
  v_max3_f32 v39, v39, v245, v246
  v_max3_f32 v37, v37, v215, v216
  v_max3_f32 v39, v39, v247, v248
  v_mfma_f32_32x32x16_bf16 a[112:127], a[204:207], v[160:163], a[112:127]
  ds_read_b64_tr_b16 a[226:227], v16 offset:43008
  v_max3_f32 v37, v37, v217, v218
  v_max3_f32 v39, v39, v249, v250
  v_max3_f32 v37, v37, v219, v220
  v_max3_f32 v39, v39, v251, v252
  s_waitcnt lgkmcnt(6)
  v_mfma_f32_32x32x16_bf16 a[0:15], a[208:211], v[136:139], a[0:15]
  ds_read_b64_tr_b16 a[228:229], v17 offset:40960
  v_max3_f32 v37, v37, v221, v222
  v_max3_f32 v39, v39, v253, v254
  v_max_f32 v37, v37, v223
  v_max_f32 v39, v39, v255
  v_mfma_f32_32x32x16_bf16 a[64:79], a[208:211], v[168:171], a[64:79]
  ds_read_b64_tr_b16 a[230:231], v17 offset:43008
  v_max_f32 v34, v36, v37
  v_max_f32 v35, v38, v39
  v_mov_b32 v36, v34
  v_mov_b32 v37, v35
  s_nop 1
  v_mfma_f32_32x32x16_bf16 a[16:31], a[212:215], v[136:139], a[16:31]
  ds_read_b64_tr_b16 a[232:233], v18 offset:40960
  v_permlane32_swap_b32 v34, v36
  v_permlane32_swap_b32 v35, v37
  v_max_f32 v34, v34, v36
  v_max_f32 v35, v35, v37
  v_mfma_f32_32x32x16_bf16 a[80:95], a[212:215], v[168:171], a[80:95]
  ds_read_b64_tr_b16 a[234:235], v18 offset:43008
  s_mov_b32 s94, 0
  buffer_load_dwordx4 v92, s[84:87], s94 offen lds
  s_waitcnt lgkmcnt(6)
  v_mfma_f32_32x32x16_bf16 a[32:47], a[216:219], v[136:139], a[32:47]
  ds_read_b64_tr_b16 a[236:237], v19 offset:40960
  v_max_f32 v36, v34, v35
  v_cmp_lt_f32 vcc, s29, v36
  s_cbranch_vccnz stub_30
ret_31:
  v_exp_f32 v192, v192
  v_mfma_f32_32x32x16_bf16 a[96:111], a[216:219], v[168:171], a[96:111]
  ds_read_b64_tr_b16 a[238:239], v19 offset:43008
  v_exp_f32 v193, v193
  v_exp_f32 v194, v194
  v_mfma_f32_32x32x16_bf16 a[48:63], a[220:223], v[136:139], a[48:63]
  ds_read_b64_tr_b16 a[240:241], v16 offset:45056
  v_add_f32 v30, v30, v192
  v_exp_f32 v195, v195
  v_add_f32 v30, v30, v193
  v_mfma_f32_32x32x16_bf16 a[112:127], a[220:223], v[168:171], a[112:127]
  ds_read_b64_tr_b16 a[242:243], v16 offset:47104
  v_cvt_pk_bf16_f32 v192, v192, v193
  v_exp_f32 v196, v196
  v_add_f32 v30, v30, v194
  s_waitcnt lgkmcnt(6)
  v_mfma_f32_32x32x16_bf16 a[0:15], a[224:227], v[144:147], a[0:15]
  ds_read_b64_tr_b16 a[244:245], v17 offset:45056
  v_exp_f32 v197, v197
  v_add_f32 v30, v30, v195
  v_cvt_pk_bf16_f32 v193, v194, v195
  v_mfma_f32_32x32x16_bf16 a[64:79], a[224:227], v[176:179], a[64:79]
  ds_read_b64_tr_b16 a[246:247], v17 offset:47104
  s_waitcnt vmcnt(8)
  s_barrier
  v_exp_f32 v198, v198
  v_add_f32 v30, v30, v196
  v_mfma_f32_32x32x16_bf16 a[16:31], a[228:231], v[144:147], a[16:31]
  ds_read_b64_tr_b16 a[248:249], v18 offset:45056
  v_exp_f32 v199, v199
  v_add_f32 v30, v30, v197
  v_cvt_pk_bf16_f32 v194, v196, v197
  v_mfma_f32_32x32x16_bf16 a[80:95], a[228:231], v[176:179], a[80:95]
  ds_read_b64_tr_b16 a[250:251], v18 offset:47104
  s_add_u32 m0, s34, 147456
  s_mov_b32 s94, 1024
  buffer_load_dwordx4 v92, s[84:87], s94 offen lds
  s_waitcnt lgkmcnt(6)
  v_mfma_f32_32x32x16_bf16 a[32:47], a[232:235], v[144:147], a[32:47]
  ds_read_b64_tr_b16 a[252:253], v19 offset:45056
  v_exp_f32 v224, v224
  v_add_f32 v30, v30, v198
  v_mfma_f32_32x32x16_bf16 a[96:111], a[232:235], v[176:179], a[96:111]
  ds_read_b64_tr_b16 a[254:255], v19 offset:47104
  v_exp_f32 v225, v225
  v_add_f32 v30, v30, v199
  v_cvt_pk_bf16_f32 v195, v198, v199
  v_mfma_f32_32x32x16_bf16 a[48:63], a[236:239], v[144:147], a[48:63]
  v_exp_f32 v226, v226
  v_add_f32 v31, v31, v224
  v_exp_f32 v227, v227
  v_add_f32 v31, v31, v225
  v_mfma_f32_32x32x16_bf16 a[112:127], a[236:239], v[176:179], a[112:127]
  v_cvt_pk_bf16_f32 v224, v224, v225
  v_exp_f32 v228, v228
  v_add_f32 v31, v31, v226
  s_waitcnt lgkmcnt(4)
  v_mfma_f32_32x32x16_bf16 a[0:15], a[240:243], v[152:155], a[0:15]
  v_exp_f32 v229, v229
  v_add_f32 v31, v31, v227
  v_cvt_pk_bf16_f32 v225, v226, v227
  v_exp_f32 v230, v230
  v_mfma_f32_32x32x16_bf16 a[64:79], a[240:243], v[184:187], a[64:79]
  v_add_f32 v31, v31, v228
  v_exp_f32 v231, v231
  v_add_f32 v31, v31, v229
  v_cvt_pk_bf16_f32 v226, v228, v229
  v_mfma_f32_32x32x16_bf16 a[16:31], a[244:247], v[152:155], a[16:31]
  v_exp_f32 v200, v200
  v_add_f32 v31, v31, v230
  v_exp_f32 v201, v201
  v_mfma_f32_32x32x16_bf16 a[80:95], a[244:247], v[184:187], a[80:95]
  s_mov_b32 s94, 2048
  buffer_load_dwordx4 v92, s[84:87], s94 offen lds
  v_add_f32 v31, v31, v231
  s_waitcnt lgkmcnt(0)
  v_mfma_f32_32x32x16_bf16 a[32:47], a[248:251], v[152:155], a[32:47]
  v_cvt_pk_bf16_f32 v227, v230, v231
  v_exp_f32 v202, v202
  v_add_f32 v30, v30, v200
  v_mfma_f32_32x32x16_bf16 a[96:111], a[248:251], v[184:187], a[96:111]
  v_exp_f32 v203, v203
  v_add_f32 v30, v30, v201
  v_cvt_pk_bf16_f32 v200, v200, v201
  v_exp_f32 v204, v204
  v_mfma_f32_32x32x16_bf16 a[48:63], a[252:255], v[152:155], a[48:63]
  v_add_f32 v30, v30, v202
  v_exp_f32 v205, v205
  v_add_f32 v30, v30, v203
  v_cvt_pk_bf16_f32 v201, v202, v203
  v_mfma_f32_32x32x16_bf16 a[112:127], a[252:255], v[184:187], a[112:127]
  v_exp_f32 v206, v206
  v_add_f32 v30, v30, v204
  v_exp_f32 v207, v207
  s_cmp_lg_u32 s33, 0
  s_cbranch_scc1 rs_stub_32
rs_ret_33:
  v_add_f32 v30, v30, v205
  v_cvt_pk_bf16_f32 v202, v204, v205
  v_exp_f32 v232, v232
  v_add_f32 v30, v30, v206
  v_exp_f32 v233, v233
  v_add_f32 v30, v30, v207
  v_cvt_pk_bf16_f32 v203, v206, v207
  v_exp_f32 v234, v234
  v_add_f32 v31, v31, v232
  v_exp_f32 v235, v235
  v_add_f32 v31, v31, v233
  v_cvt_pk_bf16_f32 v232, v232, v233
  v_exp_f32 v236, v236
  s_mov_b32 s94, 3072
  buffer_load_dwordx4 v92, s[84:87], s94 offen lds
  v_add_f32 v31, v31, v234
  v_exp_f32 v237, v237
  v_add_f32 v31, v31, v235
  v_cvt_pk_bf16_f32 v233, v234, v235
  v_exp_f32 v238, v238
  v_add_f32 v31, v31, v236
  v_exp_f32 v239, v239
  v_add_f32 v31, v31, v237
  v_cvt_pk_bf16_f32 v234, v236, v237
  v_exp_f32 v208, v208
  v_add_f32 v31, v31, v238
  v_exp_f32 v209, v209
  s_mov_b32 s94, 4096
  buffer_load_dwordx4 v92, s[84:87], s94 offen lds
  v_add_f32 v31, v31, v239
  v_cvt_pk_bf16_f32 v235, v238, v239
  v_exp_f32 v210, v210
  v_add_f32 v30, v30, v208
  v_exp_f32 v211, v211
  v_add_f32 v30, v30, v209
  v_cvt_pk_bf16_f32 v208, v208, v209
  v_exp_f32 v212, v212
  v_add_f32 v30, v30, v210
  v_exp_f32 v213, v213
  v_add_f32 v30, v30, v211
  v_cvt_pk_bf16_f32 v209, v210, v211
  v_exp_f32 v214, v214
  v_add_f32 v30, v30, v212
  s_add_u32 m0, s34, 147456
  s_mov_b32 s94, 5120
  buffer_load_dwordx4 v92, s[84:87], s94 offen lds
  v_exp_f32 v215, v215
  v_add_f32 v30, v30, v213
  v_cvt_pk_bf16_f32 v210, v212, v213
  v_exp_f32 v240, v240
  v_add_f32 v30, v30, v214
  v_exp_f32 v241, v241
  v_add_f32 v30, v30, v215
  v_cvt_pk_bf16_f32 v211, v214, v215
  v_exp_f32 v242, v242
  v_add_f32 v31, v31, v240
  v_exp_f32 v243, v243
  v_add_f32 v31, v31, v241
  v_cvt_pk_bf16_f32 v240, v240, v241
  s_mov_b32 s94, 0x40000000
  buffer_load_dwordx4 v92, s[84:87], s94 offen lds
  v_exp_f32 v244, v244
  v_add_f32 v31, v31, v242
  v_exp_f32 v245, v245
  v_add_f32 v31, v31, v243
  v_cvt_pk_bf16_f32 v241, v242, v243
  v_exp_f32 v246, v246
  v_add_f32 v31, v31, v244
  v_exp_f32 v247, v247
  v_add_f32 v31, v31, v245
  v_cvt_pk_bf16_f32 v242, v244, v245
  v_exp_f32 v216, v216
  v_add_f32 v31, v31, v246
  s_mov_b32 s94, 0x40000000
  buffer_load_dwordx4 v92, s[84:87], s94 offen lds
  v_exp_f32 v217, v217
  v_add_f32 v31, v31, v247
  v_cvt_pk_bf16_f32 v243, v246, v247
  v_exp_f32 v218, v218
  v_add_f32 v30, v30, v216
  v_exp_f32 v219, v219
  v_add_f32 v30, v30, v217
  v_cvt_pk_bf16_f32 v216, v216, v217
  v_exp_f32 v220, v220
  ds_read_b64_tr_b16 a[192:193], v16 offset:49152
  v_add_f32 v30, v30, v218
  v_exp_f32 v221, v221
  v_add_f32 v30, v30, v219
  v_cvt_pk_bf16_f32 v217, v218, v219
  ds_read_b64_tr_b16 a[194:195], v16 offset:51200
  s_mov_b32 s94, 0x40000000
  buffer_load_dwordx4 v92, s[84:87], s94 offen lds
  ds_read_b64_tr_b16 a[196:197], v17 offset:49152
  v_exp_f32 v222, v222
  v_add_f32 v30, v30, v220
  v_exp_f32 v223, v223
  ds_read_b64_tr_b16 a[198:199], v17 offset:51200
  v_add_f32 v30, v30, v221
  v_cvt_pk_bf16_f32 v218, v220, v221
  v_exp_f32 v248, v248
  v_add_f32 v30, v30, v222
  ds_read_b64_tr_b16 a[200:201], v18 offset:49152
  v_exp_f32 v249, v249
  v_add_f32 v30, v30, v223
  v_cvt_pk_bf16_f32 v219, v222, v223
  ds_read_b64_tr_b16 a[202:203], v18 offset:51200
  v_exp_f32 v250, v250
  v_add_f32 v31, v31, v248
  v_exp_f32 v251, v251
  ds_read_b64_tr_b16 a[204:205], v19 offset:49152
  v_add_f32 v31, v31, v249
  v_cvt_pk_bf16_f32 v248, v248, v249
  v_exp_f32 v252, v252
  v_add_f32 v31, v31, v250
  ds_read_b64_tr_b16 a[206:207], v19 offset:51200
  v_exp_f32 v253, v253
  v_add_f32 v31, v31, v251
  v_cvt_pk_bf16_f32 v249, v250, v251
  ds_read_b64_tr_b16 a[208:209], v16 offset:53248
  v_exp_f32 v254, v254
  v_add_f32 v31, v31, v252
  v_exp_f32 v255, v255
  ds_read_b64_tr_b16 a[210:211], v16 offset:55296
  v_add_f32 v31, v31, v253
  v_cvt_pk_bf16_f32 v250, v252, v253
  v_add_f32 v31, v31, v254
  v_add_f32 v31, v31, v255
  v_cvt_pk_bf16_f32 v251, v254, v255
  s_waitcnt lgkmcnt(6)
  v_mfma_f32_32x32x16_bf16 a[0:15], a[192:195], v[192:195], a[0:15]
  ds_read_b64_tr_b16 a[212:213], v17 offset:53248
  v_mfma_f32_32x32x16_bf16 a[64:79], a[192:195], v[224:227], a[64:79]
  ds_read_b64_tr_b16 a[214:215], v17 offset:55296
  v_mfma_f32_32x32x16_bf16 a[16:31], a[196:199], v[192:195], a[16:31]
  ds_read_b64_tr_b16 a[216:217], v18 offset:53248
  v_mfma_f32_32x32x16_bf16 a[80:95], a[196:199], v[224:227], a[80:95]
  ds_read_b64_tr_b16 a[218:219], v18 offset:55296
  s_waitcnt lgkmcnt(6)
  v_mfma_f32_32x32x16_bf16 a[32:47], a[200:203], v[192:195], a[32:47]
  ds_read_b64_tr_b16 a[220:221], v19 offset:53248
  v_mfma_f32_32x32x16_bf16 a[96:111], a[200:203], v[224:227], a[96:111]
  ds_read_b64_tr_b16 a[222:223], v19 offset:55296
  v_mfma_f32_32x32x16_bf16 a[48:63], a[204:207], v[192:195], a[48:63]
  ds_read_b64_tr_b16 a[224:225], v16 offset:57344
  v_mfma_f32_32x32x16_bf16 a[112:127], a[204:207], v[224:227], a[112:127]
  ds_read_b64_tr_b16 a[226:227], v16 offset:59392
  s_waitcnt lgkmcnt(6)
  v_mfma_f32_32x32x16_bf16 a[0:15], a[208:211], v[200:203], a[0:15]
  ds_read_b64_tr_b16 a[228:229], v17 offset:57344
  v_mfma_f32_32x32x16_bf16 a[64:79], a[208:211], v[232:235], a[64:79]
  ds_read_b64_tr_b16 a[230:231], v17 offset:59392
  v_mfma_f32_32x32x16_bf16 a[16:31], a[212:215], v[200:203], a[16:31]
  ds_read_b64_tr_b16 a[232:233], v18 offset:57344
  v_mfma_f32_32x32x16_bf16 a[80:95], a[212:215], v[232:235], a[80:95]
  ds_read_b64_tr_b16 a[234:235], v18 offset:59392
  s_waitcnt lgkmcnt(6)
  v_mfma_f32_32x32x16_bf16 a[32:47], a[216:219], v[200:203], a[32:47]
  ds_read_b64_tr_b16 a[236:237], v19 offset:57344
  v_mfma_f32_32x32x16_bf16 a[96:111], a[216:219], v[232:235], a[96:111]
  ds_read_b64_tr_b16 a[238:239], v19 offset:59392
  v_mfma_f32_32x32x16_bf16 a[48:63], a[220:223], v[200:203], a[48:63]
  ds_read_b64_tr_b16 a[240:241], v16 offset:61440
  v_mfma_f32_32x32x16_bf16 a[112:127], a[220:223], v[232:235], a[112:127]
  ds_read_b64_tr_b16 a[242:243], v16 offset:63488
  s_waitcnt lgkmcnt(6)
  v_mfma_f32_32x32x16_bf16 a[0:15], a[224:227], v[208:211], a[0:15]
  ds_read_b64_tr_b16 a[244:245], v17 offset:61440
  v_mfma_f32_32x32x16_bf16 a[64:79], a[224:227], v[240:243], a[64:79]
  ds_read_b64_tr_b16 a[246:247], v17 offset:63488
  v_mfma_f32_32x32x16_bf16 a[16:31], a[228:231], v[208:211], a[16:31]
  ds_read_b64_tr_b16 a[248:249], v18 offset:61440
  v_mfma_f32_32x32x16_bf16 a[80:95], a[228:231], v[240:243], a[80:95]
  ds_read_b64_tr_b16 a[250:251], v18 offset:63488
  s_waitcnt lgkmcnt(6)
  v_mfma_f32_32x32x16_bf16 a[32:47], a[232:235], v[208:211], a[32:47]
  ds_read_b64_tr_b16 a[252:253], v19 offset:61440
  v_mfma_f32_32x32x16_bf16 a[96:111], a[232:235], v[240:243], a[96:111]
  ds_read_b64_tr_b16 a[254:255], v19 offset:63488
  v_mfma_f32_32x32x16_bf16 a[48:63], a[236:239], v[208:211], a[48:63]
  v_mfma_f32_32x32x16_bf16 a[112:127], a[236:239], v[240:243], a[112:127]
  s_waitcnt lgkmcnt(4)
  v_mfma_f32_32x32x16_bf16 a[0:15], a[240:243], v[216:219], a[0:15]
  v_mfma_f32_32x32x16_bf16 a[64:79], a[240:243], v[248:251], a[64:79]
  v_mfma_f32_32x32x16_bf16 a[16:31], a[244:247], v[216:219], a[16:31]
  v_mfma_f32_32x32x16_bf16 a[80:95], a[244:247], v[248:251], a[80:95]
  s_waitcnt lgkmcnt(0)
  v_mfma_f32_32x32x16_bf16 a[32:47], a[248:251], v[216:219], a[32:47]
  v_mfma_f32_32x32x16_bf16 a[96:111], a[248:251], v[248:251], a[96:111]
  v_mfma_f32_32x32x16_bf16 a[48:63], a[252:255], v[216:219], a[48:63]
  v_mfma_f32_32x32x16_bf16 a[112:127], a[252:255], v[248:251], a[112:127]
  s_nop 15
  v_mov_b32 v34, v30
  v_mov_b32 v35, v31
  s_nop 1
  v_permlane32_swap_b32 v30, v34
  v_permlane32_swap_b32 v31, v35
  v_add_f32 v30, v30, v34
  v_add_f32 v31, v31, v35
  v_rcp_f32 v30, v30
  v_rcp_f32 v31, v31
  s_nop 0
  v_and_b32 v3, 31, v1
  v_lshrrev_b32 v4, 5, v1
  v_mul_u32_u24 v3, 272, v3
  v_lshlrev_b32 v4, 4, v4
  s_mul_i32 s43, s37, 17408
  v_add3_u32 v3, v3, v4, s43
  v_accvgpr_read_b32 v64, a0
  v_accvgpr_read_b32 v65, a1
  v_accvgpr_read_b32 v66, a2
  v_accvgpr_read_b32 v67, a3
  v_accvgpr_read_b32 v68, a4
  v_accvgpr_read_b32 v69, a5
  v_accvgpr_read_b32 v70, a6
  v_accvgpr_read_b32 v71, a7
  v_accvgpr_read_b32 v72, a8
  v_accvgpr_read_b32 v73, a9
  v_accvgpr_read_b32 v74, a10
  v_accvgpr_read_b32 v75, a11
  v_accvgpr_read_b32 v76, a12
  v_accvgpr_read_b32 v77, a13
  v_accvgpr_read_b32 v78, a14
  v_accvgpr_read_b32 v79, a15
  v_mul_f32 v64, v64, v30
  v_mul_f32 v65, v65, v30
  v_mul_f32 v66, v66, v30
  v_mul_f32 v67, v67, v30
  v_mul_f32 v68, v68, v30
  v_mul_f32 v69, v69, v30
  v_mul_f32 v70, v70, v30
  v_mul_f32 v71, v71, v30
  v_mul_f32 v72, v72, v30
  v_mul_f32 v73, v73, v30
  v_mul_f32 v74, v74, v30
  v_mul_f32 v75, v75, v30
  v_mul_f32 v76, v76, v30
  v_mul_f32 v77, v77, v30
  v_mul_f32 v78, v78, v30
  v_mul_f32 v79, v79, v30
  v_cvt_pk_bf16_f32 v80, v64, v65
  v_cvt_pk_bf16_f32 v81, v66, v67
  v_cvt_pk_bf16_f32 v82, v68, v69
  v_cvt_pk_bf16_f32 v83, v70, v71
  v_cvt_pk_bf16_f32 v84, v72, v73
  v_cvt_pk_bf16_f32 v85, v74, v75
  v_cvt_pk_bf16_f32 v86, v76, v77
  v_cvt_pk_bf16_f32 v87, v78, v79
  s_nop 1
  v_permlane32_swap_b32 v80, v82
  v_permlane32_swap_b32 v81, v83
  v_permlane32_swap_b32 v84, v86
  v_permlane32_swap_b32 v85, v87
  ds_write_b128 v3, v[80:83] offset:0
  ds_write_b128 v3, v[84:87] offset:32
  v_accvgpr_read_b32 v96, a16
  v_accvgpr_read_b32 v97, a17
  v_accvgpr_read_b32 v98, a18
  v_accvgpr_read_b32 v99, a19
  v_accvgpr_read_b32 v100, a20
  v_accvgpr_read_b32 v101, a21
  v_accvgpr_read_b32 v102, a22
  v_accvgpr_read_b32 v103, a23
  v_accvgpr_read_b32 v104, a24
  v_accvgpr_read_b32 v105, a25
  v_accvgpr_read_b32 v106, a26
  v_accvgpr_read_b32 v107, a27
  v_accvgpr_read_b32 v108, a28
  v_accvgpr_read_b32 v109, a29
  v_accvgpr_read_b32 v110, a30
  v_accvgpr_read_b32 v111, a31
  v_mul_f32 v96, v96, v30
  v_mul_f32 v97, v97, v30
  v_mul_f32 v98, v98, v30
  v_mul_f32 v99, v99, v30
  v_mul_f32 v100, v100, v30
  v_mul_f32 v101, v101, v30
  v_mul_f32 v102, v102, v30
  v_mul_f32 v103, v103, v30
  v_mul_f32 v104, v104, v30
  v_mul_f32 v105, v105, v30
  v_mul_f32 v106, v106, v30
  v_mul_f32 v107, v107, v30
  v_mul_f32 v108, v108, v30
  v_mul_f32 v109, v109, v30
  v_mul_f32 v110, v110, v30
  v_mul_f32 v111, v111, v30
  v_cvt_pk_bf16_f32 v112, v96, v97
  v_cvt_pk_bf16_f32 v113, v98, v99
  v_cvt_pk_bf16_f32 v114, v100, v101
  v_cvt_pk_bf16_f32 v115, v102, v103
  v_cvt_pk_bf16_f32 v116, v104, v105
  v_cvt_pk_bf16_f32 v117, v106, v107
  v_cvt_pk_bf16_f32 v118, v108, v109
  v_cvt_pk_bf16_f32 v119, v110, v111
  s_nop 1
  v_permlane32_swap_b32 v112, v114
  v_permlane32_swap_b32 v113, v115
  v_permlane32_swap_b32 v116, v118
  v_permlane32_swap_b32 v117, v119
  ds_write_b128 v3, v[112:115] offset:64
  ds_write_b128 v3, v[116:119] offset:96
  v_accvgpr_read_b32 v64, a32
  v_accvgpr_read_b32 v65, a33
  v_accvgpr_read_b32 v66, a34
  v_accvgpr_read_b32 v67, a35
  v_accvgpr_read_b32 v68, a36
  v_accvgpr_read_b32 v69, a37
  v_accvgpr_read_b32 v70, a38
  v_accvgpr_read_b32 v71, a39
  v_accvgpr_read_b32 v72, a40
  v_accvgpr_read_b32 v73, a41
  v_accvgpr_read_b32 v74, a42
  v_accvgpr_read_b32 v75, a43
  v_accvgpr_read_b32 v76, a44
  v_accvgpr_read_b32 v77, a45
  v_accvgpr_read_b32 v78, a46
  v_accvgpr_read_b32 v79, a47
  v_mul_f32 v64, v64, v30
  v_mul_f32 v65, v65, v30
  v_mul_f32 v66, v66, v30
  v_mul_f32 v67, v67, v30
  v_mul_f32 v68, v68, v30
  v_mul_f32 v69, v69, v30
  v_mul_f32 v70, v70, v30
  v_mul_f32 v71, v71, v30
  v_mul_f32 v72, v72, v30
  v_mul_f32 v73, v73, v30
  v_mul_f32 v74, v74, v30
  v_mul_f32 v75, v75, v30
  v_mul_f32 v76, v76, v30
  v_mul_f32 v77, v77, v30
  v_mul_f32 v78, v78, v30
  v_mul_f32 v79, v79, v30
  v_cvt_pk_bf16_f32 v80, v64, v65
  v_cvt_pk_bf16_f32 v81, v66, v67
  v_cvt_pk_bf16_f32 v82, v68, v69
  v_cvt_pk_bf16_f32 v83, v70, v71
  v_cvt_pk_bf16_f32 v84, v72, v73
  v_cvt_pk_bf16_f32 v85, v74, v75
  v_cvt_pk_bf16_f32 v86, v76, v77
  v_cvt_pk_bf16_f32 v87, v78, v79
  s_nop 1
  v_permlane32_swap_b32 v80, v82
  v_permlane32_swap_b32 v81, v83
  v_permlane32_swap_b32 v84, v86
  v_permlane32_swap_b32 v85, v87
  ds_write_b128 v3, v[80:83] offset:128
  ds_write_b128 v3, v[84:87] offset:160
  v_accvgpr_read_b32 v96, a48
  v_accvgpr_read_b32 v97, a49
  v_accvgpr_read_b32 v98, a50
  v_accvgpr_read_b32 v99, a51
  v_accvgpr_read_b32 v100, a52
  v_accvgpr_read_b32 v101, a53
  v_accvgpr_read_b32 v102, a54
  v_accvgpr_read_b32 v103, a55
  v_accvgpr_read_b32 v104, a56
  v_accvgpr_read_b32 v105, a57
  v_accvgpr_read_b32 v106, a58
  v_accvgpr_read_b32 v107, a59
  v_accvgpr_read_b32 v108, a60
  v_accvgpr_read_b32 v109, a61
  v_accvgpr_read_b32 v110, a62
  v_accvgpr_read_b32 v111, a63
  v_mul_f32 v96, v96, v30
  v_mul_f32 v97, v97, v30
  v_mul_f32 v98, v98, v30
  v_mul_f32 v99, v99, v30
  v_mul_f32 v100, v100, v30
  v_mul_f32 v101, v101, v30
  v_mul_f32 v102, v102, v30
  v_mul_f32 v103, v103, v30
  v_mul_f32 v104, v104, v30
  v_mul_f32 v105, v105, v30
  v_mul_f32 v106, v106, v30
  v_mul_f32 v107, v107, v30
  v_mul_f32 v108, v108, v30
  v_mul_f32 v109, v109, v30
  v_mul_f32 v110, v110, v30
  v_mul_f32 v111, v111, v30
  v_cvt_pk_bf16_f32 v112, v96, v97
  v_cvt_pk_bf16_f32 v113, v98, v99
  v_cvt_pk_bf16_f32 v114, v100, v101
  v_cvt_pk_bf16_f32 v115, v102, v103
  v_cvt_pk_bf16_f32 v116, v104, v105
  v_cvt_pk_bf16_f32 v117, v106, v107
  v_cvt_pk_bf16_f32 v118, v108, v109
  v_cvt_pk_bf16_f32 v119, v110, v111
  s_nop 1
  v_permlane32_swap_b32 v112, v114
  v_permlane32_swap_b32 v113, v115
  v_permlane32_swap_b32 v116, v118
  v_permlane32_swap_b32 v117, v119
  ds_write_b128 v3, v[112:115] offset:192
  ds_write_b128 v3, v[116:119] offset:224
  v_lshrrev_b32 v5, 4, v1
  v_and_b32 v6, 15, v1
  v_lshlrev_b32 v6, 4, v6
  v_mul_u32_u24 v7, 272, v5
  v_add3_u32 v7, v7, v6, s43
  v_add_u32 v5, s39, v5
  v_lshlrev_b32 v5, 13, v5
  v_add3_u32 v5, v5, v6, s40
  s_waitcnt lgkmcnt(0)
  ds_read_b128 v[128:131], v7 offset:0
  ds_read_b128 v[132:135], v7 offset:1088
  ds_read_b128 v[136:139], v7 offset:2176
  ds_read_b128 v[140:143], v7 offset:3264
  ds_read_b128 v[144:147], v7 offset:4352
  ds_read_b128 v[148:151], v7 offset:5440
  ds_read_b128 v[152:155], v7 offset:6528
  ds_read_b128 v[156:159], v7 offset:7616
  s_mov_b32 s44, 0
  s_waitcnt lgkmcnt(7)
  buffer_store_dwordx4 v[128:131], v5, s[24:27], s44 offen
  s_mov_b32 s44, 32768
  s_waitcnt lgkmcnt(6)
  buffer_store_dwordx4 v[132:135], v5, s[24:27], s44 offen
  s_mov_b32 s44, 65536
  s_waitcnt lgkmcnt(5)
  buffer_store_dwordx4 v[136:139], v5, s[24:27], s44 offen
  s_mov_b32 s44, 98304
  s_waitcnt lgkmcnt(4)
  buffer_store_dwordx4 v[140:143], v5, s[24:27], s44 offen
  s_mov_b32 s44, 131072
  s_waitcnt lgkmcnt(3)
  buffer_store_dwordx4 v[144:147], v5, s[24:27], s44 offen
  s_mov_b32 s44, 163840
  s_waitcnt lgkmcnt(2)
  buffer_store_dwordx4 v[148:151], v5, s[24:27], s44 offen
  s_mov_b32 s44, 196608
  s_waitcnt lgkmcnt(1)
  buffer_store_dwordx4 v[152:155], v5, s[24:27], s44 offen
  s_mov_b32 s44, 229376
  s_waitcnt lgkmcnt(0)
  buffer_store_dwordx4 v[156:159], v5, s[24:27], s44 offen
  v_accvgpr_read_b32 v64, a64
  v_accvgpr_read_b32 v65, a65
  v_accvgpr_read_b32 v66, a66
  v_accvgpr_read_b32 v67, a67
  v_accvgpr_read_b32 v68, a68
  v_accvgpr_read_b32 v69, a69
  v_accvgpr_read_b32 v70, a70
  v_accvgpr_read_b32 v71, a71
  v_accvgpr_read_b32 v72, a72
  v_accvgpr_read_b32 v73, a73
  v_accvgpr_read_b32 v74, a74
  v_accvgpr_read_b32 v75, a75
  v_accvgpr_read_b32 v76, a76
  v_accvgpr_read_b32 v77, a77
  v_accvgpr_read_b32 v78, a78
  v_accvgpr_read_b32 v79, a79
  v_mul_f32 v64, v64, v31
  v_mul_f32 v65, v65, v31
  v_mul_f32 v66, v66, v31
  v_mul_f32 v67, v67, v31
  v_mul_f32 v68, v68, v31
  v_mul_f32 v69, v69, v31
  v_mul_f32 v70, v70, v31
  v_mul_f32 v71, v71, v31
  v_mul_f32 v72, v72, v31
  v_mul_f32 v73, v73, v31
  v_mul_f32 v74, v74, v31
  v_mul_f32 v75, v75, v31
  v_mul_f32 v76, v76, v31
  v_mul_f32 v77, v77, v31
  v_mul_f32 v78, v78, v31
  v_mul_f32 v79, v79, v31
  v_cvt_pk_bf16_f32 v80, v64, v65
  v_cvt_pk_bf16_f32 v81, v66, v67
  v_cvt_pk_bf16_f32 v82, v68, v69
  v_cvt_pk_bf16_f32 v83, v70, v71
  v_cvt_pk_bf16_f32 v84, v72, v73
  v_cvt_pk_bf16_f32 v85, v74, v75
  v_cvt_pk_bf16_f32 v86, v76, v77
  v_cvt_pk_bf16_f32 v87, v78, v79
  s_nop 1
  v_permlane32_swap_b32 v80, v82
  v_permlane32_swap_b32 v81, v83
  v_permlane32_swap_b32 v84, v86
  v_permlane32_swap_b32 v85, v87
  ds_write_b128 v3, v[80:83] offset:8704
  ds_write_b128 v3, v[84:87] offset:8736
  v_accvgpr_read_b32 v96, a80
  v_accvgpr_read_b32 v97, a81
  v_accvgpr_read_b32 v98, a82
  v_accvgpr_read_b32 v99, a83
  v_accvgpr_read_b32 v100, a84
  v_accvgpr_read_b32 v101, a85
  v_accvgpr_read_b32 v102, a86
  v_accvgpr_read_b32 v103, a87
  v_accvgpr_read_b32 v104, a88
  v_accvgpr_read_b32 v105, a89
  v_accvgpr_read_b32 v106, a90
  v_accvgpr_read_b32 v107, a91
  v_accvgpr_read_b32 v108, a92
  v_accvgpr_read_b32 v109, a93
  v_accvgpr_read_b32 v110, a94
  v_accvgpr_read_b32 v111, a95
  v_mul_f32 v96, v96, v31
  v_mul_f32 v97, v97, v31
  v_mul_f32 v98, v98, v31
  v_mul_f32 v99, v99, v31
  v_mul_f32 v100, v100, v31
  v_mul_f32 v101, v101, v31
  v_mul_f32 v102, v102, v31
  v_mul_f32 v103, v103, v31
  v_mul_f32 v104, v104, v31
  v_mul_f32 v105, v105, v31
  v_mul_f32 v106, v106, v31
  v_mul_f32 v107, v107, v31
  v_mul_f32 v108, v108, v31
  v_mul_f32 v109, v109, v31
  v_mul_f32 v110, v110, v31
  v_mul_f32 v111, v111, v31
  v_cvt_pk_bf16_f32 v112, v96, v97
  v_cvt_pk_bf16_f32 v113, v98, v99
  v_cvt_pk_bf16_f32 v114, v100, v101
  v_cvt_pk_bf16_f32 v115, v102, v103
  v_cvt_pk_bf16_f32 v116, v104, v105
  v_cvt_pk_bf16_f32 v117, v106, v107
  v_cvt_pk_bf16_f32 v118, v108, v109
  v_cvt_pk_bf16_f32 v119, v110, v111
  s_nop 1
  v_permlane32_swap_b32 v112, v114
  v_permlane32_swap_b32 v113, v115
  v_permlane32_swap_b32 v116, v118
  v_permlane32_swap_b32 v117, v119
  ds_write_b128 v3, v[112:115] offset:8768
  ds_write_b128 v3, v[116:119] offset:8800
  v_accvgpr_read_b32 v64, a96
  v_accvgpr_read_b32 v65, a97
  v_accvgpr_read_b32 v66, a98
  v_accvgpr_read_b32 v67, a99
  v_accvgpr_read_b32 v68, a100
  v_accvgpr_read_b32 v69, a101
  v_accvgpr_read_b32 v70, a102
  v_accvgpr_read_b32 v71, a103
  v_accvgpr_read_b32 v72, a104
  v_accvgpr_read_b32 v73, a105
  v_accvgpr_read_b32 v74, a106
  v_accvgpr_read_b32 v75, a107
  v_accvgpr_read_b32 v76, a108
  v_accvgpr_read_b32 v77, a109
  v_accvgpr_read_b32 v78, a110
  v_accvgpr_read_b32 v79, a111
  v_mul_f32 v64, v64, v31
  v_mul_f32 v65, v65, v31
  v_mul_f32 v66, v66, v31
  v_mul_f32 v67, v67, v31
  v_mul_f32 v68, v68, v31
  v_mul_f32 v69, v69, v31
  v_mul_f32 v70, v70, v31
  v_mul_f32 v71, v71, v31
  v_mul_f32 v72, v72, v31
  v_mul_f32 v73, v73, v31
  v_mul_f32 v74, v74, v31
  v_mul_f32 v75, v75, v31
  v_mul_f32 v76, v76, v31
  v_mul_f32 v77, v77, v31
  v_mul_f32 v78, v78, v31
  v_mul_f32 v79, v79, v31
  v_cvt_pk_bf16_f32 v80, v64, v65
  v_cvt_pk_bf16_f32 v81, v66, v67
  v_cvt_pk_bf16_f32 v82, v68, v69
  v_cvt_pk_bf16_f32 v83, v70, v71
  v_cvt_pk_bf16_f32 v84, v72, v73
  v_cvt_pk_bf16_f32 v85, v74, v75
  v_cvt_pk_bf16_f32 v86, v76, v77
  v_cvt_pk_bf16_f32 v87, v78, v79
  s_nop 1
  v_permlane32_swap_b32 v80, v82
  v_permlane32_swap_b32 v81, v83
  v_permlane32_swap_b32 v84, v86
  v_permlane32_swap_b32 v85, v87
  ds_write_b128 v3, v[80:83] offset:8832
  ds_write_b128 v3, v[84:87] offset:8864
  v_accvgpr_read_b32 v96, a112
  v_accvgpr_read_b32 v97, a113
  v_accvgpr_read_b32 v98, a114
  v_accvgpr_read_b32 v99, a115
  v_accvgpr_read_b32 v100, a116
  v_accvgpr_read_b32 v101, a117
  v_accvgpr_read_b32 v102, a118
  v_accvgpr_read_b32 v103, a119
  v_accvgpr_read_b32 v104, a120
  v_accvgpr_read_b32 v105, a121
  v_accvgpr_read_b32 v106, a122
  v_accvgpr_read_b32 v107, a123
  v_accvgpr_read_b32 v108, a124
  v_accvgpr_read_b32 v109, a125
  v_accvgpr_read_b32 v110, a126
  v_accvgpr_read_b32 v111, a127
  v_mul_f32 v96, v96, v31
  v_mul_f32 v97, v97, v31
  v_mul_f32 v98, v98, v31
  v_mul_f32 v99, v99, v31
  v_mul_f32 v100, v100, v31
  v_mul_f32 v101, v101, v31
  v_mul_f32 v102, v102, v31
  v_mul_f32 v103, v103, v31
  v_mul_f32 v104, v104, v31
  v_mul_f32 v105, v105, v31
  v_mul_f32 v106, v106, v31
  v_mul_f32 v107, v107, v31
  v_mul_f32 v108, v108, v31
  v_mul_f32 v109, v109, v31
  v_mul_f32 v110, v110, v31
  v_mul_f32 v111, v111, v31
  v_cvt_pk_bf16_f32 v112, v96, v97
  v_cvt_pk_bf16_f32 v113, v98, v99
  v_cvt_pk_bf16_f32 v114, v100, v101
  v_cvt_pk_bf16_f32 v115, v102, v103
  v_cvt_pk_bf16_f32 v116, v104, v105
  v_cvt_pk_bf16_f32 v117, v106, v107
  v_cvt_pk_bf16_f32 v118, v108, v109
  v_cvt_pk_bf16_f32 v119, v110, v111
  s_nop 1
  v_permlane32_swap_b32 v112, v114
  v_permlane32_swap_b32 v113, v115
  v_permlane32_swap_b32 v116, v118
  v_permlane32_swap_b32 v117, v119
  ds_write_b128 v3, v[112:115] offset:8896
  ds_write_b128 v3, v[116:119] offset:8928
  s_waitcnt lgkmcnt(0)
  ds_read_b128 v[160:163], v7 offset:8704
  ds_read_b128 v[164:167], v7 offset:9792
  ds_read_b128 v[168:171], v7 offset:10880
  ds_read_b128 v[172:175], v7 offset:11968
  ds_read_b128 v[176:179], v7 offset:13056
  ds_read_b128 v[180:183], v7 offset:14144
  ds_read_b128 v[184:187], v7 offset:15232
  ds_read_b128 v[188:191], v7 offset:16320
  s_mov_b32 s44, 262144
  s_waitcnt lgkmcnt(7)
  buffer_store_dwordx4 v[160:163], v5, s[24:27], s44 offen
  s_mov_b32 s44, 294912
  s_waitcnt lgkmcnt(6)
  buffer_store_dwordx4 v[164:167], v5, s[24:27], s44 offen
  s_mov_b32 s44, 327680
  s_waitcnt lgkmcnt(5)
  buffer_store_dwordx4 v[168:171], v5, s[24:27], s44 offen
  s_mov_b32 s44, 360448
  s_waitcnt lgkmcnt(4)
  buffer_store_dwordx4 v[172:175], v5, s[24:27], s44 offen
  s_mov_b32 s44, 393216
  s_waitcnt lgkmcnt(3)
  buffer_store_dwordx4 v[176:179], v5, s[24:27], s44 offen
  s_mov_b32 s44, 425984
  s_waitcnt lgkmcnt(2)
  buffer_store_dwordx4 v[180:183], v5, s[24:27], s44 offen
  s_mov_b32 s44, 458752
  s_waitcnt lgkmcnt(1)
  buffer_store_dwordx4 v[184:187], v5, s[24:27], s44 offen
  s_mov_b32 s44, 491520
  s_waitcnt lgkmcnt(0)
  buffer_store_dwordx4 v[188:191], v5, s[24:27], s44 offen
at_end_4:
  s_endpgm
stub_6:
  s_call_b64 s[44:45], rare_max1_35
  s_branch ret_7
rs_stub_8:
  s_call_b64 s[44:45], rare_rescale_36
  s_branch rs_ret_9
stub_10:
  s_call_b64 s[44:45], rare_max0_34
  s_branch ret_11
rs_stub_12:
  s_call_b64 s[44:45], rare_rescale_36
  s_branch rs_ret_13
stub_14:
  s_call_b64 s[44:45], rare_max1_35
  s_branch ret_15
rs_stub_16:
  s_call_b64 s[44:45], rare_rescale_36
  s_branch rs_ret_17
stub_18:
  s_call_b64 s[44:45], rare_max0_34
  s_branch ret_19
rs_stub_20:
  s_call_b64 s[44:45], rare_rescale_36
  s_branch rs_ret_21
stub_22:
  s_call_b64 s[44:45], rare_max1_35
  s_branch ret_23
rs_stub_24:
  s_call_b64 s[44:45], rare_rescale_36
  s_branch rs_ret_25
stub_26:
  s_call_b64 s[44:45], rare_max0_34
  s_branch ret_27
rs_stub_28:
  s_call_b64 s[44:45], rare_rescale_36
  s_branch rs_ret_29
stub_30:
  s_call_b64 s[44:45], rare_max1_35
  s_branch ret_31
rs_stub_32:
  s_call_b64 s[44:45], rare_rescale_36
  s_branch rs_ret_33
rare_max0_34:
  v_max_f32 v36, 0, v34
  v_sub_f32 v32, 0, v36
  v_exp_f32 v32, v32
  v_sub_f32 v128, v128, v36
  v_sub_f32 v129, v129, v36
  v_sub_f32 v130, v130, v36
  v_sub_f32 v131, v131, v36
  v_sub_f32 v132, v132, v36
  v_sub_f32 v133, v133, v36
  v_sub_f32 v134, v134, v36
  v_sub_f32 v135, v135, v36
  v_sub_f32 v136, v136, v36
  v_sub_f32 v137, v137, v36
  v_sub_f32 v138, v138, v36
  v_sub_f32 v139, v139, v36
  v_sub_f32 v140, v140, v36
  v_sub_f32 v141, v141, v36
  v_sub_f32 v142, v142, v36
  v_sub_f32 v143, v143, v36
  v_sub_f32 v144, v144, v36
  v_sub_f32 v145, v145, v36
  v_sub_f32 v146, v146, v36
  v_sub_f32 v147, v147, v36
  v_sub_f32 v148, v148, v36
  v_sub_f32 v149, v149, v36
  v_sub_f32 v150, v150, v36
  v_sub_f32 v151, v151, v36
  v_sub_f32 v152, v152, v36
  v_sub_f32 v153, v153, v36
  v_sub_f32 v154, v154, v36
  v_sub_f32 v155, v155, v36
  v_sub_f32 v156, v156, v36
  v_sub_f32 v157, v157, v36
  v_sub_f32 v158, v158, v36
  v_sub_f32 v159, v159, v36
  v_sub_f32 v96, v96, v36
  v_sub_f32 v97, v97, v36
  v_sub_f32 v98, v98, v36
  v_sub_f32 v99, v99, v36
  v_sub_f32 v100, v100, v36
  v_sub_f32 v101, v101, v36
  v_sub_f32 v102, v102, v36
  v_sub_f32 v103, v103, v36
  v_sub_f32 v104, v104, v36
  v_sub_f32 v105, v105, v36
  v_sub_f32 v106, v106, v36
  v_sub_f32 v107, v107, v36
  v_sub_f32 v108, v108, v36
  v_sub_f32 v109, v109, v36
  v_sub_f32 v110, v110, v36
  v_sub_f32 v111, v111, v36
  v_mul_f32 v30, v30, v32
  v_max_f32 v37, 0, v35
  v_sub_f32 v33, 0, v37
  v_exp_f32 v33, v33
  v_sub_f32 v160, v160, v37
  v_sub_f32 v161, v161, v37
  v_sub_f32 v162, v162, v37
  v_sub_f32 v163, v163, v37
  v_sub_f32 v164, v164, v37
  v_sub_f32 v165, v165, v37
  v_sub_f32 v166, v166, v37
  v_sub_f32 v167, v167, v37
  v_sub_f32 v168, v168, v37
  v_sub_f32 v169, v169, v37
  v_sub_f32 v170, v170, v37
  v_sub_f32 v171, v171, v37
  v_sub_f32 v172, v172, v37
  v_sub_f32 v173, v173, v37
  v_sub_f32 v174, v174, v37
  v_sub_f32 v175, v175, v37
  v_sub_f32 v176, v176, v37
  v_sub_f32 v177, v177, v37
  v_sub_f32 v178, v178, v37
  v_sub_f32 v179, v179, v37
  v_sub_f32 v180, v180, v37
  v_sub_f32 v181, v181, v37
  v_sub_f32 v182, v182, v37
  v_sub_f32 v183, v183, v37
  v_sub_f32 v184, v184, v37
  v_sub_f32 v185, v185, v37
  v_sub_f32 v186, v186, v37
  v_sub_f32 v187, v187, v37
  v_sub_f32 v188, v188, v37
  v_sub_f32 v189, v189, v37
  v_sub_f32 v190, v190, v37
  v_sub_f32 v191, v191, v37
  v_sub_f32 v112, v112, v37
  v_sub_f32 v113, v113, v37
  v_sub_f32 v114, v114, v37
  v_sub_f32 v115, v115, v37
  v_sub_f32 v116, v116, v37
  v_sub_f32 v117, v117, v37
  v_sub_f32 v118, v118, v37
  v_sub_f32 v119, v119, v37
  v_sub_f32 v120, v120, v37
  v_sub_f32 v121, v121, v37
  v_sub_f32 v122, v122, v37
  v_sub_f32 v123, v123, v37
  v_sub_f32 v124, v124, v37
  v_sub_f32 v125, v125, v37
  v_sub_f32 v126, v126, v37
  v_sub_f32 v127, v127, v37
  v_mul_f32 v31, v31, v33
  s_mov_b32 s33, 1
  s_setpc_b64 s[44:45]
rare_max1_35:
  v_max_f32 v36, 0, v34
  v_sub_f32 v32, 0, v36
  v_exp_f32 v32, v32
  v_sub_f32 v192, v192, v36
  v_sub_f32 v193, v193, v36
  v_sub_f32 v194, v194, v36
  v_sub_f32 v195, v195, v36
  v_sub_f32 v196, v196, v36
  v_sub_f32 v197, v197, v36
  v_sub_f32 v198, v198, v36
  v_sub_f32 v199, v199, v36
  v_sub_f32 v200, v200, v36
  v_sub_f32 v201, v201, v36
  v_sub_f32 v202, v202, v36
  v_sub_f32 v203, v203, v36
  v_sub_f32 v204, v204, v36
  v_sub_f32 v205, v205, v36
  v_sub_f32 v206, v206, v36
  v_sub_f32 v207, v207, v36
  v_sub_f32 v208, v208, v36
  v_sub_f32 v209, v209, v36
  v_sub_f32 v210, v210, v36
  v_sub_f32 v211, v211, v36
  v_sub_f32 v212, v212, v36
  v_sub_f32 v213, v213, v36
  v_sub_f32 v214, v214, v36
  v_sub_f32 v215, v215, v36
  v_sub_f32 v216, v216, v36
  v_sub_f32 v217, v217, v36
  v_sub_f32 v218, v218, v36
  v_sub_f32 v219, v219, v36
  v_sub_f32 v220, v220, v36
  v_sub_f32 v221, v221, v36
  v_sub_f32 v222, v222, v36
  v_sub_f32 v223, v223, v36
  v_sub_f32 v96, v96, v36
  v_sub_f32 v97, v97, v36
  v_sub_f32 v98, v98, v36
  v_sub_f32 v99, v99, v36
  v_sub_f32 v100, v100, v36
  v_sub_f32 v101, v101, v36
  v_sub_f32 v102, v102, v36
  v_sub_f32 v103, v103, v36
  v_sub_f32 v104, v104, v36
  v_sub_f32 v105, v105, v36
  v_sub_f32 v106, v106, v36
  v_sub_f32 v107, v107, v36
  v_sub_f32 v108, v108, v36
  v_sub_f32 v109, v109, v36
  v_sub_f32 v110, v110, v36
  v_sub_f32 v111, v111, v36
  v_mul_f32 v30, v30, v32
  v_max_f32 v37, 0, v35
  v_sub_f32 v33, 0, v37
  v_exp_f32 v33, v33
  v_sub_f32 v224, v224, v37
  v_sub_f32 v225, v225, v37
  v_sub_f32 v226, v226, v37
  v_sub_f32 v227, v227, v37
  v_sub_f32 v228, v228, v37
  v_sub_f32 v229, v229, v37
  v_sub_f32 v230, v230, v37
  v_sub_f32 v231, v231, v37
  v_sub_f32 v232, v232, v37
  v_sub_f32 v233, v233, v37
  v_sub_f32 v234, v234, v37
  v_sub_f32 v235, v235, v37
  v_sub_f32 v236, v236, v37
  v_sub_f32 v237, v237, v37
  v_sub_f32 v238, v238, v37
  v_sub_f32 v239, v239, v37
  v_sub_f32 v240, v240, v37
  v_sub_f32 v241, v241, v37
  v_sub_f32 v242, v242, v37
  v_sub_f32 v243, v243, v37
  v_sub_f32 v244, v244, v37
  v_sub_f32 v245, v245, v37
  v_sub_f32 v246, v246, v37
  v_sub_f32 v247, v247, v37
  v_sub_f32 v248, v248, v37
  v_sub_f32 v249, v249, v37
  v_sub_f32 v250, v250, v37
  v_sub_f32 v251, v251, v37
  v_sub_f32 v252, v252, v37
  v_sub_f32 v253, v253, v37
  v_sub_f32 v254, v254, v37
  v_sub_f32 v255, v255, v37
  v_sub_f32 v112, v112, v37
  v_sub_f32 v113, v113, v37
  v_sub_f32 v114, v114, v37
  v_sub_f32 v115, v115, v37
  v_sub_f32 v116, v116, v37
  v_sub_f32 v117, v117, v37
  v_sub_f32 v118, v118, v37
  v_sub_f32 v119, v119, v37
  v_sub_f32 v120, v120, v37
  v_sub_f32 v121, v121, v37
  v_sub_f32 v122, v122, v37
  v_sub_f32 v123, v123, v37
  v_sub_f32 v124, v124, v37
  v_sub_f32 v125, v125, v37
  v_sub_f32 v126, v126, v37
  v_sub_f32 v127, v127, v37
  v_mul_f32 v31, v31, v33
  s_mov_b32 s33, 1
  s_setpc_b64 s[44:45]
rare_rescale_36:
  s_nop 15
  v_accvgpr_read_b32 v42, a0
  v_accvgpr_read_b32 v43, a1
  v_accvgpr_read_b32 v44, a2
  v_accvgpr_read_b32 v45, a3
  v_accvgpr_read_b32 v46, a4
  v_accvgpr_read_b32 v47, a5
  v_accvgpr_read_b32 v48, a6
  v_accvgpr_read_b32 v49, a7
  v_mul_f32 v42, v42, v32
  v_mul_f32 v43, v43, v32
  v_mul_f32 v44, v44, v32
  v_mul_f32 v45, v45, v32
  v_mul_f32 v46, v46, v32
  v_mul_f32 v47, v47, v32
  v_mul_f32 v48, v48, v32
  v_mul_f32 v49, v49, v32
  v_accvgpr_write_b32 a0, v42
  v_accvgpr_write_b32 a1, v43
  v_accvgpr_write_b32 a2, v44
  v_accvgpr_write_b32 a3, v45
  v_accvgpr_write_b32 a4, v46
  v_accvgpr_write_b32 a5, v47
  v_accvgpr_write_b32 a6, v48
  v_accvgpr_write_b32 a7, v49
  v_accvgpr_read_b32 v42, a8
  v_accvgpr_read_b32 v43, a9
  v_accvgpr_read_b32 v44, a10
  v_accvgpr_read_b32 v45, a11
  v_accvgpr_read_b32 v46, a12
  v_accvgpr_read_b32 v47, a13
  v_accvgpr_read_b32 v48, a14
  v_accvgpr_read_b32 v49, a15
  v_mul_f32 v42, v42, v32
  v_mul_f32 v43, v43, v32
  v_mul_f32 v44, v44, v32
  v_mul_f32 v45, v45, v32
  v_mul_f32 v46, v46, v32
  v_mul_f32 v47, v47, v32
  v_mul_f32 v48, v48, v32
  v_mul_f32 v49, v49, v32
  v_accvgpr_write_b32 a8, v42
  v_accvgpr_write_b32 a9, v43
  v_accvgpr_write_b32 a10, v44
  v_accvgpr_write_b32 a11, v45
  v_accvgpr_write_b32 a12, v46
  v_accvgpr_write_b32 a13, v47
  v_accvgpr_write_b32 a14, v48
  v_accvgpr_write_b32 a15, v49
  v_accvgpr_read_b32 v42, a16
  v_accvgpr_read_b32 v43, a17
  v_accvgpr_read_b32 v44, a18
  v_accvgpr_read_b32 v45, a19
  v_accvgpr_read_b32 v46, a20
  v_accvgpr_read_b32 v47, a21
  v_accvgpr_read_b32 v48, a22
  v_accvgpr_read_b32 v49, a23
  v_mul_f32 v42, v42, v32
  v_mul_f32 v43, v43, v32
  v_mul_f32 v44, v44, v32
  v_mul_f32 v45, v45, v32
  v_mul_f32 v46, v46, v32
  v_mul_f32 v47, v47, v32
  v_mul_f32 v48, v48, v32
  v_mul_f32 v49, v49, v32
  v_accvgpr_write_b32 a16, v42
  v_accvgpr_write_b32 a17, v43
  v_accvgpr_write_b32 a18, v44
  v_accvgpr_write_b32 a19, v45
  v_accvgpr_write_b32 a20, v46
  v_accvgpr_write_b32 a21, v47
  v_accvgpr_write_b32 a22, v48
  v_accvgpr_write_b32 a23, v49
  v_accvgpr_read_b32 v42, a24
  v_accvgpr_read_b32 v43, a25
  v_accvgpr_read_b32 v44, a26
  v_accvgpr_read_b32 v45, a27
  v_accvgpr_read_b32 v46, a28
  v_accvgpr_read_b32 v47, a29
  v_accvgpr_read_b32 v48, a30
  v_accvgpr_read_b32 v49, a31
  v_mul_f32 v42, v42, v32
  v_mul_f32 v43, v43, v32
  v_mul_f32 v44, v44, v32
  v_mul_f32 v45, v45, v32
  v_mul_f32 v46, v46, v32
  v_mul_f32 v47, v47, v32
  v_mul_f32 v48, v48, v32
  v_mul_f32 v49, v49, v32
  v_accvgpr_write_b32 a24, v42
  v_accvgpr_write_b32 a25, v43
  v_accvgpr_write_b32 a26, v44
  v_accvgpr_write_b32 a27, v45
  v_accvgpr_write_b32 a28, v46
  v_accvgpr_write_b32 a29, v47
  v_accvgpr_write_b32 a30, v48
  v_accvgpr_write_b32 a31, v49
  v_accvgpr_read_b32 v42, a32
  v_accvgpr_read_b32 v43, a33
  v_accvgpr_read_b32 v44, a34
  v_accvgpr_read_b32 v45, a35
  v_accvgpr_read_b32 v46, a36
  v_accvgpr_read_b32 v47, a37
  v_accvgpr_read_b32 v48, a38
  v_accvgpr_read_b32 v49, a39
  v_mul_f32 v42, v42, v32
  v_mul_f32 v43, v43, v32
  v_mul_f32 v44, v44, v32
  v_mul_f32 v45, v45, v32
  v_mul_f32 v46, v46, v32
  v_mul_f32 v47, v47, v32
  v_mul_f32 v48, v48, v32
  v_mul_f32 v49, v49, v32
  v_accvgpr_write_b32 a32, v42
  v_accvgpr_write_b32 a33, v43
  v_accvgpr_write_b32 a34, v44
  v_accvgpr_write_b32 a35, v45
  v_accvgpr_write_b32 a36, v46
  v_accvgpr_write_b32 a37, v47
  v_accvgpr_write_b32 a38, v48
  v_accvgpr_write_b32 a39, v49
  v_accvgpr_read_b32 v42, a40
  v_accvgpr_read_b32 v43, a41
  v_accvgpr_read_b32 v44, a42
  v_accvgpr_read_b32 v45, a43
  v_accvgpr_read_b32 v46, a44
  v_accvgpr_read_b32 v47, a45
  v_accvgpr_read_b32 v48, a46
  v_accvgpr_read_b32 v49, a47
  v_mul_f32 v42, v42, v32
  v_mul_f32 v43, v43, v32
  v_mul_f32 v44, v44, v32
  v_mul_f32 v45, v45, v32
  v_mul_f32 v46, v46, v32
  v_mul_f32 v47, v47, v32
  v_mul_f32 v48, v48, v32
  v_mul_f32 v49, v49, v32
  v_accvgpr_write_b32 a40, v42
  v_accvgpr_write_b32 a41, v43
  v_accvgpr_write_b32 a42, v44
  v_accvgpr_write_b32 a43, v45
  v_accvgpr_write_b32 a44, v46
  v_accvgpr_write_b32 a45, v47
  v_accvgpr_write_b32 a46, v48
  v_accvgpr_write_b32 a47, v49
  v_accvgpr_read_b32 v42, a48
  v_accvgpr_read_b32 v43, a49
  v_accvgpr_read_b32 v44, a50
  v_accvgpr_read_b32 v45, a51
  v_accvgpr_read_b32 v46, a52
  v_accvgpr_read_b32 v47, a53
  v_accvgpr_read_b32 v48, a54
  v_accvgpr_read_b32 v49, a55
  v_mul_f32 v42, v42, v32
  v_mul_f32 v43, v43, v32
  v_mul_f32 v44, v44, v32
  v_mul_f32 v45, v45, v32
  v_mul_f32 v46, v46, v32
  v_mul_f32 v47, v47, v32
  v_mul_f32 v48, v48, v32
  v_mul_f32 v49, v49, v32
  v_accvgpr_write_b32 a48, v42
  v_accvgpr_write_b32 a49, v43
  v_accvgpr_write_b32 a50, v44
  v_accvgpr_write_b32 a51, v45
  v_accvgpr_write_b32 a52, v46
  v_accvgpr_write_b32 a53, v47
  v_accvgpr_write_b32 a54, v48
  v_accvgpr_write_b32 a55, v49
  v_accvgpr_read_b32 v42, a56
  v_accvgpr_read_b32 v43, a57
  v_accvgpr_read_b32 v44, a58
  v_accvgpr_read_b32 v45, a59
  v_accvgpr_read_b32 v46, a60
  v_accvgpr_read_b32 v47, a61
  v_accvgpr_read_b32 v48, a62
  v_accvgpr_read_b32 v49, a63
  v_mul_f32 v42, v42, v32
  v_mul_f32 v43, v43, v32
  v_mul_f32 v44, v44, v32
  v_mul_f32 v45, v45, v32
  v_mul_f32 v46, v46, v32
  v_mul_f32 v47, v47, v32
  v_mul_f32 v48, v48, v32
  v_mul_f32 v49, v49, v32
  v_accvgpr_write_b32 a56, v42
  v_accvgpr_write_b32 a57, v43
  v_accvgpr_write_b32 a58, v44
  v_accvgpr_write_b32 a59, v45
  v_accvgpr_write_b32 a60, v46
  v_accvgpr_write_b32 a61, v47
  v_accvgpr_write_b32 a62, v48
  v_accvgpr_write_b32 a63, v49
  v_accvgpr_read_b32 v42, a64
  v_accvgpr_read_b32 v43, a65
  v_accvgpr_read_b32 v44, a66
  v_accvgpr_read_b32 v45, a67
  v_accvgpr_read_b32 v46, a68
  v_accvgpr_read_b32 v47, a69
  v_accvgpr_read_b32 v48, a70
  v_accvgpr_read_b32 v49, a71
  v_mul_f32 v42, v42, v33
  v_mul_f32 v43, v43, v33
  v_mul_f32 v44, v44, v33
  v_mul_f32 v45, v45, v33
  v_mul_f32 v46, v46, v33
  v_mul_f32 v47, v47, v33
  v_mul_f32 v48, v48, v33
  v_mul_f32 v49, v49, v33
  v_accvgpr_write_b32 a64, v42
  v_accvgpr_write_b32 a65, v43
  v_accvgpr_write_b32 a66, v44
  v_accvgpr_write_b32 a67, v45
  v_accvgpr_write_b32 a68, v46
  v_accvgpr_write_b32 a69, v47
  v_accvgpr_write_b32 a70, v48
  v_accvgpr_write_b32 a71, v49
  v_accvgpr_read_b32 v42, a72
  v_accvgpr_read_b32 v43, a73
  v_accvgpr_read_b32 v44, a74
  v_accvgpr_read_b32 v45, a75
  v_accvgpr_read_b32 v46, a76
  v_accvgpr_read_b32 v47, a77
  v_accvgpr_read_b32 v48, a78
  v_accvgpr_read_b32 v49, a79
  v_mul_f32 v42, v42, v33
  v_mul_f32 v43, v43, v33
  v_mul_f32 v44, v44, v33
  v_mul_f32 v45, v45, v33
  v_mul_f32 v46, v46, v33
  v_mul_f32 v47, v47, v33
  v_mul_f32 v48, v48, v33
  v_mul_f32 v49, v49, v33
  v_accvgpr_write_b32 a72, v42
  v_accvgpr_write_b32 a73, v43
  v_accvgpr_write_b32 a74, v44
  v_accvgpr_write_b32 a75, v45
  v_accvgpr_write_b32 a76, v46
  v_accvgpr_write_b32 a77, v47
  v_accvgpr_write_b32 a78, v48
  v_accvgpr_write_b32 a79, v49
  v_accvgpr_read_b32 v42, a80
  v_accvgpr_read_b32 v43, a81
  v_accvgpr_read_b32 v44, a82
  v_accvgpr_read_b32 v45, a83
  v_accvgpr_read_b32 v46, a84
  v_accvgpr_read_b32 v47, a85
  v_accvgpr_read_b32 v48, a86
  v_accvgpr_read_b32 v49, a87
  v_mul_f32 v42, v42, v33
  v_mul_f32 v43, v43, v33
  v_mul_f32 v44, v44, v33
  v_mul_f32 v45, v45, v33
  v_mul_f32 v46, v46, v33
  v_mul_f32 v47, v47, v33
  v_mul_f32 v48, v48, v33
  v_mul_f32 v49, v49, v33
  v_accvgpr_write_b32 a80, v42
  v_accvgpr_write_b32 a81, v43
  v_accvgpr_write_b32 a82, v44
  v_accvgpr_write_b32 a83, v45
  v_accvgpr_write_b32 a84, v46
  v_accvgpr_write_b32 a85, v47
  v_accvgpr_write_b32 a86, v48
  v_accvgpr_write_b32 a87, v49
  v_accvgpr_read_b32 v42, a88
  v_accvgpr_read_b32 v43, a89
  v_accvgpr_read_b32 v44, a90
  v_accvgpr_read_b32 v45, a91
  v_accvgpr_read_b32 v46, a92
  v_accvgpr_read_b32 v47, a93
  v_accvgpr_read_b32 v48, a94
  v_accvgpr_read_b32 v49, a95
  v_mul_f32 v42, v42, v33
  v_mul_f32 v43, v43, v33
  v_mul_f32 v44, v44, v33
  v_mul_f32 v45, v45, v33
  v_mul_f32 v46, v46, v33
  v_mul_f32 v47, v47, v33
  v_mul_f32 v48, v48, v33
  v_mul_f32 v49, v49, v33
  v_accvgpr_write_b32 a88, v42
  v_accvgpr_write_b32 a89, v43
  v_accvgpr_write_b32 a90, v44
  v_accvgpr_write_b32 a91, v45
  v_accvgpr_write_b32 a92, v46
  v_accvgpr_write_b32 a93, v47
  v_accvgpr_write_b32 a94, v48
  v_accvgpr_write_b32 a95, v49
  v_accvgpr_read_b32 v42, a96
  v_accvgpr_read_b32 v43, a97
  v_accvgpr_read_b32 v44, a98
  v_accvgpr_read_b32 v45, a99
  v_accvgpr_read_b32 v46, a100
  v_accvgpr_read_b32 v47, a101
  v_accvgpr_read_b32 v48, a102
  v_accvgpr_read_b32 v49, a103
  v_mul_f32 v42, v42, v33
  v_mul_f32 v43, v43, v33
  v_mul_f32 v44, v44, v33
  v_mul_f32 v45, v45, v33
  v_mul_f32 v46, v46, v33
  v_mul_f32 v47, v47, v33
  v_mul_f32 v48, v48, v33
  v_mul_f32 v49, v49, v33
  v_accvgpr_write_b32 a96, v42
  v_accvgpr_write_b32 a97, v43
  v_accvgpr_write_b32 a98, v44
  v_accvgpr_write_b32 a99, v45
  v_accvgpr_write_b32 a100, v46
  v_accvgpr_write_b32 a101, v47
  v_accvgpr_write_b32 a102, v48
  v_accvgpr_write_b32 a103, v49
  v_accvgpr_read_b32 v42, a104
  v_accvgpr_read_b32 v43, a105
  v_accvgpr_read_b32 v44, a106
  v_accvgpr_read_b32 v45, a107
  v_accvgpr_read_b32 v46, a108
  v_accvgpr_read_b32 v47, a109
  v_accvgpr_read_b32 v48, a110
  v_accvgpr_read_b32 v49, a111
  v_mul_f32 v42, v42, v33
  v_mul_f32 v43, v43, v33
  v_mul_f32 v44, v44, v33
  v_mul_f32 v45, v45, v33
  v_mul_f32 v46, v46, v33
  v_mul_f32 v47, v47, v33
  v_mul_f32 v48, v48, v33
  v_mul_f32 v49, v49, v33
  v_accvgpr_write_b32 a104, v42
  v_accvgpr_write_b32 a105, v43
  v_accvgpr_write_b32 a106, v44
  v_accvgpr_write_b32 a107, v45
  v_accvgpr_write_b32 a108, v46
  v_accvgpr_write_b32 a109, v47
  v_accvgpr_write_b32 a110, v48
  v_accvgpr_write_b32 a111, v49
  v_accvgpr_read_b32 v42, a112
  v_accvgpr_read_b32 v43, a113
  v_accvgpr_read_b32 v44, a114
  v_accvgpr_read_b32 v45, a115
  v_accvgpr_read_b32 v46, a116
  v_accvgpr_read_b32 v47, a117
  v_accvgpr_read_b32 v48, a118
  v_accvgpr_read_b32 v49, a119
  v_mul_f32 v42, v42, v33
  v_mul_f32 v43, v43, v33
  v_mul_f32 v44, v44, v33
  v_mul_f32 v45, v45, v33
  v_mul_f32 v46, v46, v33
  v_mul_f32 v47, v47, v33
  v_mul_f32 v48, v48, v33
  v_mul_f32 v49, v49, v33
  v_accvgpr_write_b32 a112, v42
  v_accvgpr_write_b32 a113, v43
  v_accvgpr_write_b32 a114, v44
  v_accvgpr_write_b32 a115, v45
  v_accvgpr_write_b32 a116, v46
  v_accvgpr_write_b32 a117, v47
  v_accvgpr_write_b32 a118, v48
  v_accvgpr_write_b32 a119, v49
  v_accvgpr_read_b32 v42, a120
  v_accvgpr_read_b32 v43, a121
  v_accvgpr_read_b32 v44, a122
  v_accvgpr_read_b32 v45, a123
  v_accvgpr_read_b32 v46, a124
  v_accvgpr_read_b32 v47, a125
  v_accvgpr_read_b32 v48, a126
  v_accvgpr_read_b32 v49, a127
  v_mul_f32 v42, v42, v33
  v_mul_f32 v43, v43, v33
  v_mul_f32 v44, v44, v33
  v_mul_f32 v45, v45, v33
  v_mul_f32 v46, v46, v33
  v_mul_f32 v47, v47, v33
  v_mul_f32 v48, v48, v33
  v_mul_f32 v49, v49, v33
  v_accvgpr_write_b32 a120, v42
  v_accvgpr_write_b32 a121, v43
  v_accvgpr_write_b32 a122, v44
  v_accvgpr_write_b32 a123, v45
  v_accvgpr_write_b32 a124, v46
  v_accvgpr_write_b32 a125, v47
  v_accvgpr_write_b32 a126, v48
  v_accvgpr_write_b32 a127, v49
  s_mov_b32 s33, 0
  s_nop 1
  s_setpc_b64 s[44:45]
.text
.globl oproj_kernel
.p2align 8
.type oproj_kernel,@function
oproj_kernel:
  s_cmp_ge_u32 s2, 256
  s_cbranch_scc1 g_end_37
  s_load_dwordx2 s[4:5], s[0:1], 96
  s_load_dwordx2 s[6:7], s[0:1], 32
  v_and_b32 v1, 63, v0
  v_lshrrev_b32 v2, 6, v0
  s_and_b32 s33, s2, 7
  s_lshr_b32 s34, s2, 3
  s_lshr_b32 s26, s33, 1
  s_and_b32 s35, s33, 1
  s_lshl_b32 s35, s35, 3
  s_lshr_b32 s24, s34, 2
  s_add_u32 s24, s24, s35
  s_lshl_b32 s24, s24, 7
  s_and_b32 s25, s34, 3
  s_mul_i32 s25, s25, 144
  v_readfirstlane_b32 s27, v2
  s_waitcnt lgkmcnt(0)
  s_add_u32 s12, s4, 0x1800000
  s_addc_u32 s13, s5, 0
  s_mov_b32 s14, 0x1000000
  s_mov_b32 s15, 0x00020000
  s_mov_b32 s16, s6
  s_mov_b32 s17, s7
  s_mov_b32 s18, 0x480000
  s_mov_b32 s19, 0x00020000
  s_add_u32 s20, s4, 0x4000000
  s_addc_u32 s21, s5, 0
  s_mov_b32 s22, 0x900000
  s_mov_b32 s23, 0x00020000
  s_mul_i32 s28, s26, 2048
  s_mul_i32 s29, s26, 1179648
  v_lshrrev_b32 v3, 3, v1
  v_lshrrev_b32 v4, 4, v1
  v_and_b32 v5, 7, v1
  s_lshl_b32 s35, s27, 5
  s_add_u32 s35, s35, s24
  s_mov_b32 s36, 8192
  v_add_u32 v6, 0, v4
  v_and_b32 v6, 7, v6
  v_xor_b32 v6, v6, v5
  v_lshlrev_b32 v6, 4, v6
  v_add_u32 v7, 0, v3
  v_add_u32 v7, s35, v7
  v_mul_lo_u32 v7, v7, s36
  v_add_u32 v8, v7, v6
  v_add_u32 v6, 4, v4
  v_and_b32 v6, 7, v6
  v_xor_b32 v6, v6, v5
  v_lshlrev_b32 v6, 4, v6
  v_add_u32 v7, 8, v3
  v_add_u32 v7, s35, v7
  v_mul_lo_u32 v7, v7, s36
  v_add_u32 v9, v7, v6
  v_add_u32 v6, 8, v4
  v_and_b32 v6, 7, v6
  v_xor_b32 v6, v6, v5
  v_lshlrev_b32 v6, 4, v6
  v_add_u32 v7, 16, v3
  v_add_u32 v7, s35, v7
  v_mul_lo_u32 v7, v7, s36
  v_add_u32 v10, v7, v6
  v_add_u32 v6, 12, v4
  v_and_b32 v6, 7, v6
  v_xor_b32 v6, v6, v5
  v_lshlrev_b32 v6, 4, v6
  v_add_u32 v7, 24, v3
  v_add_u32 v7, s35, v7
  v_mul_lo_u32 v7, v7, s36
  v_add_u32 v11, v7, v6
  s_mov_b32 s36, 1152
  s_lshl_b32 s35, s27, 4
  s_lshl_b32 s37, s25, 1
  v_add_u32 v3, 0, v1
  v_mul_u32_u24 v4, 3277, v3
  v_lshrrev_b32 v4, 16, v4
  v_mul_u32_u24 v5, 20, v4
  v_sub_u32 v5, v3, v5
  v_lshrrev_b32 v6, 3, v4
  v_and_b32 v6, 1, v6
  v_lshlrev_b32 v6, 1, v6
  v_xor_b32 v5, v5, v6
  v_min_u32 v5, 17, v5
  v_lshlrev_b32 v5, 4, v5
  v_add_u32 v4, s35, v4
  v_mul_lo_u32 v4, v4, s36
  v_add3_u32 v12, v4, v5, s37
  v_add_u32 v3, 64, v1
  v_mul_u32_u24 v4, 3277, v3
  v_lshrrev_b32 v4, 16, v4
  v_mul_u32_u24 v5, 20, v4
  v_sub_u32 v5, v3, v5
  v_lshrrev_b32 v6, 3, v4
  v_and_b32 v6, 1, v6
  v_lshlrev_b32 v6, 1, v6
  v_xor_b32 v5, v5, v6
  v_min_u32 v5, 17, v5
  v_lshlrev_b32 v5, 4, v5
  v_add_u32 v4, s35, v4
  v_mul_lo_u32 v4, v4, s36
  v_add3_u32 v13, v4, v5, s37
  v_add_u32 v3, 128, v1
  v_mul_u32_u24 v4, 3277, v3
  v_lshrrev_b32 v4, 16, v4
  v_mul_u32_u24 v5, 20, v4
  v_sub_u32 v5, v3, v5
  v_lshrrev_b32 v6, 3, v4
  v_and_b32 v6, 1, v6
  v_lshlrev_b32 v6, 1, v6
  v_xor_b32 v5, v5, v6
  v_min_u32 v5, 17, v5
  v_lshlrev_b32 v5, 4, v5
  v_add_u32 v4, s35, v4
  v_mul_lo_u32 v4, v4, s36
  v_add3_u32 v14, v4, v5, s37
  v_add_u32 v3, 192, v1
  v_mul_u32_u24 v4, 3277, v3
  v_lshrrev_b32 v4, 16, v4
  v_mul_u32_u24 v5, 20, v4
  v_sub_u32 v5, v3, v5
  v_lshrrev_b32 v6, 3, v4
  v_and_b32 v6, 1, v6
  v_lshlrev_b32 v6, 1, v6
  v_xor_b32 v5, v5, v6
  v_min_u32 v5, 17, v5
  v_lshlrev_b32 v5, 4, v5
  v_add_u32 v4, s35, v4
  v_mul_lo_u32 v4, v4, s36
  v_add3_u32 v15, v4, v5, s37
  v_add_u32 v3, 256, v1
  v_mul_u32_u24 v4, 3277, v3
  v_lshrrev_b32 v4, 16, v4
  v_mul_u32_u24 v5, 20, v4
  v_sub_u32 v5, v3, v5
  v_lshrrev_b32 v6, 3, v4
  v_and_b32 v6, 1, v6
  v_lshlrev_b32 v6, 1, v6
  v_xor_b32 v5, v5, v6
  v_min_u32 v5, 17, v5
  v_lshlrev_b32 v5, 4, v5
  v_add_u32 v4, s35, v4
  v_mul_lo_u32 v4, v4, s36
  v_add3_u32 v16, v4, v5, s37
  s_lshl_b32 s38, s27, 12
  s_mul_i32 s39, s27, 5120
  s_add_u32 s39, s39, 16384
  s_mov_b32 s30, 0
  s_mov_b32 s31, 0
  s_mov_b32 s34, 0
  s_cmp_lt_u32 s34, 16
  s_cselect_b32 s40, s28, 0x40000000
  s_cselect_b32 s41, s29, 0x40000000
  s_add_u32 s42, s30, s38
  s_add_u32 s43, s30, s39
  s_add_u32 m0, s42, 0
  s_nop 0
  buffer_load_dwordx4 v8, s[12:15], s40 offen lds
  s_add_u32 m0, s42, 1024
  s_nop 0
  buffer_load_dwordx4 v9, s[12:15], s40 offen lds
  s_add_u32 m0, s42, 2048
  s_nop 0
  buffer_load_dwordx4 v10, s[12:15], s40 offen lds
  s_add_u32 m0, s42, 3072
  s_nop 0
  buffer_load_dwordx4 v11, s[12:15], s40 offen lds
  s_add_u32 m0, s43, 0
  s_nop 0
  buffer_load_dwordx4 v12, s[16:19], s41 offen lds
  s_add_u32 m0, s43, 1024
  s_nop 0
  buffer_load_dwordx4 v13, s[16:19], s41 offen lds
  s_add_u32 m0, s43, 2048
  s_nop 0
  buffer_load_dwordx4 v14, s[16:19], s41 offen lds
  s_add_u32 m0, s43, 3072
  s_nop 0
  buffer_load_dwordx4 v15, s[16:19], s41 offen lds
  s_add_u32 m0, s43, 4096
  s_nop 0
  buffer_load_dwordx4 v16, s[16:19], s41 offen lds
  s_add_u32 s28, s28, 128
  s_add_u32 s29, s29, 73728
  s_add_u32 s34, s34, 1
  s_add_u32 s30, s30, 36864
  s_cmp_eq_u32 s30, 110592
  s_cselect_b32 s30, 0, s30
  s_cmp_lt_u32 s34, 16
  s_cselect_b32 s40, s28, 0x40000000
  s_cselect_b32 s41, s29, 0x40000000
  s_add_u32 s42, s30, s38
  s_add_u32 s43, s30, s39
  s_add_u32 m0, s42, 0
  s_nop 0
  buffer_load_dwordx4 v8, s[12:15], s40 offen lds
  s_add_u32 m0, s42, 1024
  s_nop 0
  buffer_load_dwordx4 v9, s[12:15], s40 offen lds
  s_add_u32 m0, s42, 2048
  s_nop 0
  buffer_load_dwordx4 v10, s[12:15], s40 offen lds
  s_add_u32 m0, s42, 3072
  s_nop 0
  buffer_load_dwordx4 v11, s[12:15], s40 offen lds
  s_add_u32 m0, s43, 0
  s_nop 0
  buffer_load_dwordx4 v12, s[16:19], s41 offen lds
  s_add_u32 m0, s43, 1024
  s_nop 0
  buffer_load_dwordx4 v13, s[16:19], s41 offen lds
  s_add_u32 m0, s43, 2048
  s_nop 0
  buffer_load_dwordx4 v14, s[16:19], s41 offen lds
  s_add_u32 m0, s43, 3072
  s_nop 0
  buffer_load_dwordx4 v15, s[16:19], s41 offen lds
  s_add_u32 m0, s43, 4096
  s_nop 0
  buffer_load_dwordx4 v16, s[16:19], s41 offen lds
  s_add_u32 s28, s28, 128
  s_add_u32 s29, s29, 73728
  s_add_u32 s34, s34, 1
  s_add_u32 s30, s30, 36864
  s_cmp_eq_u32 s30, 110592
  s_cselect_b32 s30, 0, s30
  s_cmp_lt_u32 s34, 16
  s_cselect_b32 s40, s28, 0x40000000
  s_cselect_b32 s41, s29, 0x40000000
  s_add_u32 s42, s30, s38
  s_add_u32 s43, s30, s39
  s_add_u32 m0, s42, 0
  s_nop 0
  buffer_load_dwordx4 v8, s[12:15], s40 offen lds
  s_add_u32 m0, s42, 1024
  s_nop 0
  buffer_load_dwordx4 v9, s[12:15], s40 offen lds
  s_add_u32 m0, s42, 2048
  s_nop 0
  buffer_load_dwordx4 v10, s[12:15], s40 offen lds
  s_add_u32 m0, s42, 3072
  s_nop 0
  buffer_load_dwordx4 v11, s[12:15], s40 offen lds
  v_and_b32 v3, 15, v1
  v_lshrrev_b32 v4, 4, v1
  v_lshrrev_b32 v5, 1, v3
  s_lshl_b32 s35, s27, 5
  v_add_u32 v6, s35, v3
  v_lshlrev_b32 v6, 7, v6
  v_add_u32 v7, 0, v4
  v_xor_b32 v7, v7, v5
  v_lshlrev_b32 v7, 4, v7
  v_add_u32 v22, v6, v7
  v_add_u32 v7, 4, v4
  v_xor_b32 v7, v7, v5
  v_lshlrev_b32 v7, 4, v7
  v_add_u32 v23, v6, v7
  v_lshrrev_b32 v5, 2, v3
  v_and_b32 v6, 3, v3
  v_lshlrev_b32 v7, 3, v4
  v_add_u32 v7, v7, v5
  v_mul_u32_u24 v7, 320, v7
  v_lshlrev_b32 v6, 3, v6
  v_add_u32 v7, v7, v6
  v_add_u32 v7, 16384, v7
  v_and_b32 v4, 1, v4
  v_lshlrev_b32 v4, 5, v4
  v_add_u32 v24, v7, v4
  v_sub_u32 v25, v7, v4
  v_mov_b32 v26, v22
  v_mov_b32 v27, v23
  v_mov_b32 v28, v24
  v_mov_b32 v29, v25
  v_accvgpr_write_b32 a0, 0
  v_accvgpr_write_b32 a1, 0
  v_accvgpr_write_b32 a2, 0
  v_accvgpr_write_b32 a3, 0
  v_accvgpr_write_b32 a4, 0
  v_accvgpr_write_b32 a5, 0
  v_accvgpr_write_b32 a6, 0
  v_accvgpr_write_b32 a7, 0
  v_accvgpr_write_b32 a8, 0
  v_accvgpr_write_b32 a9, 0
  v_accvgpr_write_b32 a10, 0
  v_accvgpr_write_b32 a11, 0
  v_accvgpr_write_b32 a12, 0
  v_accvgpr_write_b32 a13, 0
  v_accvgpr_write_b32 a14, 0
  v_accvgpr_write_b32 a15, 0
  v_accvgpr_write_b32 a16, 0
  v_accvgpr_write_b32 a17, 0
  v_accvgpr_write_b32 a18, 0
  v_accvgpr_write_b32 a19, 0
  v_accvgpr_write_b32 a20, 0
  v_accvgpr_write_b32 a21, 0
  v_accvgpr_write_b32 a22, 0
  v_accvgpr_write_b32 a23, 0
  v_accvgpr_write_b32 a24, 0
  v_accvgpr_write_b32 a25, 0
  v_accvgpr_write_b32 a26, 0
  v_accvgpr_write_b32 a27, 0
  v_accvgpr_write_b32 a28, 0
  v_accvgpr_write_b32 a29, 0
  v_accvgpr_write_b32 a30, 0
  v_accvgpr_write_b32 a31, 0
  v_accvgpr_write_b32 a32, 0
  v_accvgpr_write_b32 a33, 0
  v_accvgpr_write_b32 a34, 0
  v_accvgpr_write_b32 a35, 0
  v_accvgpr_write_b32 a36, 0
  v_accvgpr_write_b32 a37, 0
  v_accvgpr_write_b32 a38, 0
  v_accvgpr_write_b32 a39, 0
  v_accvgpr_write_b32 a40, 0
  v_accvgpr_write_b32 a41, 0
  v_accvgpr_write_b32 a42, 0
  v_accvgpr_write_b32 a43, 0
  v_accvgpr_write_b32 a44, 0
  v_accvgpr_write_b32 a45, 0
  v_accvgpr_write_b32 a46, 0
  v_accvgpr_write_b32 a47, 0
  v_accvgpr_write_b32 a48, 0
  v_accvgpr_write_b32 a49, 0
  v_accvgpr_write_b32 a50, 0
  v_accvgpr_write_b32 a51, 0
  v_accvgpr_write_b32 a52, 0
  v_accvgpr_write_b32 a53, 0
  v_accvgpr_write_b32 a54, 0
  v_accvgpr_write_b32 a55, 0
  v_accvgpr_write_b32 a56, 0
  v_accvgpr_write_b32 a57, 0
  v_accvgpr_write_b32 a58, 0
  v_accvgpr_write_b32 a59, 0
  v_accvgpr_write_b32 a60, 0
  v_accvgpr_write_b32 a61, 0
  v_accvgpr_write_b32 a62, 0
  v_accvgpr_write_b32 a63, 0
  v_accvgpr_write_b32 a64, 0
  v_accvgpr_write_b32 a65, 0
  v_accvgpr_write_b32 a66, 0
  v_accvgpr_write_b32 a67, 0
  v_accvgpr_write_b32 a68, 0
  v_accvgpr_write_b32 a69, 0
  v_accvgpr_write_b32 a70, 0
  v_accvgpr_write_b32 a71, 0
  s_waitcnt vmcnt(13)
  s_barrier
  ds_read_b128 v[32:35], v26 offset:0
  ds_read_b128 v[36:39], v26 offset:2048
  ds_read_b64_tr_b16 v[48:49], v28 offset:0
  ds_read_b64_tr_b16 v[50:51], v28 offset:1280
  ds_read_b64_tr_b16 v[52:53], v29 offset:32
  ds_read_b64_tr_b16 v[54:55], v29 offset:1312
  ds_read_b64_tr_b16 v[56:57], v28 offset:64
  ds_read_b64_tr_b16 v[58:59], v28 offset:1344
  ds_read_b64_tr_b16 v[60:61], v29 offset:96
  ds_read_b64_tr_b16 v[62:63], v29 offset:1376
  ds_read_b64_tr_b16 v[64:65], v28 offset:128
  ds_read_b64_tr_b16 v[66:67], v28 offset:1408
  ds_read_b64_tr_b16 v[68:69], v29 offset:160
  ds_read_b64_tr_b16 v[70:71], v29 offset:1440
  ds_read_b64_tr_b16 v[72:73], v28 offset:192
  ds_read_b64_tr_b16 v[74:75], v28 offset:1472
  ds_read_b64_tr_b16 v[76:77], v29 offset:224
  ds_read_b64_tr_b16 v[78:79], v29 offset:1504
  ds_read_b64_tr_b16 v[80:81], v28 offset:256
  ds_read_b64_tr_b16 v[82:83], v28 offset:1536
  s_mov_b32 s32, 16
g_loop_38:
  s_waitcnt lgkmcnt(0)
  v_mfma_f32_16x16x32_bf16 a[0:3], v[48:51], v[32:35], a[0:3]
  ds_read_b128 v[40:43], v27 offset:0
  ds_read_b128 v[44:47], v27 offset:2048
  v_mfma_f32_16x16x32_bf16 a[4:7], v[48:51], v[36:39], a[4:7]
  s_add_u32 m0, s43, 0
  s_nop 0
  buffer_load_dwordx4 v12, s[16:19], s41 offen lds
  v_mfma_f32_16x16x32_bf16 a[8:11], v[52:55], v[32:35], a[8:11]
  ds_read_b64_tr_b16 v[84:85], v28 offset:10240
  ds_read_b64_tr_b16 v[86:87], v28 offset:11520
  v_mfma_f32_16x16x32_bf16 a[12:15], v[52:55], v[36:39], a[12:15]
  ds_read_b64_tr_b16 v[88:89], v29 offset:10272
  ds_read_b64_tr_b16 v[90:91], v29 offset:11552
  v_mfma_f32_16x16x32_bf16 a[16:19], v[56:59], v[32:35], a[16:19]
  ds_read_b64_tr_b16 v[92:93], v28 offset:10304
  ds_read_b64_tr_b16 v[94:95], v28 offset:11584
  v_mfma_f32_16x16x32_bf16 a[20:23], v[56:59], v[36:39], a[20:23]
  s_add_u32 m0, s43, 1024
  s_nop 0
  buffer_load_dwordx4 v13, s[16:19], s41 offen lds
  v_mfma_f32_16x16x32_bf16 a[24:27], v[60:63], v[32:35], a[24:27]
  ds_read_b64_tr_b16 v[96:97], v29 offset:10336
  ds_read_b64_tr_b16 v[98:99], v29 offset:11616
  v_mfma_f32_16x16x32_bf16 a[28:31], v[60:63], v[36:39], a[28:31]
  ds_read_b64_tr_b16 v[100:101], v28 offset:10368
  ds_read_b64_tr_b16 v[102:103], v28 offset:11648
  v_mfma_f32_16x16x32_bf16 a[32:35], v[64:67], v[32:35], a[32:35]
  ds_read_b64_tr_b16 v[104:105], v29 offset:10400
  ds_read_b64_tr_b16 v[106:107], v29 offset:11680
  v_mfma_f32_16x16x32_bf16 a[36:39], v[64:67], v[36:39], a[36:39]
  s_add_u32 m0, s43, 2048
  s_nop 0
  buffer_load_dwordx4 v14, s[16:19], s41 offen lds
  v_mfma_f32_16x16x32_bf16 a[40:43], v[68:71], v[32:35], a[40:43]
  ds_read_b64_tr_b16 v[108:109], v28 offset:10432
  ds_read_b64_tr_b16 v[110:111], v28 offset:11712
  v_mfma_f32_16x16x32_bf16 a[44:47], v[68:71], v[36:39], a[44:47]
  ds_read_b64_tr_b16 v[112:113], v29 offset:10464
  ds_read_b64_tr_b16 v[114:115], v29 offset:11744
  v_mfma_f32_16x16x32_bf16 a[48:51], v[72:75], v[32:35], a[48:51]
  s_add_u32 m0, s43, 3072
  s_nop 0
  buffer_load_dwordx4 v15, s[16:19], s41 offen lds
  v_mfma_f32_16x16x32_bf16 a[52:55], v[72:75], v[36:39], a[52:55]
  ds_read_b64_tr_b16 v[116:117], v28 offset:10496
  ds_read_b64_tr_b16 v[118:119], v28 offset:11776
  v_mfma_f32_16x16x32_bf16 a[56:59], v[76:79], v[32:35], a[56:59]
  v_mfma_f32_16x16x32_bf16 a[60:63], v[76:79], v[36:39], a[60:63]
  v_mfma_f32_16x16x32_bf16 a[64:67], v[80:83], v[32:35], a[64:67]
  s_add_u32 m0, s43, 4096
  s_nop 0
  buffer_load_dwordx4 v16, s[16:19], s41 offen lds
  s_add_u32 s28, s28, 128
  s_add_u32 s29, s29, 73728
  s_add_u32 s34, s34, 1
  s_add_u32 s30, s30, 36864
  s_cmp_eq_u32 s30, 110592
  s_cselect_b32 s30, 0, s30
  v_mfma_f32_16x16x32_bf16 a[68:71], v[80:83], v[36:39], a[68:71]
  s_waitcnt vmcnt(9) lgkmcnt(0)
  s_barrier
  s_add_u32 s31, s31, 36864
  s_cmp_eq_u32 s31, 110592
  s_cselect_b32 s31, 0, s31
  v_add_u32 v26, s31, v22
  v_add_u32 v27, s31, v23
  v_add_u32 v28, s31, v24
  v_add_u32 v29, s31, v25
  v_mfma_f32_16x16x32_bf16 a[0:3], v[84:87], v[40:43], a[0:3]
  ds_read_b128 v[32:35], v26 offset:0
  ds_read_b128 v[36:39], v26 offset:2048
  v_mfma_f32_16x16x32_bf16 a[4:7], v[84:87], v[44:47], a[4:7]
  ds_read_b64_tr_b16 v[48:49], v28 offset:0
  ds_read_b64_tr_b16 v[50:51], v28 offset:1280
  v_mfma_f32_16x16x32_bf16 a[8:11], v[88:91], v[40:43], a[8:11]
  s_cmp_lt_u32 s34, 16
  s_cselect_b32 s40, s28, 0x40000000
  s_cselect_b32 s41, s29, 0x40000000
  s_add_u32 s42, s30, s38
  s_add_u32 s43, s30, s39
  s_add_u32 m0, s42, 0
  s_nop 0
  buffer_load_dwordx4 v8, s[12:15], s40 offen lds
  v_mfma_f32_16x16x32_bf16 a[12:15], v[88:91], v[44:47], a[12:15]
  ds_read_b64_tr_b16 v[52:53], v29 offset:32
  ds_read_b64_tr_b16 v[54:55], v29 offset:1312
  v_mfma_f32_16x16x32_bf16 a[16:19], v[92:95], v[40:43], a[16:19]
  ds_read_b64_tr_b16 v[56:57], v28 offset:64
  ds_read_b64_tr_b16 v[58:59], v28 offset:1344
  v_mfma_f32_16x16x32_bf16 a[20:23], v[92:95], v[44:47], a[20:23]
  ds_read_b64_tr_b16 v[60:61], v29 offset:96
  ds_read_b64_tr_b16 v[62:63], v29 offset:1376
  v_mfma_f32_16x16x32_bf16 a[24:27], v[96:99], v[40:43], a[24:27]
  s_add_u32 m0, s42, 1024
  s_nop 0
  buffer_load_dwordx4 v9, s[12:15], s40 offen lds
  v_mfma_f32_16x16x32_bf16 a[28:31], v[96:99], v[44:47], a[28:31]
  ds_read_b64_tr_b16 v[64:65], v28 offset:128
  ds_read_b64_tr_b16 v[66:67], v28 offset:1408
  v_mfma_f32_16x16x32_bf16 a[32:35], v[100:103], v[40:43], a[32:35]
  ds_read_b64_tr_b16 v[68:69], v29 offset:160
  ds_read_b64_tr_b16 v[70:71], v29 offset:1440
  v_mfma_f32_16x16x32_bf16 a[36:39], v[100:103], v[44:47], a[36:39]
  ds_read_b64_tr_b16 v[72:73], v28 offset:192
  ds_read_b64_tr_b16 v[74:75], v28 offset:1472
  v_mfma_f32_16x16x32_bf16 a[40:43], v[104:107], v[40:43], a[40:43]
  ds_read_b64_tr_b16 v[76:77], v29 offset:224
  ds_read_b64_tr_b16 v[78:79], v29 offset:1504
  v_mfma_f32_16x16x32_bf16 a[44:47], v[104:107], v[44:47], a[44:47]
  s_add_u32 m0, s42, 2048
  s_nop 0
  buffer_load_dwordx4 v10, s[12:15], s40 offen lds
  v_mfma_f32_16x16x32_bf16 a[48:51], v[108:111], v[40:43], a[48:51]
  ds_read_b64_tr_b16 v[80:81], v28 offset:256
  ds_read_b64_tr_b16 v[82:83], v28 offset:1536
  v_mfma_f32_16x16x32_bf16 a[52:55], v[108:111], v[44:47], a[52:55]
  v_mfma_f32_16x16x32_bf16 a[56:59], v[112:115], v[40:43], a[56:59]
  v_mfma_f32_16x16x32_bf16 a[60:63], v[112:115], v[44:47], a[60:63]
  s_add_u32 m0, s42, 3072
  s_nop 0
  buffer_load_dwordx4 v11, s[12:15], s40 offen lds
  v_mfma_f32_16x16x32_bf16 a[64:67], v[116:119], v[40:43], a[64:67]
  v_mfma_f32_16x16x32_bf16 a[68:71], v[116:119], v[44:47], a[68:71]
  s_sub_u32 s32, s32, 1
  s_cmp_lg_u32 s32, 0
  s_cbranch_scc1 g_loop_38
  s_waitcnt vmcnt(0) lgkmcnt(0)
  s_nop 7
  s_nop 7
  v_and_b32 v3, 15, v1
  v_lshrrev_b32 v4, 4, v1
  s_lshl_b32 s35, s27, 5
  s_add_u32 s35, s35, s24
  v_add_u32 v3, s35, v3
  v_lshlrev_b32 v4, 2, v4
  v_add_u32 v4, s25, v4
  s_barrier
  v_and_b32 v5, 15, v1
  v_lshrrev_b32 v6, 4, v1
  v_mul_u32_u24 v5, 304, v5
  v_lshlrev_b32 v6, 3, v6
  s_mul_i32 s36, s27, 9728
  v_add3_u32 v5, v5, v6, s36
  s_mul_i32 s38, s26, 2359296
  s_lshl_b32 s37, s25, 1
  s_add_u32 s37, s37, s38
  s_movk_i32 s39, 1152
  v_lshrrev_b32 v11, 4, v1
  v_and_b32 v6, 15, v1
  v_lshlrev_b32 v6, 4, v6
  v_mul_u32_u24 v7, 304, v11
  v_add3_u32 v7, v7, v6, s36
  v_add_u32 v11, s35, v11
  v_mul_lo_u32 v11, v11, s39
  v_add3_u32 v11, v11, v6, s37
  v_lshrrev_b32 v8, 1, v1
  v_and_b32 v9, 1, v1
  v_lshlrev_b32 v9, 4, v9
  v_add_u32 v9, 256, v9
  v_mul_u32_u24 v10, 304, v8
  v_add3_u32 v10, v10, v9, s36
  v_add_u32 v8, s35, v8
  v_mul_lo_u32 v8, v8, s39
  v_add3_u32 v8, v8, v9, s37
  v_accvgpr_read_b32 v32, a0
  v_accvgpr_read_b32 v33, a1
  v_accvgpr_read_b32 v34, a2
  v_accvgpr_read_b32 v35, a3
  v_cvt_pk_bf16_f32 v40, v32, v33
  v_cvt_pk_bf16_f32 v41, v34, v35
  ds_write_b64 v5, v[40:41] offset:0
  v_accvgpr_read_b32 v44, a8
  v_accvgpr_read_b32 v45, a9
  v_accvgpr_read_b32 v46, a10
  v_accvgpr_read_b32 v47, a11
  v_cvt_pk_bf16_f32 v52, v44, v45
  v_cvt_pk_bf16_f32 v53, v46, v47
  ds_write_b64 v5, v[52:53] offset:32
  v_accvgpr_read_b32 v56, a16
  v_accvgpr_read_b32 v57, a17
  v_accvgpr_read_b32 v58, a18
  v_accvgpr_read_b32 v59, a19
  v_cvt_pk_bf16_f32 v64, v56, v57
  v_cvt_pk_bf16_f32 v65, v58, v59
  ds_write_b64 v5, v[64:65] offset:64
  v_accvgpr_read_b32 v68, a24
  v_accvgpr_read_b32 v69, a25
  v_accvgpr_read_b32 v70, a26
  v_accvgpr_read_b32 v71, a27
  v_cvt_pk_bf16_f32 v76, v68, v69
  v_cvt_pk_bf16_f32 v77, v70, v71
  ds_write_b64 v5, v[76:77] offset:96
  v_accvgpr_read_b32 v80, a32
  v_accvgpr_read_b32 v81, a33
  v_accvgpr_read_b32 v82, a34
  v_accvgpr_read_b32 v83, a35
  v_cvt_pk_bf16_f32 v88, v80, v81
  v_cvt_pk_bf16_f32 v89, v82, v83
  ds_write_b64 v5, v[88:89] offset:128
  v_accvgpr_read_b32 v92, a40
  v_accvgpr_read_b32 v93, a41
  v_accvgpr_read_b32 v94, a42
  v_accvgpr_read_b32 v95, a43
  v_cvt_pk_bf16_f32 v100, v92, v93
  v_cvt_pk_bf16_f32 v101, v94, v95
  ds_write_b64 v5, v[100:101] offset:160
  v_accvgpr_read_b32 v104, a48
  v_accvgpr_read_b32 v105, a49
  v_accvgpr_read_b32 v106, a50
  v_accvgpr_read_b32 v107, a51
  v_cvt_pk_bf16_f32 v112, v104, v105
  v_cvt_pk_bf16_f32 v113, v106, v107
  ds_write_b64 v5, v[112:113] offset:192
  v_accvgpr_read_b32 v116, a56
  v_accvgpr_read_b32 v117, a57
  v_accvgpr_read_b32 v118, a58
  v_accvgpr_read_b32 v119, a59
  v_cvt_pk_bf16_f32 v124, v116, v117
  v_cvt_pk_bf16_f32 v125, v118, v119
  ds_write_b64 v5, v[124:125] offset:224
  v_accvgpr_read_b32 v32, a64
  v_accvgpr_read_b32 v33, a65
  v_accvgpr_read_b32 v34, a66
  v_accvgpr_read_b32 v35, a67
  v_cvt_pk_bf16_f32 v40, v32, v33
  v_cvt_pk_bf16_f32 v41, v34, v35
  ds_write_b64 v5, v[40:41] offset:256
  v_accvgpr_read_b32 v32, a4
  v_accvgpr_read_b32 v33, a5
  v_accvgpr_read_b32 v34, a6
  v_accvgpr_read_b32 v35, a7
  v_cvt_pk_bf16_f32 v40, v32, v33
  v_cvt_pk_bf16_f32 v41, v34, v35
  ds_write_b64 v5, v[40:41] offset:4864
  v_accvgpr_read_b32 v44, a12
  v_accvgpr_read_b32 v45, a13
  v_accvgpr_read_b32 v46, a14
  v_accvgpr_read_b32 v47, a15
  v_cvt_pk_bf16_f32 v52, v44, v45
  v_cvt_pk_bf16_f32 v53, v46, v47
  ds_write_b64 v5, v[52:53] offset:4896
  v_accvgpr_read_b32 v56, a20
  v_accvgpr_read_b32 v57, a21
  v_accvgpr_read_b32 v58, a22
  v_accvgpr_read_b32 v59, a23
  v_cvt_pk_bf16_f32 v64, v56, v57
  v_cvt_pk_bf16_f32 v65, v58, v59
  ds_write_b64 v5, v[64:65] offset:4928
  v_accvgpr_read_b32 v68, a28
  v_accvgpr_read_b32 v69, a29
  v_accvgpr_read_b32 v70, a30
  v_accvgpr_read_b32 v71, a31
  v_cvt_pk_bf16_f32 v76, v68, v69
  v_cvt_pk_bf16_f32 v77, v70, v71
  ds_write_b64 v5, v[76:77] offset:4960
  v_accvgpr_read_b32 v80, a36
  v_accvgpr_read_b32 v81, a37
  v_accvgpr_read_b32 v82, a38
  v_accvgpr_read_b32 v83, a39
  v_cvt_pk_bf16_f32 v88, v80, v81
  v_cvt_pk_bf16_f32 v89, v82, v83
  ds_write_b64 v5, v[88:89] offset:4992
  v_accvgpr_read_b32 v92, a44
  v_accvgpr_read_b32 v93, a45
  v_accvgpr_read_b32 v94, a46
  v_accvgpr_read_b32 v95, a47
  v_cvt_pk_bf16_f32 v100, v92, v93
  v_cvt_pk_bf16_f32 v101, v94, v95
  ds_write_b64 v5, v[100:101] offset:5024
  v_accvgpr_read_b32 v104, a52
  v_accvgpr_read_b32 v105, a53
  v_accvgpr_read_b32 v106, a54
  v_accvgpr_read_b32 v107, a55
  v_cvt_pk_bf16_f32 v112, v104, v105
  v_cvt_pk_bf16_f32 v113, v106, v107
  ds_write_b64 v5, v[112:113] offset:5056
  v_accvgpr_read_b32 v116, a60
  v_accvgpr_read_b32 v117, a61
  v_accvgpr_read_b32 v118, a62
  v_accvgpr_read_b32 v119, a63
  v_cvt_pk_bf16_f32 v124, v116, v117
  v_cvt_pk_bf16_f32 v125, v118, v119
  ds_write_b64 v5, v[124:125] offset:5088
  v_accvgpr_read_b32 v32, a68
  v_accvgpr_read_b32 v33, a69
  v_accvgpr_read_b32 v34, a70
  v_accvgpr_read_b32 v35, a71
  v_cvt_pk_bf16_f32 v40, v32, v33
  v_cvt_pk_bf16_f32 v41, v34, v35
  ds_write_b64 v5, v[40:41] offset:5120
  s_waitcnt lgkmcnt(0)
  ds_read_b128 v[128:131], v7 offset:0
  ds_read_b128 v[132:135], v7 offset:1216
  ds_read_b128 v[136:139], v7 offset:2432
  ds_read_b128 v[140:143], v7 offset:3648
  ds_read_b128 v[144:147], v7 offset:4864
  ds_read_b128 v[148:151], v7 offset:6080
  ds_read_b128 v[152:155], v7 offset:7296
  ds_read_b128 v[156:159], v7 offset:8512
  ds_read_b128 v[160:163], v10
  s_mov_b32 s40, 0
  s_waitcnt lgkmcnt(8)
  buffer_store_dwordx4 v[128:131], v11, s[20:23], s40 offen
  s_mov_b32 s40, 4608
  s_waitcnt lgkmcnt(7)
  buffer_store_dwordx4 v[132:135], v11, s[20:23], s40 offen
  s_mov_b32 s40, 9216
  s_waitcnt lgkmcnt(6)
  buffer_store_dwordx4 v[136:139], v11, s[20:23], s40 offen
  s_mov_b32 s40, 13824
  s_waitcnt lgkmcnt(5)
  buffer_store_dwordx4 v[140:143], v11, s[20:23], s40 offen
  s_mov_b32 s40, 18432
  s_waitcnt lgkmcnt(4)
  buffer_store_dwordx4 v[144:147], v11, s[20:23], s40 offen
  s_mov_b32 s40, 23040
  s_waitcnt lgkmcnt(3)
  buffer_store_dwordx4 v[148:151], v11, s[20:23], s40 offen
  s_mov_b32 s40, 27648
  s_waitcnt lgkmcnt(2)
  buffer_store_dwordx4 v[152:155], v11, s[20:23], s40 offen
  s_mov_b32 s40, 32256
  s_waitcnt lgkmcnt(1)
  buffer_store_dwordx4 v[156:159], v11, s[20:23], s40 offen
  s_waitcnt lgkmcnt(0)
  buffer_store_dwordx4 v[160:163], v8, s[20:23], 0 offen
g_end_37:
  s_endpgm
.text
.globl ln2_kernel
.p2align 8
.type ln2_kernel,@function
ln2_kernel:
  s_cmp_ge_u32 s2, 256
  s_cbranch_scc1 ln_end_39
  s_load_dwordx2 s[4:5], s[0:1], 0
  s_load_dwordx2 s[6:7], s[0:1], 96
  s_load_dwordx2 s[8:9], s[0:1], 80
  v_lshrrev_b32 v1, 5, v0
  s_lshl_b32 s3, s2, 3
  v_add_u32 v1, s3, v1
  v_and_b32 v2, 31, v0
  v_lshlrev_b32 v2, 2, v2
  s_movk_i32 s10, 1152
  v_mul_lo_u32 v3, v1, s10
  v_add_u32 v3, v3, v2
  v_lshlrev_b32 v4, 1, v3
  s_waitcnt lgkmcnt(0)
  s_mov_b32 s12, s6
  s_mov_b32 s13, s7
  s_mov_b32 s14, 0x1b00
  s_mov_b32 s15, 0x00020000
  s_mov_b32 s16, s4
  s_mov_b32 s17, s5
  s_mov_b32 s18, 0x240000
  s_mov_b32 s19, 0x00020000
  s_add_u32 s20, s6, 0x490000
  s_addc_u32 s21, s7, 0
  s_mov_b32 s22, 0x240000
  s_mov_b32 s23, 0x00020000
  s_add_u32 s24, s6, 0x250000
  s_addc_u32 s25, s7, 0
  s_mov_b32 s26, 0x240000
  s_mov_b32 s27, 0x00020000
  s_add_u32 s28, s6, 0x4000000
  s_addc_u32 s29, s7, 0
  s_mov_b32 s30, 0x900000
  s_mov_b32 s31, 0x00020000
  buffer_load_dword v10, v3, s[16:19], 0 offen offset:0
  buffer_load_dword v11, v3, s[16:19], 0 offen offset:128
  buffer_load_dword v12, v3, s[16:19], 0 offen offset:256
  buffer_load_dword v13, v3, s[16:19], 0 offen offset:384
  buffer_load_dword v14, v3, s[16:19], 0 offen offset:512
  buffer_load_dword v15, v3, s[16:19], 0 offen offset:640
  buffer_load_dword v16, v3, s[16:19], 0 offen offset:768
  buffer_load_dword v17, v3, s[16:19], 0 offen offset:896
  buffer_load_dword v18, v3, s[16:19], 0 offen offset:1024
  s_movk_i32 s11, 4608
  buffer_load_dword v20, v2, s[12:15], s11 offen offset:0
  buffer_load_dword v21, v2, s[12:15], s11 offen offset:128
  buffer_load_dword v22, v2, s[12:15], s11 offen offset:256
  buffer_load_dword v23, v2, s[12:15], s11 offen offset:384
  buffer_load_dword v24, v2, s[12:15], s11 offen offset:512
  buffer_load_dword v25, v2, s[12:15], s11 offen offset:640
  buffer_load_dword v26, v2, s[12:15], s11 offen offset:768
  buffer_load_dword v27, v2, s[12:15], s11 offen offset:896
  buffer_load_dword v28, v2, s[12:15], s11 offen offset:1024
  s_movk_i32 s11, 3456
  buffer_load_dword v30, v2, s[12:15], s11 offen offset:0
  buffer_load_dword v31, v2, s[12:15], s11 offen offset:128
  buffer_load_dword v32, v2, s[12:15], s11 offen offset:256
  buffer_load_dword v33, v2, s[12:15], s11 offen offset:384
  buffer_load_dword v34, v2, s[12:15], s11 offen offset:512
  buffer_load_dword v35, v2, s[12:15], s11 offen offset:640
  buffer_load_dword v36, v2, s[12:15], s11 offen offset:768
  buffer_load_dword v37, v2, s[12:15], s11 offen offset:896
  buffer_load_dword v38, v2, s[12:15], s11 offen offset:1024
  s_movk_i32 s11, 2304
  buffer_load_dword v40, v2, s[12:15], s11 offen offset:0
  buffer_load_dword v41, v2, s[12:15], s11 offen offset:128
  buffer_load_dword v42, v2, s[12:15], s11 offen offset:256
  buffer_load_dword v43, v2, s[12:15], s11 offen offset:384
  buffer_load_dword v44, v2, s[12:15], s11 offen offset:512
  buffer_load_dword v45, v2, s[12:15], s11 offen offset:640
  buffer_load_dword v46, v2, s[12:15], s11 offen offset:768
  buffer_load_dword v47, v2, s[12:15], s11 offen offset:896
  buffer_load_dword v48, v2, s[12:15], s11 offen offset:1024
  s_mov_b32 s11, 0x0
  buffer_load_dword v80, v3, s[28:31], s11 offen offset:0
  buffer_load_dword v82, v3, s[28:31], s11 offen offset:128
  buffer_load_dword v84, v3, s[28:31], s11 offen offset:256
  buffer_load_dword v86, v3, s[28:31], s11 offen offset:384
  buffer_load_dword v88, v3, s[28:31], s11 offen offset:512
  buffer_load_dword v90, v3, s[28:31], s11 offen offset:640
  buffer_load_dword v92, v3, s[28:31], s11 offen offset:768
  buffer_load_dword v94, v3, s[28:31], s11 offen offset:896
  buffer_load_dword v96, v3, s[28:31], s11 offen offset:1024
  s_mov_b32 s11, 0x240000
  buffer_load_dword v98, v3, s[28:31], s11 offen offset:0
  buffer_load_dword v100, v3, s[28:31], s11 offen offset:128
  buffer_load_dword v102, v3, s[28:31], s11 offen offset:256
  buffer_load_dword v104, v3, s[28:31], s11 offen offset:384
  buffer_load_dword v106, v3, s[28:31], s11 offen offset:512
  buffer_load_dword v108, v3, s[28:31], s11 offen offset:640
  buffer_load_dword v110, v3, s[28:31], s11 offen offset:768
  buffer_load_dword v112, v3, s[28:31], s11 offen offset:896
  buffer_load_dword v114, v3, s[28:31], s11 offen offset:1024
  s_mov_b32 s11, 0x480000
  buffer_load_dword v116, v3, s[28:31], s11 offen offset:0
  buffer_load_dword v118, v3, s[28:31], s11 offen offset:128
  buffer_load_dword v120, v3, s[28:31], s11 offen offset:256
  buffer_load_dword v122, v3, s[28:31], s11 offen offset:384
  buffer_load_dword v124, v3, s[28:31], s11 offen offset:512
  buffer_load_dword v126, v3, s[28:31], s11 offen offset:640
  buffer_load_dword v128, v3, s[28:31], s11 offen offset:768
  buffer_load_dword v130, v3, s[28:31], s11 offen offset:896
  buffer_load_dword v132, v3, s[28:31], s11 offen offset:1024
  s_mov_b32 s11, 0x6c0000
  buffer_load_dword v134, v3, s[28:31], s11 offen offset:0
  buffer_load_dword v136, v3, s[28:31], s11 offen offset:128
  buffer_load_dword v138, v3, s[28:31], s11 offen offset:256
  buffer_load_dword v140, v3, s[28:31], s11 offen offset:384
  buffer_load_dword v142, v3, s[28:31], s11 offen offset:512
  buffer_load_dword v144, v3, s[28:31], s11 offen offset:640
  buffer_load_dword v146, v3, s[28:31], s11 offen offset:768
  buffer_load_dword v148, v3, s[28:31], s11 offen offset:896
  buffer_load_dword v150, v3, s[28:31], s11 offen offset:1024
  s_waitcnt vmcnt(0)
  v_lshlrev_b32 v60, 16, v10
  v_and_b32 v61, 0xffff0000, v10
  v_lshlrev_b32 v62, 16, v11
  v_and_b32 v63, 0xffff0000, v11
  v_lshlrev_b32 v64, 16, v12
  v_and_b32 v65, 0xffff0000, v12
  v_lshlrev_b32 v66, 16, v13
  v_and_b32 v67, 0xffff0000, v13
  v_lshlrev_b32 v68, 16, v14
  v_and_b32 v69, 0xffff0000, v14
  v_lshlrev_b32 v70, 16, v15
  v_and_b32 v71, 0xffff0000, v15
  v_lshlrev_b32 v72, 16, v16
  v_and_b32 v73, 0xffff0000, v16
  v_lshlrev_b32 v74, 16, v17
  v_and_b32 v75, 0xffff0000, v17
  v_lshlrev_b32 v76, 16, v18
  v_and_b32 v77, 0xffff0000, v18
  v_and_b32 v81, 0xffff0000, v80
  v_lshlrev_b32 v80, 16, v80
  v_and_b32 v99, 0xffff0000, v98
  v_lshlrev_b32 v98, 16, v98
  v_and_b32 v117, 0xffff0000, v116
  v_lshlrev_b32 v116, 16, v116
  v_and_b32 v135, 0xffff0000, v134
  v_lshlrev_b32 v134, 16, v134
  v_add_f32 v80, v80, v98
  v_add_f32 v81, v81, v99
  v_add_f32 v80, v80, v116
  v_add_f32 v81, v81, v117
  v_add_f32 v80, v80, v134
  v_add_f32 v81, v81, v135
  v_cvt_pk_bf16_f32 v5, v80, v81
  v_lshlrev_b32 v80, 16, v5
  v_and_b32 v81, 0xffff0000, v5
  v_lshlrev_b32 v6, 16, v40
  v_and_b32 v7, 0xffff0000, v40
  v_mul_f32 v80, v80, v6
  v_mul_f32 v81, v81, v7
  v_cvt_pk_bf16_f32 v5, v80, v81
  v_lshlrev_b32 v80, 16, v5
  v_and_b32 v81, 0xffff0000, v5
  v_add_f32 v60, v60, v80
  v_add_f32 v61, v61, v81
  v_cvt_pk_bf16_f32 v10, v60, v61
  v_lshlrev_b32 v60, 16, v10
  v_and_b32 v61, 0xffff0000, v10
  buffer_store_dword v10, v3, s[24:27], 0 offen offset:0
  v_and_b32 v83, 0xffff0000, v82
  v_lshlrev_b32 v82, 16, v82
  v_and_b32 v101, 0xffff0000, v100
  v_lshlrev_b32 v100, 16, v100
  v_and_b32 v119, 0xffff0000, v118
  v_lshlrev_b32 v118, 16, v118
  v_and_b32 v137, 0xffff0000, v136
  v_lshlrev_b32 v136, 16, v136
  v_add_f32 v82, v82, v100
  v_add_f32 v83, v83, v101
  v_add_f32 v82, v82, v118
  v_add_f32 v83, v83, v119
  v_add_f32 v82, v82, v136
  v_add_f32 v83, v83, v137
  v_cvt_pk_bf16_f32 v5, v82, v83
  v_lshlrev_b32 v82, 16, v5
  v_and_b32 v83, 0xffff0000, v5
  v_lshlrev_b32 v6, 16, v41
  v_and_b32 v7, 0xffff0000, v41
  v_mul_f32 v82, v82, v6
  v_mul_f32 v83, v83, v7
  v_cvt_pk_bf16_f32 v5, v82, v83
  v_lshlrev_b32 v82, 16, v5
  v_and_b32 v83, 0xffff0000, v5
  v_add_f32 v62, v62, v82
  v_add_f32 v63, v63, v83
  v_cvt_pk_bf16_f32 v11, v62, v63
  v_lshlrev_b32 v62, 16, v11
  v_and_b32 v63, 0xffff0000, v11
  buffer_store_dword v11, v3, s[24:27], 0 offen offset:128
  v_and_b32 v85, 0xffff0000, v84
  v_lshlrev_b32 v84, 16, v84
  v_and_b32 v103, 0xffff0000, v102
  v_lshlrev_b32 v102, 16, v102
  v_and_b32 v121, 0xffff0000, v120
  v_lshlrev_b32 v120, 16, v120
  v_and_b32 v139, 0xffff0000, v138
  v_lshlrev_b32 v138, 16, v138
  v_add_f32 v84, v84, v102
  v_add_f32 v85, v85, v103
  v_add_f32 v84, v84, v120
  v_add_f32 v85, v85, v121
  v_add_f32 v84, v84, v138
  v_add_f32 v85, v85, v139
  v_cvt_pk_bf16_f32 v5, v84, v85
  v_lshlrev_b32 v84, 16, v5
  v_and_b32 v85, 0xffff0000, v5
  v_lshlrev_b32 v6, 16, v42
  v_and_b32 v7, 0xffff0000, v42
  v_mul_f32 v84, v84, v6
  v_mul_f32 v85, v85, v7
  v_cvt_pk_bf16_f32 v5, v84, v85
  v_lshlrev_b32 v84, 16, v5
  v_and_b32 v85, 0xffff0000, v5
  v_add_f32 v64, v64, v84
  v_add_f32 v65, v65, v85
  v_cvt_pk_bf16_f32 v12, v64, v65
  v_lshlrev_b32 v64, 16, v12
  v_and_b32 v65, 0xffff0000, v12
  buffer_store_dword v12, v3, s[24:27], 0 offen offset:256
  v_and_b32 v87, 0xffff0000, v86
  v_lshlrev_b32 v86, 16, v86
  v_and_b32 v105, 0xffff0000, v104
  v_lshlrev_b32 v104, 16, v104
  v_and_b32 v123, 0xffff0000, v122
  v_lshlrev_b32 v122, 16, v122
  v_and_b32 v141, 0xffff0000, v140
  v_lshlrev_b32 v140, 16, v140
  v_add_f32 v86, v86, v104
  v_add_f32 v87, v87, v105
  v_add_f32 v86, v86, v122
  v_add_f32 v87, v87, v123
  v_add_f32 v86, v86, v140
  v_add_f32 v87, v87, v141
  v_cvt_pk_bf16_f32 v5, v86, v87
  v_lshlrev_b32 v86, 16, v5
  v_and_b32 v87, 0xffff0000, v5
  v_lshlrev_b32 v6, 16, v43
  v_and_b32 v7, 0xffff0000, v43
  v_mul_f32 v86, v86, v6
  v_mul_f32 v87, v87, v7
  v_cvt_pk_bf16_f32 v5, v86, v87
  v_lshlrev_b32 v86, 16, v5
  v_and_b32 v87, 0xffff0000, v5
  v_add_f32 v66, v66, v86
  v_add_f32 v67, v67, v87
  v_cvt_pk_bf16_f32 v13, v66, v67
  v_lshlrev_b32 v66, 16, v13
  v_and_b32 v67, 0xffff0000, v13
  buffer_store_dword v13, v3, s[24:27], 0 offen offset:384
  v_and_b32 v89, 0xffff0000, v88
  v_lshlrev_b32 v88, 16, v88
  v_and_b32 v107, 0xffff0000, v106
  v_lshlrev_b32 v106, 16, v106
  v_and_b32 v125, 0xffff0000, v124
  v_lshlrev_b32 v124, 16, v124
  v_and_b32 v143, 0xffff0000, v142
  v_lshlrev_b32 v142, 16, v142
  v_add_f32 v88, v88, v106
  v_add_f32 v89, v89, v107
  v_add_f32 v88, v88, v124
  v_add_f32 v89, v89, v125
  v_add_f32 v88, v88, v142
  v_add_f32 v89, v89, v143
  v_cvt_pk_bf16_f32 v5, v88, v89
  v_lshlrev_b32 v88, 16, v5
  v_and_b32 v89, 0xffff0000, v5
  v_lshlrev_b32 v6, 16, v44
  v_and_b32 v7, 0xffff0000, v44
  v_mul_f32 v88, v88, v6
  v_mul_f32 v89, v89, v7
  v_cvt_pk_bf16_f32 v5, v88, v89
  v_lshlrev_b32 v88, 16, v5
  v_and_b32 v89, 0xffff0000, v5
  v_add_f32 v68, v68, v88
  v_add_f32 v69, v69, v89
  v_cvt_pk_bf16_f32 v14, v68, v69
  v_lshlrev_b32 v68, 16, v14
  v_and_b32 v69, 0xffff0000, v14
  buffer_store_dword v14, v3, s[24:27], 0 offen offset:512
  v_and_b32 v91, 0xffff0000, v90
  v_lshlrev_b32 v90, 16, v90
  v_and_b32 v109, 0xffff0000, v108
  v_lshlrev_b32 v108, 16, v108
  v_and_b32 v127, 0xffff0000, v126
  v_lshlrev_b32 v126, 16, v126
  v_and_b32 v145, 0xffff0000, v144
  v_lshlrev_b32 v144, 16, v144
  v_add_f32 v90, v90, v108
  v_add_f32 v91, v91, v109
  v_add_f32 v90, v90, v126
  v_add_f32 v91, v91, v127
  v_add_f32 v90, v90, v144
  v_add_f32 v91, v91, v145
  v_cvt_pk_bf16_f32 v5, v90, v91
  v_lshlrev_b32 v90, 16, v5
  v_and_b32 v91, 0xffff0000, v5
  v_lshlrev_b32 v6, 16, v45
  v_and_b32 v7, 0xffff0000, v45
  v_mul_f32 v90, v90, v6
  v_mul_f32 v91, v91, v7
  v_cvt_pk_bf16_f32 v5, v90, v91
  v_lshlrev_b32 v90, 16, v5
  v_and_b32 v91, 0xffff0000, v5
  v_add_f32 v70, v70, v90
  v_add_f32 v71, v71, v91
  v_cvt_pk_bf16_f32 v15, v70, v71
  v_lshlrev_b32 v70, 16, v15
  v_and_b32 v71, 0xffff0000, v15
  buffer_store_dword v15, v3, s[24:27], 0 offen offset:640
  v_and_b32 v93, 0xffff0000, v92
  v_lshlrev_b32 v92, 16, v92
  v_and_b32 v111, 0xffff0000, v110
  v_lshlrev_b32 v110, 16, v110
  v_and_b32 v129, 0xffff0000, v128
  v_lshlrev_b32 v128, 16, v128
  v_and_b32 v147, 0xffff0000, v146
  v_lshlrev_b32 v146, 16, v146
  v_add_f32 v92, v92, v110
  v_add_f32 v93, v93, v111
  v_add_f32 v92, v92, v128
  v_add_f32 v93, v93, v129
  v_add_f32 v92, v92, v146
  v_add_f32 v93, v93, v147
  v_cvt_pk_bf16_f32 v5, v92, v93
  v_lshlrev_b32 v92, 16, v5
  v_and_b32 v93, 0xffff0000, v5
  v_lshlrev_b32 v6, 16, v46
  v_and_b32 v7, 0xffff0000, v46
  v_mul_f32 v92, v92, v6
  v_mul_f32 v93, v93, v7
  v_cvt_pk_bf16_f32 v5, v92, v93
  v_lshlrev_b32 v92, 16, v5
  v_and_b32 v93, 0xffff0000, v5
  v_add_f32 v72, v72, v92
  v_add_f32 v73, v73, v93
  v_cvt_pk_bf16_f32 v16, v72, v73
  v_lshlrev_b32 v72, 16, v16
  v_and_b32 v73, 0xffff0000, v16
  buffer_store_dword v16, v3, s[24:27], 0 offen offset:768
  v_and_b32 v95, 0xffff0000, v94
  v_lshlrev_b32 v94, 16, v94
  v_and_b32 v113, 0xffff0000, v112
  v_lshlrev_b32 v112, 16, v112
  v_and_b32 v131, 0xffff0000, v130
  v_lshlrev_b32 v130, 16, v130
  v_and_b32 v149, 0xffff0000, v148
  v_lshlrev_b32 v148, 16, v148
  v_add_f32 v94, v94, v112
  v_add_f32 v95, v95, v113
  v_add_f32 v94, v94, v130
  v_add_f32 v95, v95, v131
  v_add_f32 v94, v94, v148
  v_add_f32 v95, v95, v149
  v_cvt_pk_bf16_f32 v5, v94, v95
  v_lshlrev_b32 v94, 16, v5
  v_and_b32 v95, 0xffff0000, v5
  v_lshlrev_b32 v6, 16, v47
  v_and_b32 v7, 0xffff0000, v47
  v_mul_f32 v94, v94, v6
  v_mul_f32 v95, v95, v7
  v_cvt_pk_bf16_f32 v5, v94, v95
  v_lshlrev_b32 v94, 16, v5
  v_and_b32 v95, 0xffff0000, v5
  v_add_f32 v74, v74, v94
  v_add_f32 v75, v75, v95
  v_cvt_pk_bf16_f32 v17, v74, v75
  v_lshlrev_b32 v74, 16, v17
  v_and_b32 v75, 0xffff0000, v17
  buffer_store_dword v17, v3, s[24:27], 0 offen offset:896
  v_and_b32 v97, 0xffff0000, v96
  v_lshlrev_b32 v96, 16, v96
  v_and_b32 v115, 0xffff0000, v114
  v_lshlrev_b32 v114, 16, v114
  v_and_b32 v133, 0xffff0000, v132
  v_lshlrev_b32 v132, 16, v132
  v_and_b32 v151, 0xffff0000, v150
  v_lshlrev_b32 v150, 16, v150
  v_add_f32 v96, v96, v114
  v_add_f32 v97, v97, v115
  v_add_f32 v96, v96, v132
  v_add_f32 v97, v97, v133
  v_add_f32 v96, v96, v150
  v_add_f32 v97, v97, v151
  v_cvt_pk_bf16_f32 v5, v96, v97
  v_lshlrev_b32 v96, 16, v5
  v_and_b32 v97, 0xffff0000, v5
  v_lshlrev_b32 v6, 16, v48
  v_and_b32 v7, 0xffff0000, v48
  v_mul_f32 v96, v96, v6
  v_mul_f32 v97, v97, v7
  v_cvt_pk_bf16_f32 v5, v96, v97
  v_lshlrev_b32 v96, 16, v5
  v_and_b32 v97, 0xffff0000, v5
  v_add_f32 v76, v76, v96
  v_add_f32 v77, v77, v97
  v_cvt_pk_bf16_f32 v18, v76, v77
  v_lshlrev_b32 v76, 16, v18
  v_and_b32 v77, 0xffff0000, v18
  buffer_store_dword v18, v3, s[24:27], 0 offen offset:1024
  v_add_f32 v5, v60, v61
  v_add_f32 v5, v5, v62
  v_add_f32 v5, v5, v63
  v_add_f32 v5, v5, v64
  v_add_f32 v5, v5, v65
  v_add_f32 v5, v5, v66
  v_add_f32 v5, v5, v67
  v_add_f32 v5, v5, v68
  v_add_f32 v5, v5, v69
  v_add_f32 v5, v5, v70
  v_add_f32 v5, v5, v71
  v_add_f32 v5, v5, v72
  v_add_f32 v5, v5, v73
  v_add_f32 v5, v5, v74
  v_add_f32 v5, v5, v75
  v_add_f32 v5, v5, v76
  v_add_f32 v5, v5, v77
  s_nop 1
  v_add_f32_dpp v5, v5, v5 quad_perm:[1,0,3,2] row_mask:0xf bank_mask:0xf
  s_nop 1
  v_add_f32_dpp v5, v5, v5 quad_perm:[2,3,0,1] row_mask:0xf bank_mask:0xf
  s_nop 1
  v_add_f32_dpp v5, v5, v5 row_half_mirror row_mask:0xf bank_mask:0xf
  s_nop 1
  v_add_f32_dpp v5, v5, v5 row_mirror row_mask:0xf bank_mask:0xf
  ds_swizzle_b32 v6, v5 offset:0x401F
  s_waitcnt lgkmcnt(0)
  v_add_f32 v5, v5, v6
  s_mov_b32 s11, 0x3ae38e39
  v_mul_f32 v5, s11, v5
  v_mov_b32 v8, 0
  v_sub_f32 v6, v60, v5
  v_fmac_f32 v8, v6, v6
  v_sub_f32 v6, v61, v5
  v_fmac_f32 v8, v6, v6
  v_sub_f32 v6, v62, v5
  v_fmac_f32 v8, v6, v6
  v_sub_f32 v6, v63, v5
  v_fmac_f32 v8, v6, v6
  v_sub_f32 v6, v64, v5
  v_fmac_f32 v8, v6, v6
  v_sub_f32 v6, v65, v5
  v_fmac_f32 v8, v6, v6
  v_sub_f32 v6, v66, v5
  v_fmac_f32 v8, v6, v6
  v_sub_f32 v6, v67, v5
  v_fmac_f32 v8, v6, v6
  v_sub_f32 v6, v68, v5
  v_fmac_f32 v8, v6, v6
  v_sub_f32 v6, v69, v5
  v_fmac_f32 v8, v6, v6
  v_sub_f32 v6, v70, v5
  v_fmac_f32 v8, v6, v6
  v_sub_f32 v6, v71, v5
  v_fmac_f32 v8, v6, v6
  v_sub_f32 v6, v72, v5
  v_fmac_f32 v8, v6, v6
  v_sub_f32 v6, v73, v5
  v_fmac_f32 v8, v6, v6
  v_sub_f32 v6, v74, v5
  v_fmac_f32 v8, v6, v6
  v_sub_f32 v6, v75, v5
  v_fmac_f32 v8, v6, v6
  v_sub_f32 v6, v76, v5
  v_fmac_f32 v8, v6, v6
  v_sub_f32 v6, v77, v5
  v_fmac_f32 v8, v6, v6
  s_nop 1
  v_add_f32_dpp v8, v8, v8 quad_perm:[1,0,3,2] row_mask:0xf bank_mask:0xf
  s_nop 1
  v_add_f32_dpp v8, v8, v8 quad_perm:[2,3,0,1] row_mask:0xf bank_mask:0xf
  s_nop 1
  v_add_f32_dpp v8, v8, v8 row_half_mirror row_mask:0xf bank_mask:0xf
  s_nop 1
  v_add_f32_dpp v8, v8, v8 row_mirror row_mask:0xf bank_mask:0xf
  ds_swizzle_b32 v6, v8 offset:0x401F
  s_waitcnt lgkmcnt(0)
  v_add_f32 v8, v8, v6
  v_mul_f32 v8, s11, v8
  v_cvt_pk_bf16_f32 v6, v5, v8
  v_lshlrev_b32 v5, 16, v6
  v_and_b32 v8, 0xffff0000, v6
  v_add_f32 v8, 0x3727c5ac, v8
  v_cvt_pk_bf16_f32 v6, v8, v8
  v_lshlrev_b32 v8, 16, v6
  v_sqrt_f32 v8, v8
  s_nop 0
  v_cvt_pk_bf16_f32 v6, v8, v8
  v_lshlrev_b32 v8, 16, v6
  v_rcp_f32 v8, v8
  s_nop 0
  v_sub_f32 v60, v60, v5
  v_sub_f32 v61, v61, v5
  v_cvt_pk_bf16_f32 v6, v60, v61
  v_lshlrev_b32 v60, 16, v6
  v_and_b32 v61, 0xffff0000, v6
  v_mul_f32 v60, v60, v8
  v_mul_f32 v61, v61, v8
  v_cvt_pk_bf16_f32 v6, v60, v61
  v_lshlrev_b32 v60, 16, v6
  v_and_b32 v61, 0xffff0000, v6
  v_lshlrev_b32 v6, 16, v20
  v_and_b32 v7, 0xffff0000, v20
  v_add_f32 v6, 1.0, v6
  v_add_f32 v7, 1.0, v7
  v_cvt_pk_bf16_f32 v9, v6, v7
  v_lshlrev_b32 v6, 16, v9
  v_and_b32 v7, 0xffff0000, v9
  v_mul_f32 v60, v60, v6
  v_mul_f32 v61, v61, v7
  v_cvt_pk_bf16_f32 v9, v60, v61
  v_lshlrev_b32 v60, 16, v9
  v_and_b32 v61, 0xffff0000, v9
  v_lshlrev_b32 v6, 16, v30
  v_and_b32 v7, 0xffff0000, v30
  v_add_f32 v60, v60, v6
  v_add_f32 v61, v61, v7
  v_cvt_pk_bf16_f32 v50, v60, v61
  buffer_store_dword v50, v3, s[20:23], 0 offen offset:0
  v_sub_f32 v62, v62, v5
  v_sub_f32 v63, v63, v5
  v_cvt_pk_bf16_f32 v6, v62, v63
  v_lshlrev_b32 v62, 16, v6
  v_and_b32 v63, 0xffff0000, v6
  v_mul_f32 v62, v62, v8
  v_mul_f32 v63, v63, v8
  v_cvt_pk_bf16_f32 v6, v62, v63
  v_lshlrev_b32 v62, 16, v6
  v_and_b32 v63, 0xffff0000, v6
  v_lshlrev_b32 v6, 16, v21
  v_and_b32 v7, 0xffff0000, v21
  v_add_f32 v6, 1.0, v6
  v_add_f32 v7, 1.0, v7
  v_cvt_pk_bf16_f32 v9, v6, v7
  v_lshlrev_b32 v6, 16, v9
  v_and_b32 v7, 0xffff0000, v9
  v_mul_f32 v62, v62, v6
  v_mul_f32 v63, v63, v7
  v_cvt_pk_bf16_f32 v9, v62, v63
  v_lshlrev_b32 v62, 16, v9
  v_and_b32 v63, 0xffff0000, v9
  v_lshlrev_b32 v6, 16, v31
  v_and_b32 v7, 0xffff0000, v31
  v_add_f32 v62, v62, v6
  v_add_f32 v63, v63, v7
  v_cvt_pk_bf16_f32 v51, v62, v63
  buffer_store_dword v51, v3, s[20:23], 0 offen offset:128
  v_sub_f32 v64, v64, v5
  v_sub_f32 v65, v65, v5
  v_cvt_pk_bf16_f32 v6, v64, v65
  v_lshlrev_b32 v64, 16, v6
  v_and_b32 v65, 0xffff0000, v6
  v_mul_f32 v64, v64, v8
  v_mul_f32 v65, v65, v8
  v_cvt_pk_bf16_f32 v6, v64, v65
  v_lshlrev_b32 v64, 16, v6
  v_and_b32 v65, 0xffff0000, v6
  v_lshlrev_b32 v6, 16, v22
  v_and_b32 v7, 0xffff0000, v22
  v_add_f32 v6, 1.0, v6
  v_add_f32 v7, 1.0, v7
  v_cvt_pk_bf16_f32 v9, v6, v7
  v_lshlrev_b32 v6, 16, v9
  v_and_b32 v7, 0xffff0000, v9
  v_mul_f32 v64, v64, v6
  v_mul_f32 v65, v65, v7
  v_cvt_pk_bf16_f32 v9, v64, v65
  v_lshlrev_b32 v64, 16, v9
  v_and_b32 v65, 0xffff0000, v9
  v_lshlrev_b32 v6, 16, v32
  v_and_b32 v7, 0xffff0000, v32
  v_add_f32 v64, v64, v6
  v_add_f32 v65, v65, v7
  v_cvt_pk_bf16_f32 v52, v64, v65
  buffer_store_dword v52, v3, s[20:23], 0 offen offset:256
  v_sub_f32 v66, v66, v5
  v_sub_f32 v67, v67, v5
  v_cvt_pk_bf16_f32 v6, v66, v67
  v_lshlrev_b32 v66, 16, v6
  v_and_b32 v67, 0xffff0000, v6
  v_mul_f32 v66, v66, v8
  v_mul_f32 v67, v67, v8
  v_cvt_pk_bf16_f32 v6, v66, v67
  v_lshlrev_b32 v66, 16, v6
  v_and_b32 v67, 0xffff0000, v6
  v_lshlrev_b32 v6, 16, v23
  v_and_b32 v7, 0xffff0000, v23
  v_add_f32 v6, 1.0, v6
  v_add_f32 v7, 1.0, v7
  v_cvt_pk_bf16_f32 v9, v6, v7
  v_lshlrev_b32 v6, 16, v9
  v_and_b32 v7, 0xffff0000, v9
  v_mul_f32 v66, v66, v6
  v_mul_f32 v67, v67, v7
  v_cvt_pk_bf16_f32 v9, v66, v67
  v_lshlrev_b32 v66, 16, v9
  v_and_b32 v67, 0xffff0000, v9
  v_lshlrev_b32 v6, 16, v33
  v_and_b32 v7, 0xffff0000, v33
  v_add_f32 v66, v66, v6
  v_add_f32 v67, v67, v7
  v_cvt_pk_bf16_f32 v53, v66, v67
  buffer_store_dword v53, v3, s[20:23], 0 offen offset:384
  v_sub_f32 v68, v68, v5
  v_sub_f32 v69, v69, v5
  v_cvt_pk_bf16_f32 v6, v68, v69
  v_lshlrev_b32 v68, 16, v6
  v_and_b32 v69, 0xffff0000, v6
  v_mul_f32 v68, v68, v8
  v_mul_f32 v69, v69, v8
  v_cvt_pk_bf16_f32 v6, v68, v69
  v_lshlrev_b32 v68, 16, v6
  v_and_b32 v69, 0xffff0000, v6
  v_lshlrev_b32 v6, 16, v24
  v_and_b32 v7, 0xffff0000, v24
  v_add_f32 v6, 1.0, v6
  v_add_f32 v7, 1.0, v7
  v_cvt_pk_bf16_f32 v9, v6, v7
  v_lshlrev_b32 v6, 16, v9
  v_and_b32 v7, 0xffff0000, v9
  v_mul_f32 v68, v68, v6
  v_mul_f32 v69, v69, v7
  v_cvt_pk_bf16_f32 v9, v68, v69
  v_lshlrev_b32 v68, 16, v9
  v_and_b32 v69, 0xffff0000, v9
  v_lshlrev_b32 v6, 16, v34
  v_and_b32 v7, 0xffff0000, v34
  v_add_f32 v68, v68, v6
  v_add_f32 v69, v69, v7
  v_cvt_pk_bf16_f32 v54, v68, v69
  buffer_store_dword v54, v3, s[20:23], 0 offen offset:512
  v_sub_f32 v70, v70, v5
  v_sub_f32 v71, v71, v5
  v_cvt_pk_bf16_f32 v6, v70, v71
  v_lshlrev_b32 v70, 16, v6
  v_and_b32 v71, 0xffff0000, v6
  v_mul_f32 v70, v70, v8
  v_mul_f32 v71, v71, v8
  v_cvt_pk_bf16_f32 v6, v70, v71
  v_lshlrev_b32 v70, 16, v6
  v_and_b32 v71, 0xffff0000, v6
  v_lshlrev_b32 v6, 16, v25
  v_and_b32 v7, 0xffff0000, v25
  v_add_f32 v6, 1.0, v6
  v_add_f32 v7, 1.0, v7
  v_cvt_pk_bf16_f32 v9, v6, v7
  v_lshlrev_b32 v6, 16, v9
  v_and_b32 v7, 0xffff0000, v9
  v_mul_f32 v70, v70, v6
  v_mul_f32 v71, v71, v7
  v_cvt_pk_bf16_f32 v9, v70, v71
  v_lshlrev_b32 v70, 16, v9
  v_and_b32 v71, 0xffff0000, v9
  v_lshlrev_b32 v6, 16, v35
  v_and_b32 v7, 0xffff0000, v35
  v_add_f32 v70, v70, v6
  v_add_f32 v71, v71, v7
  v_cvt_pk_bf16_f32 v55, v70, v71
  buffer_store_dword v55, v3, s[20:23], 0 offen offset:640
  v_sub_f32 v72, v72, v5
  v_sub_f32 v73, v73, v5
  v_cvt_pk_bf16_f32 v6, v72, v73
  v_lshlrev_b32 v72, 16, v6
  v_and_b32 v73, 0xffff0000, v6
  v_mul_f32 v72, v72, v8
  v_mul_f32 v73, v73, v8
  v_cvt_pk_bf16_f32 v6, v72, v73
  v_lshlrev_b32 v72, 16, v6
  v_and_b32 v73, 0xffff0000, v6
  v_lshlrev_b32 v6, 16, v26
  v_and_b32 v7, 0xffff0000, v26
  v_add_f32 v6, 1.0, v6
  v_add_f32 v7, 1.0, v7
  v_cvt_pk_bf16_f32 v9, v6, v7
  v_lshlrev_b32 v6, 16, v9
  v_and_b32 v7, 0xffff0000, v9
  v_mul_f32 v72, v72, v6
  v_mul_f32 v73, v73, v7
  v_cvt_pk_bf16_f32 v9, v72, v73
  v_lshlrev_b32 v72, 16, v9
  v_and_b32 v73, 0xffff0000, v9
  v_lshlrev_b32 v6, 16, v36
  v_and_b32 v7, 0xffff0000, v36
  v_add_f32 v72, v72, v6
  v_add_f32 v73, v73, v7
  v_cvt_pk_bf16_f32 v56, v72, v73
  buffer_store_dword v56, v3, s[20:23], 0 offen offset:768
  v_sub_f32 v74, v74, v5
  v_sub_f32 v75, v75, v5
  v_cvt_pk_bf16_f32 v6, v74, v75
  v_lshlrev_b32 v74, 16, v6
  v_and_b32 v75, 0xffff0000, v6
  v_mul_f32 v74, v74, v8
  v_mul_f32 v75, v75, v8
  v_cvt_pk_bf16_f32 v6, v74, v75
  v_lshlrev_b32 v74, 16, v6
  v_and_b32 v75, 0xffff0000, v6
  v_lshlrev_b32 v6, 16, v27
  v_and_b32 v7, 0xffff0000, v27
  v_add_f32 v6, 1.0, v6
  v_add_f32 v7, 1.0, v7
  v_cvt_pk_bf16_f32 v9, v6, v7
  v_lshlrev_b32 v6, 16, v9
  v_and_b32 v7, 0xffff0000, v9
  v_mul_f32 v74, v74, v6
  v_mul_f32 v75, v75, v7
  v_cvt_pk_bf16_f32 v9, v74, v75
  v_lshlrev_b32 v74, 16, v9
  v_and_b32 v75, 0xffff0000, v9
  v_lshlrev_b32 v6, 16, v37
  v_and_b32 v7, 0xffff0000, v37
  v_add_f32 v74, v74, v6
  v_add_f32 v75, v75, v7
  v_cvt_pk_bf16_f32 v57, v74, v75
  buffer_store_dword v57, v3, s[20:23], 0 offen offset:896
  v_sub_f32 v76, v76, v5
  v_sub_f32 v77, v77, v5
  v_cvt_pk_bf16_f32 v6, v76, v77
  v_lshlrev_b32 v76, 16, v6
  v_and_b32 v77, 0xffff0000, v6
  v_mul_f32 v76, v76, v8
  v_mul_f32 v77, v77, v8
  v_cvt_pk_bf16_f32 v6, v76, v77
  v_lshlrev_b32 v76, 16, v6
  v_and_b32 v77, 0xffff0000, v6
  v_lshlrev_b32 v6, 16, v28
  v_and_b32 v7, 0xffff0000, v28
  v_add_f32 v6, 1.0, v6
  v_add_f32 v7, 1.0, v7
  v_cvt_pk_bf16_f32 v9, v6, v7
  v_lshlrev_b32 v6, 16, v9
  v_and_b32 v7, 0xffff0000, v9
  v_mul_f32 v76, v76, v6
  v_mul_f32 v77, v77, v7
  v_cvt_pk_bf16_f32 v9, v76, v77
  v_lshlrev_b32 v76, 16, v9
  v_and_b32 v77, 0xffff0000, v9
  v_lshlrev_b32 v6, 16, v38
  v_and_b32 v7, 0xffff0000, v38
  v_add_f32 v76, v76, v6
  v_add_f32 v77, v77, v7
  v_cvt_pk_bf16_f32 v58, v76, v77
  buffer_store_dword v58, v3, s[20:23], 0 offen offset:1024
ln_end_39:
  s_endpgm
.text
.globl ffn1_kernel
.p2align 8
.type ffn1_kernel,@function
ffn1_kernel:
  s_cmp_ge_u32 s2, 256
  s_cbranch_scc1 g8_end_40
  s_load_dwordx2 s[4:5], s[0:1], 96
  s_load_dwordx2 s[6:7], s[0:1], 48
  v_and_b32 v1, 63, v0
  v_lshrrev_b32 v2, 6, v0
  s_and_b32 s33, s2, 7
  s_lshr_b32 s34, s2, 3
  s_and_b32 s25, s34, 1
  s_lshl_b32 s35, s33, 1
  s_add_u32 s25, s25, s35
  s_mul_i32 s25, s25, 288
  s_lshr_b32 s24, s34, 1
  s_lshl_b32 s24, s24, 7
  v_readfirstlane_b32 s27, v2
  s_waitcnt lgkmcnt(0)
  s_and_b32 s44, s27, 3
  s_lshr_b32 s45, s27, 2
  s_add_u32 s12, s4, 0x490000
  s_addc_u32 s13, s5, 0
  s_mov_b32 s14, 0x240000
  s_mov_b32 s15, 0x00020000
  s_mov_b32 s16, s6
  s_mov_b32 s17, s7
  s_mov_b32 s18, 0x510000
  s_mov_b32 s19, 0x00020000
  s_add_u32 s20, s4, 0x2800000
  s_addc_u32 s21, s5, 0
  s_mov_b32 s22, 0x1200000
  s_mov_b32 s23, 0x00020000
  s_mov_b32 s28, 0
  s_mov_b32 s29, 0
  v_lshrrev_b32 v3, 3, v1
  v_lshrrev_b32 v4, 4, v1
  v_and_b32 v5, 7, v1
  s_lshl_b32 s35, s27, 4
  s_add_u32 s35, s35, s24
  s_mov_b32 s36, 1152
  v_add_u32 v6, 0, v4
  v_and_b32 v6, 7, v6
  v_xor_b32 v6, v6, v5
  v_lshlrev_b32 v6, 4, v6
  v_add_u32 v7, 0, v3
  v_add_u32 v7, s35, v7
  v_mul_lo_u32 v7, v7, s36
  v_add_u32 v8, v7, v6
  v_add_u32 v6, 4, v4
  v_and_b32 v6, 7, v6
  v_xor_b32 v6, v6, v5
  v_lshlrev_b32 v6, 4, v6
  v_add_u32 v7, 8, v3
  v_add_u32 v7, s35, v7
  v_mul_lo_u32 v7, v7, s36
  v_add_u32 v9, v7, v6
  s_mov_b32 s36, 9216
  s_lshl_b32 s35, s27, 3
  s_lshl_b32 s37, s25, 1
  v_add_u32 v3, 0, v1
  v_mul_u32_u24 v4, 1821, v3
  v_lshrrev_b32 v4, 16, v4
  v_mul_u32_u24 v5, 36, v4
  v_sub_u32 v5, v3, v5
  v_add_u32 v4, s35, v4
  v_lshrrev_b32 v6, 3, v4
  v_and_b32 v6, 1, v6
  v_lshlrev_b32 v6, 1, v6
  v_xor_b32 v5, v5, v6
  v_lshlrev_b32 v5, 4, v5
  v_mul_lo_u32 v4, v4, s36
  v_add3_u32 v12, v4, v5, s37
  v_add_u32 v3, 64, v1
  v_mul_u32_u24 v4, 1821, v3
  v_lshrrev_b32 v4, 16, v4
  v_mul_u32_u24 v5, 36, v4
  v_sub_u32 v5, v3, v5
  v_add_u32 v4, s35, v4
  v_lshrrev_b32 v6, 3, v4
  v_and_b32 v6, 1, v6
  v_lshlrev_b32 v6, 1, v6
  v_xor_b32 v5, v5, v6
  v_lshlrev_b32 v5, 4, v5
  v_mul_lo_u32 v4, v4, s36
  v_add3_u32 v13, v4, v5, s37
  v_add_u32 v3, 128, v1
  v_mul_u32_u24 v4, 1821, v3
  v_lshrrev_b32 v4, 16, v4
  v_mul_u32_u24 v5, 36, v4
  v_sub_u32 v5, v3, v5
  v_add_u32 v4, s35, v4
  v_lshrrev_b32 v6, 3, v4
  v_and_b32 v6, 1, v6
  v_lshlrev_b32 v6, 1, v6
  v_xor_b32 v5, v5, v6
  v_lshlrev_b32 v5, 4, v5
  v_mul_lo_u32 v4, v4, s36
  v_add3_u32 v14, v4, v5, s37
  v_add_u32 v3, 192, v1
  v_mul_u32_u24 v4, 1821, v3
  v_lshrrev_b32 v4, 16, v4
  v_mul_u32_u24 v5, 36, v4
  v_sub_u32 v5, v3, v5
  v_add_u32 v4, s35, v4
  v_lshrrev_b32 v6, 3, v4
  v_and_b32 v6, 1, v6
  v_lshlrev_b32 v6, 1, v6
  v_xor_b32 v5, v5, v6
  v_lshlrev_b32 v5, 4, v5
  v_mul_lo_u32 v4, v4, s36
  v_add3_u32 v15, v4, v5, s37
  v_add_u32 v3, 256, v1
  v_mul_u32_u24 v4, 1821, v3
  v_lshrrev_b32 v4, 16, v4
  v_mul_u32_u24 v5, 36, v4
  v_sub_u32 v5, v3, v5
  v_add_u32 v4, s35, v4
  v_lshrrev_b32 v6, 3, v4
  v_and_b32 v6, 1, v6
  v_lshlrev_b32 v6, 1, v6
  v_xor_b32 v5, v5, v6
  v_lshlrev_b32 v5, 4, v5
  v_mul_lo_u32 v4, v4, s36
  v_add3_u32 v16, v4, v5, s37
  s_lshl_b32 s38, s27, 11
  s_mul_i32 s39, s27, 4608
  s_add_u32 s39, s39, 16384
  s_mov_b32 s30, 0
  s_mov_b32 s31, 0
  s_mov_b32 s34, 0
  s_cmp_lt_u32 s34, 9
  s_cselect_b32 s40, s28, 0x40000000
  s_cselect_b32 s41, s29, 0x40000000
  s_add_u32 s42, s30, s38
  s_add_u32 s43, s30, s39
  s_add_u32 m0, s42, 0
  s_nop 0
  buffer_load_dwordx4 v8, s[12:15], s40 offen lds
  s_add_u32 m0, s42, 1024
  s_nop 0
  buffer_load_dwordx4 v9, s[12:15], s40 offen lds
  s_add_u32 m0, s43, 0
  s_nop 0
  buffer_load_dwordx4 v12, s[16:19], s41 offen lds
  s_add_u32 m0, s43, 1024
  s_nop 0
  buffer_load_dwordx4 v13, s[16:19], s41 offen lds
  s_add_u32 m0, s43, 2048
  s_nop 0
  buffer_load_dwordx4 v14, s[16:19], s41 offen lds
  s_add_u32 m0, s43, 3072
  s_nop 0
  buffer_load_dwordx4 v15, s[16:19], s41 offen lds
  s_add_u32 m0, s43, 4096
  s_mov_b32 exec_hi, 0
  buffer_load_dwordx4 v16, s[16:19], s41 offen lds
  s_mov_b32 exec_hi, -1
  s_add_u32 s28, s28, 128
  s_add_u32 s29, s29, 589824
  s_add_u32 s34, s34, 1
  s_add_u32 s30, s30, 53248
  s_cmp_eq_u32 s30, 159744
  s_cselect_b32 s30, 0, s30
  s_cmp_lt_u32 s34, 9
  s_cselect_b32 s40, s28, 0x40000000
  s_cselect_b32 s41, s29, 0x40000000
  s_add_u32 s42, s30, s38
  s_add_u32 s43, s30, s39
  s_add_u32 m0, s42, 0
  s_nop 0
  buffer_load_dwordx4 v8, s[12:15], s40 offen lds
  s_add_u32 m0, s42, 1024
  s_nop 0
  buffer_load_dwordx4 v9, s[12:15], s40 offen lds
  s_add_u32 m0, s43, 0
  s_nop 0
  buffer_load_dwordx4 v12, s[16:19], s41 offen lds
  s_add_u32 m0, s43, 1024
  s_nop 0
  buffer_load_dwordx4 v13, s[16:19], s41 offen lds
  s_add_u32 m0, s43, 2048
  s_nop 0
  buffer_load_dwordx4 v14, s[16:19], s41 offen lds
  s_add_u32 m0, s43, 3072
  s_nop 0
  buffer_load_dwordx4 v15, s[16:19], s41 offen lds
  s_add_u32 m0, s43, 4096
  s_mov_b32 exec_hi, 0
  buffer_load_dwordx4 v16, s[16:19], s41 offen lds
  s_mov_b32 exec_hi, -1
  s_add_u32 s28, s28, 128
  s_add_u32 s29, s29, 589824
  s_add_u32 s34, s34, 1
  s_add_u32 s30, s30, 53248
  s_cmp_eq_u32 s30, 159744
  s_cselect_b32 s30, 0, s30
  s_cmp_lt_u32 s34, 9
  s_cselect_b32 s40, s28, 0x40000000
  s_cselect_b32 s41, s29, 0x40000000
  s_add_u32 s42, s30, s38
  s_add_u32 s43, s30, s39
  s_add_u32 m0, s42, 0
  s_nop 0
  buffer_load_dwordx4 v8, s[12:15], s40 offen lds
  s_add_u32 m0, s42, 1024
  s_nop 0
  buffer_load_dwordx4 v9, s[12:15], s40 offen lds
  s_add_u32 m0, s43, 0
  s_nop 0
  buffer_load_dwordx4 v12, s[16:19], s41 offen lds
  v_and_b32 v3, 15, v1
  v_lshrrev_b32 v4, 4, v1
  v_lshrrev_b32 v5, 1, v3
  s_lshl_b32 s35, s44, 5
  v_add_u32 v6, s35, v3
  v_lshlrev_b32 v6, 7, v6
  v_add_u32 v7, 0, v4
  v_xor_b32 v7, v7, v5
  v_lshlrev_b32 v7, 4, v7
  v_add_u32 v22, v6, v7
  v_add_u32 v7, 4, v4
  v_xor_b32 v7, v7, v5
  v_lshlrev_b32 v7, 4, v7
  v_add_u32 v23, v6, v7
  v_lshrrev_b32 v5, 2, v3
  v_and_b32 v6, 3, v3
  v_lshlrev_b32 v7, 3, v4
  v_add_u32 v7, v7, v5
  v_mul_u32_u24 v7, 576, v7
  v_lshlrev_b32 v6, 3, v6
  v_add_u32 v7, v7, v6
  s_mul_i32 s35, s45, 288
  s_add_u32 s35, s35, 16384
  v_add_u32 v7, s35, v7
  v_and_b32 v4, 1, v4
  v_lshlrev_b32 v4, 5, v4
  v_add_u32 v5, v7, v4
  v_sub_u32 v6, v7, v4
  s_cmp_eq_u32 s45, 0
  s_cselect_b64 vcc, -1, 0
  v_cndmask_b32 v24, v6, v5, vcc
  v_cndmask_b32 v25, v5, v6, vcc
  v_mov_b32 v26, v22
  v_mov_b32 v27, v23
  v_mov_b32 v28, v24
  v_mov_b32 v29, v25
  v_accvgpr_write_b32 a0, 0
  v_accvgpr_write_b32 a1, 0
  v_accvgpr_write_b32 a2, 0
  v_accvgpr_write_b32 a3, 0
  v_accvgpr_write_b32 a4, 0
  v_accvgpr_write_b32 a5, 0
  v_accvgpr_write_b32 a6, 0
  v_accvgpr_write_b32 a7, 0
  v_accvgpr_write_b32 a8, 0
  v_accvgpr_write_b32 a9, 0
  v_accvgpr_write_b32 a10, 0
  v_accvgpr_write_b32 a11, 0
  v_accvgpr_write_b32 a12, 0
  v_accvgpr_write_b32 a13, 0
  v_accvgpr_write_b32 a14, 0
  v_accvgpr_write_b32 a15, 0
  v_accvgpr_write_b32 a16, 0
  v_accvgpr_write_b32 a17, 0
  v_accvgpr_write_b32 a18, 0
  v_accvgpr_write_b32 a19, 0
  v_accvgpr_write_b32 a20, 0
  v_accvgpr_write_b32 a21, 0
  v_accvgpr_write_b32 a22, 0
  v_accvgpr_write_b32 a23, 0
  v_accvgpr_write_b32 a24, 0
  v_accvgpr_write_b32 a25, 0
  v_accvgpr_write_b32 a26, 0
  v_accvgpr_write_b32 a27, 0
  v_accvgpr_write_b32 a28, 0
  v_accvgpr_write_b32 a29, 0
  v_accvgpr_write_b32 a30, 0
  v_accvgpr_write_b32 a31, 0
  v_accvgpr_write_b32 a32, 0
  v_accvgpr_write_b32 a33, 0
  v_accvgpr_write_b32 a34, 0
  v_accvgpr_write_b32 a35, 0
  v_accvgpr_write_b32 a36, 0
  v_accvgpr_write_b32 a37, 0
  v_accvgpr_write_b32 a38, 0
  v_accvgpr_write_b32 a39, 0
  v_accvgpr_write_b32 a40, 0
  v_accvgpr_write_b32 a41, 0
  v_accvgpr_write_b32 a42, 0
  v_accvgpr_write_b32 a43, 0
  v_accvgpr_write_b32 a44, 0
  v_accvgpr_write_b32 a45, 0
  v_accvgpr_write_b32 a46, 0
  v_accvgpr_write_b32 a47, 0
  v_accvgpr_write_b32 a48, 0
  v_accvgpr_write_b32 a49, 0
  v_accvgpr_write_b32 a50, 0
  v_accvgpr_write_b32 a51, 0
  v_accvgpr_write_b32 a52, 0
  v_accvgpr_write_b32 a53, 0
  v_accvgpr_write_b32 a54, 0
  v_accvgpr_write_b32 a55, 0
  v_accvgpr_write_b32 a56, 0
  v_accvgpr_write_b32 a57, 0
  v_accvgpr_write_b32 a58, 0
  v_accvgpr_write_b32 a59, 0
  v_accvgpr_write_b32 a60, 0
  v_accvgpr_write_b32 a61, 0
  v_accvgpr_write_b32 a62, 0
  v_accvgpr_write_b32 a63, 0
  v_accvgpr_write_b32 a64, 0
  v_accvgpr_write_b32 a65, 0
  v_accvgpr_write_b32 a66, 0
  v_accvgpr_write_b32 a67, 0
  v_accvgpr_write_b32 a68, 0
  v_accvgpr_write_b32 a69, 0
  v_accvgpr_write_b32 a70, 0
  v_accvgpr_write_b32 a71, 0
  s_waitcnt vmcnt(10)
  s_barrier
  ds_read_b128 v[32:35], v26 offset:0
  ds_read_b128 v[36:39], v26 offset:2048
  ds_read_b64_tr_b16 v[48:49], v28 offset:0
  ds_read_b64_tr_b16 v[50:51], v28 offset:2304
  ds_read_b64_tr_b16 v[52:53], v29 offset:32
  ds_read_b64_tr_b16 v[54:55], v29 offset:2336
  ds_read_b64_tr_b16 v[56:57], v28 offset:64
  ds_read_b64_tr_b16 v[58:59], v28 offset:2368
  ds_read_b64_tr_b16 v[60:61], v29 offset:96
  ds_read_b64_tr_b16 v[62:63], v29 offset:2400
  ds_read_b64_tr_b16 v[64:65], v28 offset:128
  ds_read_b64_tr_b16 v[66:67], v28 offset:2432
  ds_read_b64_tr_b16 v[68:69], v29 offset:160
  ds_read_b64_tr_b16 v[70:71], v29 offset:2464
  ds_read_b64_tr_b16 v[72:73], v28 offset:192
  ds_read_b64_tr_b16 v[74:75], v28 offset:2496
  ds_read_b64_tr_b16 v[76:77], v29 offset:224
  ds_read_b64_tr_b16 v[78:79], v29 offset:2528
  ds_read_b64_tr_b16 v[80:81], v28 offset:256
  ds_read_b64_tr_b16 v[82:83], v28 offset:2560
  s_mov_b32 s32, 9
g8_loop_41:
  s_waitcnt lgkmcnt(0)
  v_mfma_f32_16x16x32_bf16 a[0:3], v[48:51], v[32:35], a[0:3]
  ds_read_b128 v[40:43], v27 offset:0
  ds_read_b128 v[44:47], v27 offset:2048
  v_mfma_f32_16x16x32_bf16 a[4:7], v[48:51], v[36:39], a[4:7]
  ds_read_b64_tr_b16 v[84:85], v28 offset:18432
  ds_read_b64_tr_b16 v[86:87], v28 offset:20736
  v_mfma_f32_16x16x32_bf16 a[8:11], v[52:55], v[32:35], a[8:11]
  s_add_u32 m0, s43, 1024
  s_nop 0
  buffer_load_dwordx4 v13, s[16:19], s41 offen lds
  v_mfma_f32_16x16x32_bf16 a[12:15], v[52:55], v[36:39], a[12:15]
  ds_read_b64_tr_b16 v[88:89], v29 offset:18464
  ds_read_b64_tr_b16 v[90:91], v29 offset:20768
  v_mfma_f32_16x16x32_bf16 a[16:19], v[56:59], v[32:35], a[16:19]
  ds_read_b64_tr_b16 v[92:93], v28 offset:18496
  ds_read_b64_tr_b16 v[94:95], v28 offset:20800
  v_mfma_f32_16x16x32_bf16 a[20:23], v[56:59], v[36:39], a[20:23]
  ds_read_b64_tr_b16 v[96:97], v29 offset:18528
  ds_read_b64_tr_b16 v[98:99], v29 offset:20832
  v_mfma_f32_16x16x32_bf16 a[24:27], v[60:63], v[32:35], a[24:27]
  s_add_u32 m0, s43, 2048
  s_nop 0
  buffer_load_dwordx4 v14, s[16:19], s41 offen lds
  v_mfma_f32_16x16x32_bf16 a[28:31], v[60:63], v[36:39], a[28:31]
  ds_read_b64_tr_b16 v[100:101], v28 offset:18560
  ds_read_b64_tr_b16 v[102:103], v28 offset:20864
  v_mfma_f32_16x16x32_bf16 a[32:35], v[64:67], v[32:35], a[32:35]
  ds_read_b64_tr_b16 v[104:105], v29 offset:18592
  ds_read_b64_tr_b16 v[106:107], v29 offset:20896
  v_mfma_f32_16x16x32_bf16 a[36:39], v[64:67], v[36:39], a[36:39]
  ds_read_b64_tr_b16 v[108:109], v28 offset:18624
  ds_read_b64_tr_b16 v[110:111], v28 offset:20928
  v_mfma_f32_16x16x32_bf16 a[40:43], v[68:71], v[32:35], a[40:43]
  ds_read_b64_tr_b16 v[112:113], v29 offset:18656
  ds_read_b64_tr_b16 v[114:115], v29 offset:20960
  v_mfma_f32_16x16x32_bf16 a[44:47], v[68:71], v[36:39], a[44:47]
  s_add_u32 m0, s43, 3072
  s_nop 0
  buffer_load_dwordx4 v15, s[16:19], s41 offen lds
  v_mfma_f32_16x16x32_bf16 a[48:51], v[72:75], v[32:35], a[48:51]
  ds_read_b64_tr_b16 v[116:117], v28 offset:18688
  ds_read_b64_tr_b16 v[118:119], v28 offset:20992
  v_mfma_f32_16x16x32_bf16 a[52:55], v[72:75], v[36:39], a[52:55]
  v_mfma_f32_16x16x32_bf16 a[56:59], v[76:79], v[32:35], a[56:59]
  v_mfma_f32_16x16x32_bf16 a[60:63], v[76:79], v[36:39], a[60:63]
  s_add_u32 m0, s43, 4096
  s_mov_b32 exec_hi, 0
  buffer_load_dwordx4 v16, s[16:19], s41 offen lds
  s_mov_b32 exec_hi, -1
  s_add_u32 s28, s28, 128
  s_add_u32 s29, s29, 589824
  s_add_u32 s34, s34, 1
  s_add_u32 s30, s30, 53248
  s_cmp_eq_u32 s30, 159744
  s_cselect_b32 s30, 0, s30
  v_mfma_f32_16x16x32_bf16 a[64:67], v[80:83], v[32:35], a[64:67]
  v_mfma_f32_16x16x32_bf16 a[68:71], v[80:83], v[36:39], a[68:71]
  s_waitcnt vmcnt(7) lgkmcnt(0)
  s_barrier
  s_add_u32 s31, s31, 53248
  s_cmp_eq_u32 s31, 159744
  s_cselect_b32 s31, 0, s31
  v_add_u32 v26, s31, v22
  v_add_u32 v27, s31, v23
  v_add_u32 v28, s31, v24
  v_add_u32 v29, s31, v25
  v_mfma_f32_16x16x32_bf16 a[0:3], v[84:87], v[40:43], a[0:3]
  ds_read_b128 v[32:35], v26 offset:0
  ds_read_b128 v[36:39], v26 offset:2048
  v_mfma_f32_16x16x32_bf16 a[4:7], v[84:87], v[44:47], a[4:7]
  ds_read_b64_tr_b16 v[48:49], v28 offset:0
  ds_read_b64_tr_b16 v[50:51], v28 offset:2304
  v_mfma_f32_16x16x32_bf16 a[8:11], v[88:91], v[40:43], a[8:11]
  ds_read_b64_tr_b16 v[52:53], v29 offset:32
  ds_read_b64_tr_b16 v[54:55], v29 offset:2336
  v_mfma_f32_16x16x32_bf16 a[12:15], v[88:91], v[44:47], a[12:15]
  s_cmp_lt_u32 s34, 9
  s_cselect_b32 s40, s28, 0x40000000
  s_cselect_b32 s41, s29, 0x40000000
  s_add_u32 s42, s30, s38
  s_add_u32 s43, s30, s39
  s_add_u32 m0, s42, 0
  s_nop 0
  buffer_load_dwordx4 v8, s[12:15], s40 offen lds
  v_mfma_f32_16x16x32_bf16 a[16:19], v[92:95], v[40:43], a[16:19]
  ds_read_b64_tr_b16 v[56:57], v28 offset:64
  ds_read_b64_tr_b16 v[58:59], v28 offset:2368
  v_mfma_f32_16x16x32_bf16 a[20:23], v[92:95], v[44:47], a[20:23]
  ds_read_b64_tr_b16 v[60:61], v29 offset:96
  ds_read_b64_tr_b16 v[62:63], v29 offset:2400
  v_mfma_f32_16x16x32_bf16 a[24:27], v[96:99], v[40:43], a[24:27]
  ds_read_b64_tr_b16 v[64:65], v28 offset:128
  ds_read_b64_tr_b16 v[66:67], v28 offset:2432
  v_mfma_f32_16x16x32_bf16 a[28:31], v[96:99], v[44:47], a[28:31]
  ds_read_b64_tr_b16 v[68:69], v29 offset:160
  ds_read_b64_tr_b16 v[70:71], v29 offset:2464
  v_mfma_f32_16x16x32_bf16 a[32:35], v[100:103], v[40:43], a[32:35]
  ds_read_b64_tr_b16 v[72:73], v28 offset:192
  ds_read_b64_tr_b16 v[74:75], v28 offset:2496
  v_mfma_f32_16x16x32_bf16 a[36:39], v[100:103], v[44:47], a[36:39]
  s_add_u32 m0, s42, 1024
  s_nop 0
  buffer_load_dwordx4 v9, s[12:15], s40 offen lds
  v_mfma_f32_16x16x32_bf16 a[40:43], v[104:107], v[40:43], a[40:43]
  ds_read_b64_tr_b16 v[76:77], v29 offset:224
  ds_read_b64_tr_b16 v[78:79], v29 offset:2528
  v_mfma_f32_16x16x32_bf16 a[44:47], v[104:107], v[44:47], a[44:47]
  ds_read_b64_tr_b16 v[80:81], v28 offset:256
  ds_read_b64_tr_b16 v[82:83], v28 offset:2560
  v_mfma_f32_16x16x32_bf16 a[48:51], v[108:111], v[40:43], a[48:51]
  v_mfma_f32_16x16x32_bf16 a[52:55], v[108:111], v[44:47], a[52:55]
  v_mfma_f32_16x16x32_bf16 a[56:59], v[112:115], v[40:43], a[56:59]
  v_mfma_f32_16x16x32_bf16 a[60:63], v[112:115], v[44:47], a[60:63]
  s_add_u32 m0, s43, 0
  s_nop 0
  buffer_load_dwordx4 v12, s[16:19], s41 offen lds
  v_mfma_f32_16x16x32_bf16 a[64:67], v[116:119], v[40:43], a[64:67]
  v_mfma_f32_16x16x32_bf16 a[68:71], v[116:119], v[44:47], a[68:71]
  s_sub_u32 s32, s32, 1
  s_cmp_lg_u32 s32, 0
  s_cbranch_scc1 g8_loop_41
  s_waitcnt vmcnt(0) lgkmcnt(0)
  s_barrier
  s_lshl_b32 s35, s44, 5
  s_add_u32 s35, s35, s24
  v_and_b32 v5, 15, v1
  v_lshrrev_b32 v6, 4, v1
  v_mul_u32_u24 v5, 304, v5
  v_lshlrev_b32 v6, 3, v6
  s_mul_i32 s36, s27, 9728
  v_add3_u32 v5, v5, v6, s36
  s_mul_i32 s37, s45, 288
  s_lshl_b32 s38, s25, 1
  s_add_u32 s37, s37, s38
  s_mov_b32 s39, 9216
  v_lshrrev_b32 v11, 4, v1
  v_and_b32 v6, 15, v1
  v_lshlrev_b32 v6, 4, v6
  v_mul_u32_u24 v7, 304, v11
  v_add3_u32 v7, v7, v6, s36
  v_add_u32 v11, s35, v11
  v_mul_lo_u32 v11, v11, s39
  v_add3_u32 v11, v11, v6, s37
  v_lshrrev_b32 v8, 1, v1
  v_and_b32 v9, 1, v1
  v_lshlrev_b32 v9, 4, v9
  v_add_u32 v9, 256, v9
  v_mul_u32_u24 v10, 304, v8
  v_add3_u32 v10, v10, v9, s36
  v_add_u32 v8, s35, v8
  v_mul_lo_u32 v8, v8, s39
  v_add3_u32 v8, v8, v9, s37
  s_mov_b32 s38, 0xbfb8aa3b
  v_accvgpr_read_b32 v32, a0
  v_accvgpr_read_b32 v33, a1
  v_accvgpr_read_b32 v34, a2
  v_accvgpr_read_b32 v35, a3
  v_cvt_pk_bf16_f32 v40, v32, v33
  v_lshlrev_b32 v32, 16, v40
  v_and_b32 v33, 0xffff0000, v40
  v_cvt_pk_bf16_f32 v40, v34, v35
  v_lshlrev_b32 v34, 16, v40
  v_and_b32 v35, 0xffff0000, v40
  v_mul_f32 v36, s38, v32
  v_mul_f32 v37, s38, v33
  v_mul_f32 v38, s38, v34
  v_mul_f32 v39, s38, v35
  v_exp_f32 v36, v36
  v_exp_f32 v37, v37
  v_exp_f32 v38, v38
  v_exp_f32 v39, v39
  v_add_f32 v36, 1.0, v36
  v_add_f32 v37, 1.0, v37
  v_add_f32 v38, 1.0, v38
  v_add_f32 v39, 1.0, v39
  v_rcp_f32 v36, v36
  v_rcp_f32 v37, v37
  v_rcp_f32 v38, v38
  v_rcp_f32 v39, v39
  s_nop 0
  v_mul_f32 v32, v32, v36
  v_mul_f32 v33, v33, v37
  v_mul_f32 v34, v34, v38
  v_mul_f32 v35, v35, v39
  v_cvt_pk_bf16_f32 v40, v32, v33
  v_cvt_pk_bf16_f32 v41, v34, v35
  ds_write_b64 v5, v[40:41] offset:0
  v_accvgpr_read_b32 v44, a8
  v_accvgpr_read_b32 v45, a9
  v_accvgpr_read_b32 v46, a10
  v_accvgpr_read_b32 v47, a11
  v_cvt_pk_bf16_f32 v52, v44, v45
  v_lshlrev_b32 v44, 16, v52
  v_and_b32 v45, 0xffff0000, v52
  v_cvt_pk_bf16_f32 v52, v46, v47
  v_lshlrev_b32 v46, 16, v52
  v_and_b32 v47, 0xffff0000, v52
  v_mul_f32 v48, s38, v44
  v_mul_f32 v49, s38, v45
  v_mul_f32 v50, s38, v46
  v_mul_f32 v51, s38, v47
  v_exp_f32 v48, v48
  v_exp_f32 v49, v49
  v_exp_f32 v50, v50
  v_exp_f32 v51, v51
  v_add_f32 v48, 1.0, v48
  v_add_f32 v49, 1.0, v49
  v_add_f32 v50, 1.0, v50
  v_add_f32 v51, 1.0, v51
  v_rcp_f32 v48, v48
  v_rcp_f32 v49, v49
  v_rcp_f32 v50, v50
  v_rcp_f32 v51, v51
  s_nop 0
  v_mul_f32 v44, v44, v48
  v_mul_f32 v45, v45, v49
  v_mul_f32 v46, v46, v50
  v_mul_f32 v47, v47, v51
  v_cvt_pk_bf16_f32 v52, v44, v45
  v_cvt_pk_bf16_f32 v53, v46, v47
  ds_write_b64 v5, v[52:53] offset:32
  v_accvgpr_read_b32 v56, a16
  v_accvgpr_read_b32 v57, a17
  v_accvgpr_read_b32 v58, a18
  v_accvgpr_read_b32 v59, a19
  v_cvt_pk_bf16_f32 v64, v56, v57
  v_lshlrev_b32 v56, 16, v64
  v_and_b32 v57, 0xffff0000, v64
  v_cvt_pk_bf16_f32 v64, v58, v59
  v_lshlrev_b32 v58, 16, v64
  v_and_b32 v59, 0xffff0000, v64
  v_mul_f32 v60, s38, v56
  v_mul_f32 v61, s38, v57
  v_mul_f32 v62, s38, v58
  v_mul_f32 v63, s38, v59
  v_exp_f32 v60, v60
  v_exp_f32 v61, v61
  v_exp_f32 v62, v62
  v_exp_f32 v63, v63
  v_add_f32 v60, 1.0, v60
  v_add_f32 v61, 1.0, v61
  v_add_f32 v62, 1.0, v62
  v_add_f32 v63, 1.0, v63
  v_rcp_f32 v60, v60
  v_rcp_f32 v61, v61
  v_rcp_f32 v62, v62
  v_rcp_f32 v63, v63
  s_nop 0
  v_mul_f32 v56, v56, v60
  v_mul_f32 v57, v57, v61
  v_mul_f32 v58, v58, v62
  v_mul_f32 v59, v59, v63
  v_cvt_pk_bf16_f32 v64, v56, v57
  v_cvt_pk_bf16_f32 v65, v58, v59
  ds_write_b64 v5, v[64:65] offset:64
  v_accvgpr_read_b32 v68, a24
  v_accvgpr_read_b32 v69, a25
  v_accvgpr_read_b32 v70, a26
  v_accvgpr_read_b32 v71, a27
  v_cvt_pk_bf16_f32 v76, v68, v69
  v_lshlrev_b32 v68, 16, v76
  v_and_b32 v69, 0xffff0000, v76
  v_cvt_pk_bf16_f32 v76, v70, v71
  v_lshlrev_b32 v70, 16, v76
  v_and_b32 v71, 0xffff0000, v76
  v_mul_f32 v72, s38, v68
  v_mul_f32 v73, s38, v69
  v_mul_f32 v74, s38, v70
  v_mul_f32 v75, s38, v71
  v_exp_f32 v72, v72
  v_exp_f32 v73, v73
  v_exp_f32 v74, v74
  v_exp_f32 v75, v75
  v_add_f32 v72, 1.0, v72
  v_add_f32 v73, 1.0, v73
  v_add_f32 v74, 1.0, v74
  v_add_f32 v75, 1.0, v75
  v_rcp_f32 v72, v72
  v_rcp_f32 v73, v73
  v_rcp_f32 v74, v74
  v_rcp_f32 v75, v75
  s_nop 0
  v_mul_f32 v68, v68, v72
  v_mul_f32 v69, v69, v73
  v_mul_f32 v70, v70, v74
  v_mul_f32 v71, v71, v75
  v_cvt_pk_bf16_f32 v76, v68, v69
  v_cvt_pk_bf16_f32 v77, v70, v71
  ds_write_b64 v5, v[76:77] offset:96
  v_accvgpr_read_b32 v80, a32
  v_accvgpr_read_b32 v81, a33
  v_accvgpr_read_b32 v82, a34
  v_accvgpr_read_b32 v83, a35
  v_cvt_pk_bf16_f32 v88, v80, v81
  v_lshlrev_b32 v80, 16, v88
  v_and_b32 v81, 0xffff0000, v88
  v_cvt_pk_bf16_f32 v88, v82, v83
  v_lshlrev_b32 v82, 16, v88
  v_and_b32 v83, 0xffff0000, v88
  v_mul_f32 v84, s38, v80
  v_mul_f32 v85, s38, v81
  v_mul_f32 v86, s38, v82
  v_mul_f32 v87, s38, v83
  v_exp_f32 v84, v84
  v_exp_f32 v85, v85
  v_exp_f32 v86, v86
  v_exp_f32 v87, v87
  v_add_f32 v84, 1.0, v84
  v_add_f32 v85, 1.0, v85
  v_add_f32 v86, 1.0, v86
  v_add_f32 v87, 1.0, v87
  v_rcp_f32 v84, v84
  v_rcp_f32 v85, v85
  v_rcp_f32 v86, v86
  v_rcp_f32 v87, v87
  s_nop 0
  v_mul_f32 v80, v80, v84
  v_mul_f32 v81, v81, v85
  v_mul_f32 v82, v82, v86
  v_mul_f32 v83, v83, v87
  v_cvt_pk_bf16_f32 v88, v80, v81
  v_cvt_pk_bf16_f32 v89, v82, v83
  ds_write_b64 v5, v[88:89] offset:128
  v_accvgpr_read_b32 v92, a40
  v_accvgpr_read_b32 v93, a41
  v_accvgpr_read_b32 v94, a42
  v_accvgpr_read_b32 v95, a43
  v_cvt_pk_bf16_f32 v100, v92, v93
  v_lshlrev_b32 v92, 16, v100
  v_and_b32 v93, 0xffff0000, v100
  v_cvt_pk_bf16_f32 v100, v94, v95
  v_lshlrev_b32 v94, 16, v100
  v_and_b32 v95, 0xffff0000, v100
  v_mul_f32 v96, s38, v92
  v_mul_f32 v97, s38, v93
  v_mul_f32 v98, s38, v94
  v_mul_f32 v99, s38, v95
  v_exp_f32 v96, v96
  v_exp_f32 v97, v97
  v_exp_f32 v98, v98
  v_exp_f32 v99, v99
  v_add_f32 v96, 1.0, v96
  v_add_f32 v97, 1.0, v97
  v_add_f32 v98, 1.0, v98
  v_add_f32 v99, 1.0, v99
  v_rcp_f32 v96, v96
  v_rcp_f32 v97, v97
  v_rcp_f32 v98, v98
  v_rcp_f32 v99, v99
  s_nop 0
  v_mul_f32 v92, v92, v96
  v_mul_f32 v93, v93, v97
  v_mul_f32 v94, v94, v98
  v_mul_f32 v95, v95, v99
  v_cvt_pk_bf16_f32 v100, v92, v93
  v_cvt_pk_bf16_f32 v101, v94, v95
  ds_write_b64 v5, v[100:101] offset:160
  v_accvgpr_read_b32 v104, a48
  v_accvgpr_read_b32 v105, a49
  v_accvgpr_read_b32 v106, a50
  v_accvgpr_read_b32 v107, a51
  v_cvt_pk_bf16_f32 v112, v104, v105
  v_lshlrev_b32 v104, 16, v112
  v_and_b32 v105, 0xffff0000, v112
  v_cvt_pk_bf16_f32 v112, v106, v107
  v_lshlrev_b32 v106, 16, v112
  v_and_b32 v107, 0xffff0000, v112
  v_mul_f32 v108, s38, v104
  v_mul_f32 v109, s38, v105
  v_mul_f32 v110, s38, v106
  v_mul_f32 v111, s38, v107
  v_exp_f32 v108, v108
  v_exp_f32 v109, v109
  v_exp_f32 v110, v110
  v_exp_f32 v111, v111
  v_add_f32 v108, 1.0, v108
  v_add_f32 v109, 1.0, v109
  v_add_f32 v110, 1.0, v110
  v_add_f32 v111, 1.0, v111
  v_rcp_f32 v108, v108
  v_rcp_f32 v109, v109
  v_rcp_f32 v110, v110
  v_rcp_f32 v111, v111
  s_nop 0
  v_mul_f32 v104, v104, v108
  v_mul_f32 v105, v105, v109
  v_mul_f32 v106, v106, v110
  v_mul_f32 v107, v107, v111
  v_cvt_pk_bf16_f32 v112, v104, v105
  v_cvt_pk_bf16_f32 v113, v106, v107
  ds_write_b64 v5, v[112:113] offset:192
  v_accvgpr_read_b32 v116, a56
  v_accvgpr_read_b32 v117, a57
  v_accvgpr_read_b32 v118, a58
  v_accvgpr_read_b32 v119, a59
  v_cvt_pk_bf16_f32 v124, v116, v117
  v_lshlrev_b32 v116, 16, v124
  v_and_b32 v117, 0xffff0000, v124
  v_cvt_pk_bf16_f32 v124, v118, v119
  v_lshlrev_b32 v118, 16, v124
  v_and_b32 v119, 0xffff0000, v124
  v_mul_f32 v120, s38, v116
  v_mul_f32 v121, s38, v117
  v_mul_f32 v122, s38, v118
  v_mul_f32 v123, s38, v119
  v_exp_f32 v120, v120
  v_exp_f32 v121, v121
  v_exp_f32 v122, v122
  v_exp_f32 v123, v123
  v_add_f32 v120, 1.0, v120
  v_add_f32 v121, 1.0, v121
  v_add_f32 v122, 1.0, v122
  v_add_f32 v123, 1.0, v123
  v_rcp_f32 v120, v120
  v_rcp_f32 v121, v121
  v_rcp_f32 v122, v122
  v_rcp_f32 v123, v123
  s_nop 0
  v_mul_f32 v116, v116, v120
  v_mul_f32 v117, v117, v121
  v_mul_f32 v118, v118, v122
  v_mul_f32 v119, v119, v123
  v_cvt_pk_bf16_f32 v124, v116, v117
  v_cvt_pk_bf16_f32 v125, v118, v119
  ds_write_b64 v5, v[124:125] offset:224
  v_accvgpr_read_b32 v32, a64
  v_accvgpr_read_b32 v33, a65
  v_accvgpr_read_b32 v34, a66
  v_accvgpr_read_b32 v35, a67
  v_cvt_pk_bf16_f32 v40, v32, v33
  v_lshlrev_b32 v32, 16, v40
  v_and_b32 v33, 0xffff0000, v40
  v_cvt_pk_bf16_f32 v40, v34, v35
  v_lshlrev_b32 v34, 16, v40
  v_and_b32 v35, 0xffff0000, v40
  v_mul_f32 v36, s38, v32
  v_mul_f32 v37, s38, v33
  v_mul_f32 v38, s38, v34
  v_mul_f32 v39, s38, v35
  v_exp_f32 v36, v36
  v_exp_f32 v37, v37
  v_exp_f32 v38, v38
  v_exp_f32 v39, v39
  v_add_f32 v36, 1.0, v36
  v_add_f32 v37, 1.0, v37
  v_add_f32 v38, 1.0, v38
  v_add_f32 v39, 1.0, v39
  v_rcp_f32 v36, v36
  v_rcp_f32 v37, v37
  v_rcp_f32 v38, v38
  v_rcp_f32 v39, v39
  s_nop 0
  v_mul_f32 v32, v32, v36
  v_mul_f32 v33, v33, v37
  v_mul_f32 v34, v34, v38
  v_mul_f32 v35, v35, v39
  v_cvt_pk_bf16_f32 v40, v32, v33
  v_cvt_pk_bf16_f32 v41, v34, v35
  ds_write_b64 v5, v[40:41] offset:256
  s_waitcnt lgkmcnt(0)
  ds_read_b128 v[128:131], v7 offset:0
  ds_read_b128 v[132:135], v7 offset:1216
  ds_read_b128 v[136:139], v7 offset:2432
  ds_read_b128 v[140:143], v7 offset:3648
  s_mov_b32 s40, 0
  s_waitcnt lgkmcnt(3)
  buffer_store_dwordx4 v[128:131], v11, s[20:23], s40 offen
  s_mov_b32 s40, 36864
  s_waitcnt lgkmcnt(2)
  buffer_store_dwordx4 v[132:135], v11, s[20:23], s40 offen
  s_mov_b32 s40, 73728
  s_waitcnt lgkmcnt(1)
  buffer_store_dwordx4 v[136:139], v11, s[20:23], s40 offen
  s_mov_b32 s40, 110592
  s_waitcnt lgkmcnt(0)
  buffer_store_dwordx4 v[140:143], v11, s[20:23], s40 offen
  v_accvgpr_read_b32 v32, a4
  v_accvgpr_read_b32 v33, a5
  v_accvgpr_read_b32 v34, a6
  v_accvgpr_read_b32 v35, a7
  v_cvt_pk_bf16_f32 v40, v32, v33
  v_lshlrev_b32 v32, 16, v40
  v_and_b32 v33, 0xffff0000, v40
  v_cvt_pk_bf16_f32 v40, v34, v35
  v_lshlrev_b32 v34, 16, v40
  v_and_b32 v35, 0xffff0000, v40
  v_mul_f32 v36, s38, v32
  v_mul_f32 v37, s38, v33
  v_mul_f32 v38, s38, v34
  v_mul_f32 v39, s38, v35
  v_exp_f32 v36, v36
  v_exp_f32 v37, v37
  v_exp_f32 v38, v38
  v_exp_f32 v39, v39
  v_add_f32 v36, 1.0, v36
  v_add_f32 v37, 1.0, v37
  v_add_f32 v38, 1.0, v38
  v_add_f32 v39, 1.0, v39
  v_rcp_f32 v36, v36
  v_rcp_f32 v37, v37
  v_rcp_f32 v38, v38
  v_rcp_f32 v39, v39
  s_nop 0
  v_mul_f32 v32, v32, v36
  v_mul_f32 v33, v33, v37
  v_mul_f32 v34, v34, v38
  v_mul_f32 v35, v35, v39
  v_cvt_pk_bf16_f32 v40, v32, v33
  v_cvt_pk_bf16_f32 v41, v34, v35
  ds_write_b64 v5, v[40:41] offset:4864
  v_accvgpr_read_b32 v44, a12
  v_accvgpr_read_b32 v45, a13
  v_accvgpr_read_b32 v46, a14
  v_accvgpr_read_b32 v47, a15
  v_cvt_pk_bf16_f32 v52, v44, v45
  v_lshlrev_b32 v44, 16, v52
  v_and_b32 v45, 0xffff0000, v52
  v_cvt_pk_bf16_f32 v52, v46, v47
  v_lshlrev_b32 v46, 16, v52
  v_and_b32 v47, 0xffff0000, v52
  v_mul_f32 v48, s38, v44
  v_mul_f32 v49, s38, v45
  v_mul_f32 v50, s38, v46
  v_mul_f32 v51, s38, v47
  v_exp_f32 v48, v48
  v_exp_f32 v49, v49
  v_exp_f32 v50, v50
  v_exp_f32 v51, v51
  v_add_f32 v48, 1.0, v48
  v_add_f32 v49, 1.0, v49
  v_add_f32 v50, 1.0, v50
  v_add_f32 v51, 1.0, v51
  v_rcp_f32 v48, v48
  v_rcp_f32 v49, v49
  v_rcp_f32 v50, v50
  v_rcp_f32 v51, v51
  s_nop 0
  v_mul_f32 v44, v44, v48
  v_mul_f32 v45, v45, v49
  v_mul_f32 v46, v46, v50
  v_mul_f32 v47, v47, v51
  v_cvt_pk_bf16_f32 v52, v44, v45
  v_cvt_pk_bf16_f32 v53, v46, v47
  ds_write_b64 v5, v[52:53] offset:4896
  v_accvgpr_read_b32 v56, a20
  v_accvgpr_read_b32 v57, a21
  v_accvgpr_read_b32 v58, a22
  v_accvgpr_read_b32 v59, a23
  v_cvt_pk_bf16_f32 v64, v56, v57
  v_lshlrev_b32 v56, 16, v64
  v_and_b32 v57, 0xffff0000, v64
  v_cvt_pk_bf16_f32 v64, v58, v59
  v_lshlrev_b32 v58, 16, v64
  v_and_b32 v59, 0xffff0000, v64
  v_mul_f32 v60, s38, v56
  v_mul_f32 v61, s38, v57
  v_mul_f32 v62, s38, v58
  v_mul_f32 v63, s38, v59
  v_exp_f32 v60, v60
  v_exp_f32 v61, v61
  v_exp_f32 v62, v62
  v_exp_f32 v63, v63
  v_add_f32 v60, 1.0, v60
  v_add_f32 v61, 1.0, v61
  v_add_f32 v62, 1.0, v62
  v_add_f32 v63, 1.0, v63
  v_rcp_f32 v60, v60
  v_rcp_f32 v61, v61
  v_rcp_f32 v62, v62
  v_rcp_f32 v63, v63
  s_nop 0
  v_mul_f32 v56, v56, v60
  v_mul_f32 v57, v57, v61
  v_mul_f32 v58, v58, v62
  v_mul_f32 v59, v59, v63
  v_cvt_pk_bf16_f32 v64, v56, v57
  v_cvt_pk_bf16_f32 v65, v58, v59
  ds_write_b64 v5, v[64:65] offset:4928
  v_accvgpr_read_b32 v68, a28
  v_accvgpr_read_b32 v69, a29
  v_accvgpr_read_b32 v70, a30
  v_accvgpr_read_b32 v71, a31
  v_cvt_pk_bf16_f32 v76, v68, v69
  v_lshlrev_b32 v68, 16, v76
  v_and_b32 v69, 0xffff0000, v76
  v_cvt_pk_bf16_f32 v76, v70, v71
  v_lshlrev_b32 v70, 16, v76
  v_and_b32 v71, 0xffff0000, v76
  v_mul_f32 v72, s38, v68
  v_mul_f32 v73, s38, v69
  v_mul_f32 v74, s38, v70
  v_mul_f32 v75, s38, v71
  v_exp_f32 v72, v72
  v_exp_f32 v73, v73
  v_exp_f32 v74, v74
  v_exp_f32 v75, v75
  v_add_f32 v72, 1.0, v72
  v_add_f32 v73, 1.0, v73
  v_add_f32 v74, 1.0, v74
  v_add_f32 v75, 1.0, v75
  v_rcp_f32 v72, v72
  v_rcp_f32 v73, v73
  v_rcp_f32 v74, v74
  v_rcp_f32 v75, v75
  s_nop 0
  v_mul_f32 v68, v68, v72
  v_mul_f32 v69, v69, v73
  v_mul_f32 v70, v70, v74
  v_mul_f32 v71, v71, v75
  v_cvt_pk_bf16_f32 v76, v68, v69
  v_cvt_pk_bf16_f32 v77, v70, v71
  ds_write_b64 v5, v[76:77] offset:4960
  v_accvgpr_read_b32 v80, a36
  v_accvgpr_read_b32 v81, a37
  v_accvgpr_read_b32 v82, a38
  v_accvgpr_read_b32 v83, a39
  v_cvt_pk_bf16_f32 v88, v80, v81
  v_lshlrev_b32 v80, 16, v88
  v_and_b32 v81, 0xffff0000, v88
  v_cvt_pk_bf16_f32 v88, v82, v83
  v_lshlrev_b32 v82, 16, v88
  v_and_b32 v83, 0xffff0000, v88
  v_mul_f32 v84, s38, v80
  v_mul_f32 v85, s38, v81
  v_mul_f32 v86, s38, v82
  v_mul_f32 v87, s38, v83
  v_exp_f32 v84, v84
  v_exp_f32 v85, v85
  v_exp_f32 v86, v86
  v_exp_f32 v87, v87
  v_add_f32 v84, 1.0, v84
  v_add_f32 v85, 1.0, v85
  v_add_f32 v86, 1.0, v86
  v_add_f32 v87, 1.0, v87
  v_rcp_f32 v84, v84
  v_rcp_f32 v85, v85
  v_rcp_f32 v86, v86
  v_rcp_f32 v87, v87
  s_nop 0
  v_mul_f32 v80, v80, v84
  v_mul_f32 v81, v81, v85
  v_mul_f32 v82, v82, v86
  v_mul_f32 v83, v83, v87
  v_cvt_pk_bf16_f32 v88, v80, v81
  v_cvt_pk_bf16_f32 v89, v82, v83
  ds_write_b64 v5, v[88:89] offset:4992
  v_accvgpr_read_b32 v92, a44
  v_accvgpr_read_b32 v93, a45
  v_accvgpr_read_b32 v94, a46
  v_accvgpr_read_b32 v95, a47
  v_cvt_pk_bf16_f32 v100, v92, v93
  v_lshlrev_b32 v92, 16, v100
  v_and_b32 v93, 0xffff0000, v100
  v_cvt_pk_bf16_f32 v100, v94, v95
  v_lshlrev_b32 v94, 16, v100
  v_and_b32 v95, 0xffff0000, v100
  v_mul_f32 v96, s38, v92
  v_mul_f32 v97, s38, v93
  v_mul_f32 v98, s38, v94
  v_mul_f32 v99, s38, v95
  v_exp_f32 v96, v96
  v_exp_f32 v97, v97
  v_exp_f32 v98, v98
  v_exp_f32 v99, v99
  v_add_f32 v96, 1.0, v96
  v_add_f32 v97, 1.0, v97
  v_add_f32 v98, 1.0, v98
  v_add_f32 v99, 1.0, v99
  v_rcp_f32 v96, v96
  v_rcp_f32 v97, v97
  v_rcp_f32 v98, v98
  v_rcp_f32 v99, v99
  s_nop 0
  v_mul_f32 v92, v92, v96
  v_mul_f32 v93, v93, v97
  v_mul_f32 v94, v94, v98
  v_mul_f32 v95, v95, v99
  v_cvt_pk_bf16_f32 v100, v92, v93
  v_cvt_pk_bf16_f32 v101, v94, v95
  ds_write_b64 v5, v[100:101] offset:5024
  v_accvgpr_read_b32 v104, a52
  v_accvgpr_read_b32 v105, a53
  v_accvgpr_read_b32 v106, a54
  v_accvgpr_read_b32 v107, a55
  v_cvt_pk_bf16_f32 v112, v104, v105
  v_lshlrev_b32 v104, 16, v112
  v_and_b32 v105, 0xffff0000, v112
  v_cvt_pk_bf16_f32 v112, v106, v107
  v_lshlrev_b32 v106, 16, v112
  v_and_b32 v107, 0xffff0000, v112
  v_mul_f32 v108, s38, v104
  v_mul_f32 v109, s38, v105
  v_mul_f32 v110, s38, v106
  v_mul_f32 v111, s38, v107
  v_exp_f32 v108, v108
  v_exp_f32 v109, v109
  v_exp_f32 v110, v110
  v_exp_f32 v111, v111
  v_add_f32 v108, 1.0, v108
  v_add_f32 v109, 1.0, v109
  v_add_f32 v110, 1.0, v110
  v_add_f32 v111, 1.0, v111
  v_rcp_f32 v108, v108
  v_rcp_f32 v109, v109
  v_rcp_f32 v110, v110
  v_rcp_f32 v111, v111
  s_nop 0
  v_mul_f32 v104, v104, v108
  v_mul_f32 v105, v105, v109
  v_mul_f32 v106, v106, v110
  v_mul_f32 v107, v107, v111
  v_cvt_pk_bf16_f32 v112, v104, v105
  v_cvt_pk_bf16_f32 v113, v106, v107
  ds_write_b64 v5, v[112:113] offset:5056
  v_accvgpr_read_b32 v116, a60
  v_accvgpr_read_b32 v117, a61
  v_accvgpr_read_b32 v118, a62
  v_accvgpr_read_b32 v119, a63
  v_cvt_pk_bf16_f32 v124, v116, v117
  v_lshlrev_b32 v116, 16, v124
  v_and_b32 v117, 0xffff0000, v124
  v_cvt_pk_bf16_f32 v124, v118, v119
  v_lshlrev_b32 v118, 16, v124
  v_and_b32 v119, 0xffff0000, v124
  v_mul_f32 v120, s38, v116
  v_mul_f32 v121, s38, v117
  v_mul_f32 v122, s38, v118
  v_mul_f32 v123, s38, v119
  v_exp_f32 v120, v120
  v_exp_f32 v121, v121
  v_exp_f32 v122, v122
  v_exp_f32 v123, v123
  v_add_f32 v120, 1.0, v120
  v_add_f32 v121, 1.0, v121
  v_add_f32 v122, 1.0, v122
  v_add_f32 v123, 1.0, v123
  v_rcp_f32 v120, v120
  v_rcp_f32 v121, v121
  v_rcp_f32 v122, v122
  v_rcp_f32 v123, v123
  s_nop 0
  v_mul_f32 v116, v116, v120
  v_mul_f32 v117, v117, v121
  v_mul_f32 v118, v118, v122
  v_mul_f32 v119, v119, v123
  v_cvt_pk_bf16_f32 v124, v116, v117
  v_cvt_pk_bf16_f32 v125, v118, v119
  ds_write_b64 v5, v[124:125] offset:5088
  v_accvgpr_read_b32 v32, a68
  v_accvgpr_read_b32 v33, a69
  v_accvgpr_read_b32 v34, a70
  v_accvgpr_read_b32 v35, a71
  v_cvt_pk_bf16_f32 v40, v32, v33
  v_lshlrev_b32 v32, 16, v40
  v_and_b32 v33, 0xffff0000, v40
  v_cvt_pk_bf16_f32 v40, v34, v35
  v_lshlrev_b32 v34, 16, v40
  v_and_b32 v35, 0xffff0000, v40
  v_mul_f32 v36, s38, v32
  v_mul_f32 v37, s38, v33
  v_mul_f32 v38, s38, v34
  v_mul_f32 v39, s38, v35
  v_exp_f32 v36, v36
  v_exp_f32 v37, v37
  v_exp_f32 v38, v38
  v_exp_f32 v39, v39
  v_add_f32 v36, 1.0, v36
  v_add_f32 v37, 1.0, v37
  v_add_f32 v38, 1.0, v38
  v_add_f32 v39, 1.0, v39
  v_rcp_f32 v36, v36
  v_rcp_f32 v37, v37
  v_rcp_f32 v38, v38
  v_rcp_f32 v39, v39
  s_nop 0
  v_mul_f32 v32, v32, v36
  v_mul_f32 v33, v33, v37
  v_mul_f32 v34, v34, v38
  v_mul_f32 v35, v35, v39
  v_cvt_pk_bf16_f32 v40, v32, v33
  v_cvt_pk_bf16_f32 v41, v34, v35
  ds_write_b64 v5, v[40:41] offset:5120
  s_waitcnt lgkmcnt(0)
  ds_read_b128 v[144:147], v7 offset:4864
  ds_read_b128 v[148:151], v7 offset:6080
  ds_read_b128 v[152:155], v7 offset:7296
  ds_read_b128 v[156:159], v7 offset:8512
  ds_read_b128 v[160:163], v10
  s_mov_b32 s40, 147456
  s_waitcnt lgkmcnt(4)
  buffer_store_dwordx4 v[144:147], v11, s[20:23], s40 offen
  s_mov_b32 s40, 184320
  s_waitcnt lgkmcnt(3)
  buffer_store_dwordx4 v[148:151], v11, s[20:23], s40 offen
  s_mov_b32 s40, 221184
  s_waitcnt lgkmcnt(2)
  buffer_store_dwordx4 v[152:155], v11, s[20:23], s40 offen
  s_mov_b32 s40, 258048
  s_waitcnt lgkmcnt(1)
  buffer_store_dwordx4 v[156:159], v11, s[20:23], s40 offen
  s_waitcnt lgkmcnt(0)
  buffer_store_dwordx4 v[160:163], v8, s[20:23], 0 offen
g8_end_40:
  s_endpgm
.text
.globl ffn2_kernel
.p2align 8
.type ffn2_kernel,@function
ffn2_kernel:
  s_cmp_ge_u32 s2, 256
  s_cbranch_scc1 g_end_42
  s_load_dwordx2 s[4:5], s[0:1], 96
  s_load_dwordx2 s[6:7], s[0:1], 56
  v_and_b32 v1, 63, v0
  v_lshrrev_b32 v2, 6, v0
  s_and_b32 s33, s2, 7
  s_lshr_b32 s34, s2, 3
  s_lshr_b32 s26, s33, 1
  s_and_b32 s35, s33, 1
  s_lshl_b32 s35, s35, 3
  s_lshr_b32 s24, s34, 2
  s_add_u32 s24, s24, s35
  s_lshl_b32 s24, s24, 7
  s_and_b32 s25, s34, 3
  s_mul_i32 s25, s25, 144
  v_readfirstlane_b32 s27, v2
  s_waitcnt lgkmcnt(0)
  s_add_u32 s12, s4, 0x2800000
  s_addc_u32 s13, s5, 0
  s_mov_b32 s14, 0x1200000
  s_mov_b32 s15, 0x00020000
  s_mov_b32 s16, s6
  s_mov_b32 s17, s7
  s_mov_b32 s18, 0x510000
  s_mov_b32 s19, 0x00020000
  s_add_u32 s20, s4, 0x5400000
  s_addc_u32 s21, s5, 0
  s_mov_b32 s22, 0x900000
  s_mov_b32 s23, 0x00020000
  s_mul_i32 s28, s26, 2304
  s_mul_i32 s29, s26, 1327104
  v_lshrrev_b32 v3, 3, v1
  v_lshrrev_b32 v4, 4, v1
  v_and_b32 v5, 7, v1
  s_lshl_b32 s35, s27, 5
  s_add_u32 s35, s35, s24
  s_mov_b32 s36, 9216
  v_add_u32 v6, 0, v4
  v_and_b32 v6, 7, v6
  v_xor_b32 v6, v6, v5
  v_lshlrev_b32 v6, 4, v6
  v_add_u32 v7, 0, v3
  v_add_u32 v7, s35, v7
  v_mul_lo_u32 v7, v7, s36
  v_add_u32 v8, v7, v6
  v_add_u32 v6, 4, v4
  v_and_b32 v6, 7, v6
  v_xor_b32 v6, v6, v5
  v_lshlrev_b32 v6, 4, v6
  v_add_u32 v7, 8, v3
  v_add_u32 v7, s35, v7
  v_mul_lo_u32 v7, v7, s36
  v_add_u32 v9, v7, v6
  v_add_u32 v6, 8, v4
  v_and_b32 v6, 7, v6
  v_xor_b32 v6, v6, v5
  v_lshlrev_b32 v6, 4, v6
  v_add_u32 v7, 16, v3
  v_add_u32 v7, s35, v7
  v_mul_lo_u32 v7, v7, s36
  v_add_u32 v10, v7, v6
  v_add_u32 v6, 12, v4
  v_and_b32 v6, 7, v6
  v_xor_b32 v6, v6, v5
  v_lshlrev_b32 v6, 4, v6
  v_add_u32 v7, 24, v3
  v_add_u32 v7, s35, v7
  v_mul_lo_u32 v7, v7, s36
  v_add_u32 v11, v7, v6
  s_mov_b32 s36, 1152
  s_lshl_b32 s35, s27, 4
  s_lshl_b32 s37, s25, 1
  v_add_u32 v3, 0, v1
  v_mul_u32_u24 v4, 3277, v3
  v_lshrrev_b32 v4, 16, v4
  v_mul_u32_u24 v5, 20, v4
  v_sub_u32 v5, v3, v5
  v_lshrrev_b32 v6, 3, v4
  v_and_b32 v6, 1, v6
  v_lshlrev_b32 v6, 1, v6
  v_xor_b32 v5, v5, v6
  v_min_u32 v5, 17, v5
  v_lshlrev_b32 v5, 4, v5
  v_add_u32 v4, s35, v4
  v_mul_lo_u32 v4, v4, s36
  v_add3_u32 v12, v4, v5, s37
  v_add_u32 v3, 64, v1
  v_mul_u32_u24 v4, 3277, v3
  v_lshrrev_b32 v4, 16, v4
  v_mul_u32_u24 v5, 20, v4
  v_sub_u32 v5, v3, v5
  v_lshrrev_b32 v6, 3, v4
  v_and_b32 v6, 1, v6
  v_lshlrev_b32 v6, 1, v6
  v_xor_b32 v5, v5, v6
  v_min_u32 v5, 17, v5
  v_lshlrev_b32 v5, 4, v5
  v_add_u32 v4, s35, v4
  v_mul_lo_u32 v4, v4, s36
  v_add3_u32 v13, v4, v5, s37
  v_add_u32 v3, 128, v1
  v_mul_u32_u24 v4, 3277, v3
  v_lshrrev_b32 v4, 16, v4
  v_mul_u32_u24 v5, 20, v4
  v_sub_u32 v5, v3, v5
  v_lshrrev_b32 v6, 3, v4
  v_and_b32 v6, 1, v6
  v_lshlrev_b32 v6, 1, v6
  v_xor_b32 v5, v5, v6
  v_min_u32 v5, 17, v5
  v_lshlrev_b32 v5, 4, v5
  v_add_u32 v4, s35, v4
  v_mul_lo_u32 v4, v4, s36
  v_add3_u32 v14, v4, v5, s37
  v_add_u32 v3, 192, v1
  v_mul_u32_u24 v4, 3277, v3
  v_lshrrev_b32 v4, 16, v4
  v_mul_u32_u24 v5, 20, v4
  v_sub_u32 v5, v3, v5
  v_lshrrev_b32 v6, 3, v4
  v_and_b32 v6, 1, v6
  v_lshlrev_b32 v6, 1, v6
  v_xor_b32 v5, v5, v6
  v_min_u32 v5, 17, v5
  v_lshlrev_b32 v5, 4, v5
  v_add_u32 v4, s35, v4
  v_mul_lo_u32 v4, v4, s36
  v_add3_u32 v15, v4, v5, s37
  v_add_u32 v3, 256, v1
  v_mul_u32_u24 v4, 3277, v3
  v_lshrrev_b32 v4, 16, v4
  v_mul_u32_u24 v5, 20, v4
  v_sub_u32 v5, v3, v5
  v_lshrrev_b32 v6, 3, v4
  v_and_b32 v6, 1, v6
  v_lshlrev_b32 v6, 1, v6
  v_xor_b32 v5, v5, v6
  v_min_u32 v5, 17, v5
  v_lshlrev_b32 v5, 4, v5
  v_add_u32 v4, s35, v4
  v_mul_lo_u32 v4, v4, s36
  v_add3_u32 v16, v4, v5, s37
  s_lshl_b32 s38, s27, 12
  s_mul_i32 s39, s27, 5120
  s_add_u32 s39, s39, 16384
  s_mov_b32 s30, 0
  s_mov_b32 s31, 0
  s_mov_b32 s34, 0
  s_cmp_lt_u32 s34, 18
  s_cselect_b32 s40, s28, 0x40000000
  s_cselect_b32 s41, s29, 0x40000000
  s_add_u32 s42, s30, s38
  s_add_u32 s43, s30, s39
  s_add_u32 m0, s42, 0
  s_nop 0
  buffer_load_dwordx4 v8, s[12:15], s40 offen lds
  s_add_u32 m0, s42, 1024
  s_nop 0
  buffer_load_dwordx4 v9, s[12:15], s40 offen lds
  s_add_u32 m0, s42, 2048
  s_nop 0
  buffer_load_dwordx4 v10, s[12:15], s40 offen lds
  s_add_u32 m0, s42, 3072
  s_nop 0
  buffer_load_dwordx4 v11, s[12:15], s40 offen lds
  s_add_u32 m0, s43, 0
  s_nop 0
  buffer_load_dwordx4 v12, s[16:19], s41 offen lds
  s_add_u32 m0, s43, 1024
  s_nop 0
  buffer_load_dwordx4 v13, s[16:19], s41 offen lds
  s_add_u32 m0, s43, 2048
  s_nop 0
  buffer_load_dwordx4 v14, s[16:19], s41 offen lds
  s_add_u32 m0, s43, 3072
  s_nop 0
  buffer_load_dwordx4 v15, s[16:19], s41 offen lds
  s_add_u32 m0, s43, 4096
  s_nop 0
  buffer_load_dwordx4 v16, s[16:19], s41 offen lds
  s_add_u32 s28, s28, 128
  s_add_u32 s29, s29, 73728
  s_add_u32 s34, s34, 1
  s_add_u32 s30, s30, 36864
  s_cmp_eq_u32 s30, 110592
  s_cselect_b32 s30, 0, s30
  s_cmp_lt_u32 s34, 18
  s_cselect_b32 s40, s28, 0x40000000
  s_cselect_b32 s41, s29, 0x40000000
  s_add_u32 s42, s30, s38
  s_add_u32 s43, s30, s39
  s_add_u32 m0, s42, 0
  s_nop 0
  buffer_load_dwordx4 v8, s[12:15], s40 offen lds
  s_add_u32 m0, s42, 1024
  s_nop 0
  buffer_load_dwordx4 v9, s[12:15], s40 offen lds
  s_add_u32 m0, s42, 2048
  s_nop 0
  buffer_load_dwordx4 v10, s[12:15], s40 offen lds
  s_add_u32 m0, s42, 3072
  s_nop 0
  buffer_load_dwordx4 v11, s[12:15], s40 offen lds
  s_add_u32 m0, s43, 0
  s_nop 0
  buffer_load_dwordx4 v12, s[16:19], s41 offen lds
  s_add_u32 m0, s43, 1024
  s_nop 0
  buffer_load_dwordx4 v13, s[16:19], s41 offen lds
  s_add_u32 m0, s43, 2048
  s_nop 0
  buffer_load_dwordx4 v14, s[16:19], s41 offen lds
  s_add_u32 m0, s43, 3072
  s_nop 0
  buffer_load_dwordx4 v15, s[16:19], s41 offen lds
  s_add_u32 m0, s43, 4096
  s_nop 0
  buffer_load_dwordx4 v16, s[16:19], s41 offen lds
  s_add_u32 s28, s28, 128
  s_add_u32 s29, s29, 73728
  s_add_u32 s34, s34, 1
  s_add_u32 s30, s30, 36864
  s_cmp_eq_u32 s30, 110592
  s_cselect_b32 s30, 0, s30
  s_cmp_lt_u32 s34, 18
  s_cselect_b32 s40, s28, 0x40000000
  s_cselect_b32 s41, s29, 0x40000000
  s_add_u32 s42, s30, s38
  s_add_u32 s43, s30, s39
  s_add_u32 m0, s42, 0
  s_nop 0
  buffer_load_dwordx4 v8, s[12:15], s40 offen lds
  s_add_u32 m0, s42, 1024
  s_nop 0
  buffer_load_dwordx4 v9, s[12:15], s40 offen lds
  s_add_u32 m0, s42, 2048
  s_nop 0
  buffer_load_dwordx4 v10, s[12:15], s40 offen lds
  s_add_u32 m0, s42, 3072
  s_nop 0
  buffer_load_dwordx4 v11, s[12:15], s40 offen lds
  v_and_b32 v3, 15, v1
  v_lshrrev_b32 v4, 4, v1
  v_lshrrev_b32 v5, 1, v3
  s_lshl_b32 s35, s27, 5
  v_add_u32 v6, s35, v3
  v_lshlrev_b32 v6, 7, v6
  v_add_u32 v7, 0, v4
  v_xor_b32 v7, v7, v5
  v_lshlrev_b32 v7, 4, v7
  v_add_u32 v22, v6, v7
  v_add_u32 v7, 4, v4
  v_xor_b32 v7, v7, v5
  v_lshlrev_b32 v7, 4, v7
  v_add_u32 v23, v6, v7
  v_lshrrev_b32 v5, 2, v3
  v_and_b32 v6, 3, v3
  v_lshlrev_b32 v7, 3, v4
  v_add_u32 v7, v7, v5
  v_mul_u32_u24 v7, 320, v7
  v_lshlrev_b32 v6, 3, v6
  v_add_u32 v7, v7, v6
  v_add_u32 v7, 16384, v7
  v_and_b32 v4, 1, v4
  v_lshlrev_b32 v4, 5, v4
  v_add_u32 v24, v7, v4
  v_sub_u32 v25, v7, v4
  v_mov_b32 v26, v22
  v_mov_b32 v27, v23
  v_mov_b32 v28, v24
  v_mov_b32 v29, v25
  v_accvgpr_write_b32 a0, 0
  v_accvgpr_write_b32 a1, 0
  v_accvgpr_write_b32 a2, 0
  v_accvgpr_write_b32 a3, 0
  v_accvgpr_write_b32 a4, 0
  v_accvgpr_write_b32 a5, 0
  v_accvgpr_write_b32 a6, 0
  v_accvgpr_write_b32 a7, 0
  v_accvgpr_write_b32 a8, 0
  v_accvgpr_write_b32 a9, 0
  v_accvgpr_write_b32 a10, 0
  v_accvgpr_write_b32 a11, 0
  v_accvgpr_write_b32 a12, 0
  v_accvgpr_write_b32 a13, 0
  v_accvgpr_write_b32 a14, 0
  v_accvgpr_write_b32 a15, 0
  v_accvgpr_write_b32 a16, 0
  v_accvgpr_write_b32 a17, 0
  v_accvgpr_write_b32 a18, 0
  v_accvgpr_write_b32 a19, 0
  v_accvgpr_write_b32 a20, 0
  v_accvgpr_write_b32 a21, 0
  v_accvgpr_write_b32 a22, 0
  v_accvgpr_write_b32 a23, 0
  v_accvgpr_write_b32 a24, 0
  v_accvgpr_write_b32 a25, 0
  v_accvgpr_write_b32 a26, 0
  v_accvgpr_write_b32 a27, 0
  v_accvgpr_write_b32 a28, 0
  v_accvgpr_write_b32 a29, 0
  v_accvgpr_write_b32 a30, 0
  v_accvgpr_write_b32 a31, 0
  v_accvgpr_write_b32 a32, 0
  v_accvgpr_write_b32 a33, 0
  v_accvgpr_write_b32 a34, 0
  v_accvgpr_write_b32 a35, 0
  v_accvgpr_write_b32 a36, 0
  v_accvgpr_write_b32 a37, 0
  v_accvgpr_write_b32 a38, 0
  v_accvgpr_write_b32 a39, 0
  v_accvgpr_write_b32 a40, 0
  v_accvgpr_write_b32 a41, 0
  v_accvgpr_write_b32 a42, 0
  v_accvgpr_write_b32 a43, 0
  v_accvgpr_write_b32 a44, 0
  v_accvgpr_write_b32 a45, 0
  v_accvgpr_write_b32 a46, 0
  v_accvgpr_write_b32 a47, 0
  v_accvgpr_write_b32 a48, 0
  v_accvgpr_write_b32 a49, 0
  v_accvgpr_write_b32 a50, 0
  v_accvgpr_write_b32 a51, 0
  v_accvgpr_write_b32 a52, 0
  v_accvgpr_write_b32 a53, 0
  v_accvgpr_write_b32 a54, 0
  v_accvgpr_write_b32 a55, 0
  v_accvgpr_write_b32 a56, 0
  v_accvgpr_write_b32 a57, 0
  v_accvgpr_write_b32 a58, 0
  v_accvgpr_write_b32 a59, 0
  v_accvgpr_write_b32 a60, 0
  v_accvgpr_write_b32 a61, 0
  v_accvgpr_write_b32 a62, 0
  v_accvgpr_write_b32 a63, 0
  v_accvgpr_write_b32 a64, 0
  v_accvgpr_write_b32 a65, 0
  v_accvgpr_write_b32 a66, 0
  v_accvgpr_write_b32 a67, 0
  v_accvgpr_write_b32 a68, 0
  v_accvgpr_write_b32 a69, 0
  v_accvgpr_write_b32 a70, 0
  v_accvgpr_write_b32 a71, 0
  s_waitcnt vmcnt(13)
  s_barrier
  ds_read_b128 v[32:35], v26 offset:0
  ds_read_b128 v[36:39], v26 offset:2048
  ds_read_b64_tr_b16 v[48:49], v28 offset:0
  ds_read_b64_tr_b16 v[50:51], v28 offset:1280
  ds_read_b64_tr_b16 v[52:53], v29 offset:32
  ds_read_b64_tr_b16 v[54:55], v29 offset:1312
  ds_read_b64_tr_b16 v[56:57], v28 offset:64
  ds_read_b64_tr_b16 v[58:59], v28 offset:1344
  ds_read_b64_tr_b16 v[60:61], v29 offset:96
  ds_read_b64_tr_b16 v[62:63], v29 offset:1376
  ds_read_b64_tr_b16 v[64:65], v28 offset:128
  ds_read_b64_tr_b16 v[66:67], v28 offset:1408
  ds_read_b64_tr_b16 v[68:69], v29 offset:160
  ds_read_b64_tr_b16 v[70:71], v29 offset:1440
  ds_read_b64_tr_b16 v[72:73], v28 offset:192
  ds_read_b64_tr_b16 v[74:75], v28 offset:1472
  ds_read_b64_tr_b16 v[76:77], v29 offset:224
  ds_read_b64_tr_b16 v[78:79], v29 offset:1504
  ds_read_b64_tr_b16 v[80:81], v28 offset:256
  ds_read_b64_tr_b16 v[82:83], v28 offset:1536
  s_mov_b32 s32, 18
g_loop_43:
  s_waitcnt lgkmcnt(0)
  v_mfma_f32_16x16x32_bf16 a[0:3], v[48:51], v[32:35], a[0:3]
  ds_read_b128 v[40:43], v27 offset:0
  ds_read_b128 v[44:47], v27 offset:2048
  v_mfma_f32_16x16x32_bf16 a[4:7], v[48:51], v[36:39], a[4:7]
  s_add_u32 m0, s43, 0
  s_nop 0
  buffer_load_dwordx4 v12, s[16:19], s41 offen lds
  v_mfma_f32_16x16x32_bf16 a[8:11], v[52:55], v[32:35], a[8:11]
  ds_read_b64_tr_b16 v[84:85], v28 offset:10240
  ds_read_b64_tr_b16 v[86:87], v28 offset:11520
  v_mfma_f32_16x16x32_bf16 a[12:15], v[52:55], v[36:39], a[12:15]
  ds_read_b64_tr_b16 v[88:89], v29 offset:10272
  ds_read_b64_tr_b16 v[90:91], v29 offset:11552
  v_mfma_f32_16x16x32_bf16 a[16:19], v[56:59], v[32:35], a[16:19]
  ds_read_b64_tr_b16 v[92:93], v28 offset:10304
  ds_read_b64_tr_b16 v[94:95], v28 offset:11584
  v_mfma_f32_16x16x32_bf16 a[20:23], v[56:59], v[36:39], a[20:23]
  s_add_u32 m0, s43, 1024
  s_nop 0
  buffer_load_dwordx4 v13, s[16:19], s41 offen lds
  v_mfma_f32_16x16x32_bf16 a[24:27], v[60:63], v[32:35], a[24:27]
  ds_read_b64_tr_b16 v[96:97], v29 offset:10336
  ds_read_b64_tr_b16 v[98:99], v29 offset:11616
  v_mfma_f32_16x16x32_bf16 a[28:31], v[60:63], v[36:39], a[28:31]
  ds_read_b64_tr_b16 v[100:101], v28 offset:10368
  ds_read_b64_tr_b16 v[102:103], v28 offset:11648
  v_mfma_f32_16x16x32_bf16 a[32:35], v[64:67], v[32:35], a[32:35]
  ds_read_b64_tr_b16 v[104:105], v29 offset:10400
  ds_read_b64_tr_b16 v[106:107], v29 offset:11680
  v_mfma_f32_16x16x32_bf16 a[36:39], v[64:67], v[36:39], a[36:39]
  s_add_u32 m0, s43, 2048
  s_nop 0
  buffer_load_dwordx4 v14, s[16:19], s41 offen lds
  v_mfma_f32_16x16x32_bf16 a[40:43], v[68:71], v[32:35], a[40:43]
  ds_read_b64_tr_b16 v[108:109], v28 offset:10432
  ds_read_b64_tr_b16 v[110:111], v28 offset:11712
  v_mfma_f32_16x16x32_bf16 a[44:47], v[68:71], v[36:39], a[44:47]
  ds_read_b64_tr_b16 v[112:113], v29 offset:10464
  ds_read_b64_tr_b16 v[114:115], v29 offset:11744
  v_mfma_f32_16x16x32_bf16 a[48:51], v[72:75], v[32:35], a[48:51]
  s_add_u32 m0, s43, 3072
  s_nop 0
  buffer_load_dwordx4 v15, s[16:19], s41 offen lds
  v_mfma_f32_16x16x32_bf16 a[52:55], v[72:75], v[36:39], a[52:55]
  ds_read_b64_tr_b16 v[116:117], v28 offset:10496
  ds_read_b64_tr_b16 v[118:119], v28 offset:11776
  v_mfma_f32_16x16x32_bf16 a[56:59], v[76:79], v[32:35], a[56:59]
  v_mfma_f32_16x16x32_bf16 a[60:63], v[76:79], v[36:39], a[60:63]
  v_mfma_f32_16x16x32_bf16 a[64:67], v[80:83], v[32:35], a[64:67]
  s_add_u32 m0, s43, 4096
  s_nop 0
  buffer_load_dwordx4 v16, s[16:19], s41 offen lds
  s_add_u32 s28, s28, 128
  s_add_u32 s29, s29, 73728
  s_add_u32 s34, s34, 1
  s_add_u32 s30, s30, 36864
  s_cmp_eq_u32 s30, 110592
  s_cselect_b32 s30, 0, s30
  v_mfma_f32_16x16x32_bf16 a[68:71], v[80:83], v[36:39], a[68:71]
  s_waitcnt vmcnt(9) lgkmcnt(0)
  s_barrier
  s_add_u32 s31, s31, 36864
  s_cmp_eq_u32 s31, 110592
  s_cselect_b32 s31, 0, s31
  v_add_u32 v26, s31, v22
  v_add_u32 v27, s31, v23
  v_add_u32 v28, s31, v24
  v_add_u32 v29, s31, v25
  v_mfma_f32_16x16x32_bf16 a[0:3], v[84:87], v[40:43], a[0:3]
  ds_read_b128 v[32:35], v26 offset:0
  ds_read_b128 v[36:39], v26 offset:2048
  v_mfma_f32_16x16x32_bf16 a[4:7], v[84:87], v[44:47], a[4:7]
  ds_read_b64_tr_b16 v[48:49], v28 offset:0
  ds_read_b64_tr_b16 v[50:51], v28 offset:1280
  v_mfma_f32_16x16x32_bf16 a[8:11], v[88:91], v[40:43], a[8:11]
  s_cmp_lt_u32 s34, 18
  s_cselect_b32 s40, s28, 0x40000000
  s_cselect_b32 s41, s29, 0x40000000
  s_add_u32 s42, s30, s38
  s_add_u32 s43, s30, s39
  s_add_u32 m0, s42, 0
  s_nop 0
  buffer_load_dwordx4 v8, s[12:15], s40 offen lds
  v_mfma_f32_16x16x32_bf16 a[12:15], v[88:91], v[44:47], a[12:15]
  ds_read_b64_tr_b16 v[52:53], v29 offset:32
  ds_read_b64_tr_b16 v[54:55], v29 offset:1312
  v_mfma_f32_16x16x32_bf16 a[16:19], v[92:95], v[40:43], a[16:19]
  ds_read_b64_tr_b16 v[56:57], v28 offset:64
  ds_read_b64_tr_b16 v[58:59], v28 offset:1344
  v_mfma_f32_16x16x32_bf16 a[20:23], v[92:95], v[44:47], a[20:23]
  ds_read_b64_tr_b16 v[60:61], v29 offset:96
  ds_read_b64_tr_b16 v[62:63], v29 offset:1376
  v_mfma_f32_16x16x32_bf16 a[24:27], v[96:99], v[40:43], a[24:27]
  s_add_u32 m0, s42, 1024
  s_nop 0
  buffer_load_dwordx4 v9, s[12:15], s40 offen lds
  v_mfma_f32_16x16x32_bf16 a[28:31], v[96:99], v[44:47], a[28:31]
  ds_read_b64_tr_b16 v[64:65], v28 offset:128
  ds_read_b64_tr_b16 v[66:67], v28 offset:1408
  v_mfma_f32_16x16x32_bf16 a[32:35], v[100:103], v[40:43], a[32:35]
  ds_read_b64_tr_b16 v[68:69], v29 offset:160
  ds_read_b64_tr_b16 v[70:71], v29 offset:1440
  v_mfma_f32_16x16x32_bf16 a[36:39], v[100:103], v[44:47], a[36:39]
  ds_read_b64_tr_b16 v[72:73], v28 offset:192
  ds_read_b64_tr_b16 v[74:75], v28 offset:1472
  v_mfma_f32_16x16x32_bf16 a[40:43], v[104:107], v[40:43], a[40:43]
  ds_read_b64_tr_b16 v[76:77], v29 offset:224
  ds_read_b64_tr_b16 v[78:79], v29 offset:1504
  v_mfma_f32_16x16x32_bf16 a[44:47], v[104:107], v[44:47], a[44:47]
  s_add_u32 m0, s42, 2048
  s_nop 0
  buffer_load_dwordx4 v10, s[12:15], s40 offen lds
  v_mfma_f32_16x16x32_bf16 a[48:51], v[108:111], v[40:43], a[48:51]
  ds_read_b64_tr_b16 v[80:81], v28 offset:256
  ds_read_b64_tr_b16 v[82:83], v28 offset:1536
  v_mfma_f32_16x16x32_bf16 a[52:55], v[108:111], v[44:47], a[52:55]
  v_mfma_f32_16x16x32_bf16 a[56:59], v[112:115], v[40:43], a[56:59]
  v_mfma_f32_16x16x32_bf16 a[60:63], v[112:115], v[44:47], a[60:63]
  s_add_u32 m0, s42, 3072
  s_nop 0
  buffer_load_dwordx4 v11, s[12:15], s40 offen lds
  v_mfma_f32_16x16x32_bf16 a[64:67], v[116:119], v[40:43], a[64:67]
  v_mfma_f32_16x16x32_bf16 a[68:71], v[116:119], v[44:47], a[68:71]
  s_sub_u32 s32, s32, 1
  s_cmp_lg_u32 s32, 0
  s_cbranch_scc1 g_loop_43
  s_waitcnt vmcnt(0) lgkmcnt(0)
  s_nop 7
  s_nop 7
  v_and_b32 v3, 15, v1
  v_lshrrev_b32 v4, 4, v1
  s_lshl_b32 s35, s27, 5
  s_add_u32 s35, s35, s24
  v_add_u32 v3, s35, v3
  v_lshlrev_b32 v4, 2, v4
  v_add_u32 v4, s25, v4
  s_barrier
  v_and_b32 v5, 15, v1
  v_lshrrev_b32 v6, 4, v1
  v_mul_u32_u24 v5, 304, v5
  v_lshlrev_b32 v6, 3, v6
  s_mul_i32 s36, s27, 9728
  v_add3_u32 v5, v5, v6, s36
  s_mul_i32 s38, s26, 2359296
  s_lshl_b32 s37, s25, 1
  s_add_u32 s37, s37, s38
  s_movk_i32 s39, 1152
  v_lshrrev_b32 v11, 4, v1
  v_and_b32 v6, 15, v1
  v_lshlrev_b32 v6, 4, v6
  v_mul_u32_u24 v7, 304, v11
  v_add3_u32 v7, v7, v6, s36
  v_add_u32 v11, s35, v11
  v_mul_lo_u32 v11, v11, s39
  v_add3_u32 v11, v11, v6, s37
  v_lshrrev_b32 v8, 1, v1
  v_and_b32 v9, 1, v1
  v_lshlrev_b32 v9, 4, v9
  v_add_u32 v9, 256, v9
  v_mul_u32_u24 v10, 304, v8
  v_add3_u32 v10, v10, v9, s36
  v_add_u32 v8, s35, v8
  v_mul_lo_u32 v8, v8, s39
  v_add3_u32 v8, v8, v9, s37
  v_accvgpr_read_b32 v32, a0
  v_accvgpr_read_b32 v33, a1
  v_accvgpr_read_b32 v34, a2
  v_accvgpr_read_b32 v35, a3
  v_cvt_pk_bf16_f32 v40, v32, v33
  v_cvt_pk_bf16_f32 v41, v34, v35
  ds_write_b64 v5, v[40:41] offset:0
  v_accvgpr_read_b32 v44, a8
  v_accvgpr_read_b32 v45, a9
  v_accvgpr_read_b32 v46, a10
  v_accvgpr_read_b32 v47, a11
  v_cvt_pk_bf16_f32 v52, v44, v45
  v_cvt_pk_bf16_f32 v53, v46, v47
  ds_write_b64 v5, v[52:53] offset:32
  v_accvgpr_read_b32 v56, a16
  v_accvgpr_read_b32 v57, a17
  v_accvgpr_read_b32 v58, a18
  v_accvgpr_read_b32 v59, a19
  v_cvt_pk_bf16_f32 v64, v56, v57
  v_cvt_pk_bf16_f32 v65, v58, v59
  ds_write_b64 v5, v[64:65] offset:64
  v_accvgpr_read_b32 v68, a24
  v_accvgpr_read_b32 v69, a25
  v_accvgpr_read_b32 v70, a26
  v_accvgpr_read_b32 v71, a27
  v_cvt_pk_bf16_f32 v76, v68, v69
  v_cvt_pk_bf16_f32 v77, v70, v71
  ds_write_b64 v5, v[76:77] offset:96
  v_accvgpr_read_b32 v80, a32
  v_accvgpr_read_b32 v81, a33
  v_accvgpr_read_b32 v82, a34
  v_accvgpr_read_b32 v83, a35
  v_cvt_pk_bf16_f32 v88, v80, v81
  v_cvt_pk_bf16_f32 v89, v82, v83
  ds_write_b64 v5, v[88:89] offset:128
  v_accvgpr_read_b32 v92, a40
  v_accvgpr_read_b32 v93, a41
  v_accvgpr_read_b32 v94, a42
  v_accvgpr_read_b32 v95, a43
  v_cvt_pk_bf16_f32 v100, v92, v93
  v_cvt_pk_bf16_f32 v101, v94, v95
  ds_write_b64 v5, v[100:101] offset:160
  v_accvgpr_read_b32 v104, a48
  v_accvgpr_read_b32 v105, a49
  v_accvgpr_read_b32 v106, a50
  v_accvgpr_read_b32 v107, a51
  v_cvt_pk_bf16_f32 v112, v104, v105
  v_cvt_pk_bf16_f32 v113, v106, v107
  ds_write_b64 v5, v[112:113] offset:192
  v_accvgpr_read_b32 v116, a56
  v_accvgpr_read_b32 v117, a57
  v_accvgpr_read_b32 v118, a58
  v_accvgpr_read_b32 v119, a59
  v_cvt_pk_bf16_f32 v124, v116, v117
  v_cvt_pk_bf16_f32 v125, v118, v119
  ds_write_b64 v5, v[124:125] offset:224
  v_accvgpr_read_b32 v32, a64
  v_accvgpr_read_b32 v33, a65
  v_accvgpr_read_b32 v34, a66
  v_accvgpr_read_b32 v35, a67
  v_cvt_pk_bf16_f32 v40, v32, v33
  v_cvt_pk_bf16_f32 v41, v34, v35
  ds_write_b64 v5, v[40:41] offset:256
  v_accvgpr_read_b32 v32, a4
  v_accvgpr_read_b32 v33, a5
  v_accvgpr_read_b32 v34, a6
  v_accvgpr_read_b32 v35, a7
  v_cvt_pk_bf16_f32 v40, v32, v33
  v_cvt_pk_bf16_f32 v41, v34, v35
  ds_write_b64 v5, v[40:41] offset:4864
  v_accvgpr_read_b32 v44, a12
  v_accvgpr_read_b32 v45, a13
  v_accvgpr_read_b32 v46, a14
  v_accvgpr_read_b32 v47, a15
  v_cvt_pk_bf16_f32 v52, v44, v45
  v_cvt_pk_bf16_f32 v53, v46, v47
  ds_write_b64 v5, v[52:53] offset:4896
  v_accvgpr_read_b32 v56, a20
  v_accvgpr_read_b32 v57, a21
  v_accvgpr_read_b32 v58, a22
  v_accvgpr_read_b32 v59, a23
  v_cvt_pk_bf16_f32 v64, v56, v57
  v_cvt_pk_bf16_f32 v65, v58, v59
  ds_write_b64 v5, v[64:65] offset:4928
  v_accvgpr_read_b32 v68, a28
  v_accvgpr_read_b32 v69, a29
  v_accvgpr_read_b32 v70, a30
  v_accvgpr_read_b32 v71, a31
  v_cvt_pk_bf16_f32 v76, v68, v69
  v_cvt_pk_bf16_f32 v77, v70, v71
  ds_write_b64 v5, v[76:77] offset:4960
  v_accvgpr_read_b32 v80, a36
  v_accvgpr_read_b32 v81, a37
  v_accvgpr_read_b32 v82, a38
  v_accvgpr_read_b32 v83, a39
  v_cvt_pk_bf16_f32 v88, v80, v81
  v_cvt_pk_bf16_f32 v89, v82, v83
  ds_write_b64 v5, v[88:89] offset:4992
  v_accvgpr_read_b32 v92, a44
  v_accvgpr_read_b32 v93, a45
  v_accvgpr_read_b32 v94, a46
  v_accvgpr_read_b32 v95, a47
  v_cvt_pk_bf16_f32 v100, v92, v93
  v_cvt_pk_bf16_f32 v101, v94, v95
  ds_write_b64 v5, v[100:101] offset:5024
  v_accvgpr_read_b32 v104, a52
  v_accvgpr_read_b32 v105, a53
  v_accvgpr_read_b32 v106, a54
  v_accvgpr_read_b32 v107, a55
  v_cvt_pk_bf16_f32 v112, v104, v105
  v_cvt_pk_bf16_f32 v113, v106, v107
  ds_write_b64 v5, v[112:113] offset:5056
  v_accvgpr_read_b32 v116, a60
  v_accvgpr_read_b32 v117, a61
  v_accvgpr_read_b32 v118, a62
  v_accvgpr_read_b32 v119, a63
  v_cvt_pk_bf16_f32 v124, v116, v117
  v_cvt_pk_bf16_f32 v125, v118, v119
  ds_write_b64 v5, v[124:125] offset:5088
  v_accvgpr_read_b32 v32, a68
  v_accvgpr_read_b32 v33, a69
  v_accvgpr_read_b32 v34, a70
  v_accvgpr_read_b32 v35, a71
  v_cvt_pk_bf16_f32 v40, v32, v33
  v_cvt_pk_bf16_f32 v41, v34, v35
  ds_write_b64 v5, v[40:41] offset:5120
  s_waitcnt lgkmcnt(0)
  ds_read_b128 v[128:131], v7 offset:0
  ds_read_b128 v[132:135], v7 offset:1216
  ds_read_b128 v[136:139], v7 offset:2432
  ds_read_b128 v[140:143], v7 offset:3648
  ds_read_b128 v[144:147], v7 offset:4864
  ds_read_b128 v[148:151], v7 offset:6080
  ds_read_b128 v[152:155], v7 offset:7296
  ds_read_b128 v[156:159], v7 offset:8512
  ds_read_b128 v[160:163], v10
  s_mov_b32 s40, 0
  s_waitcnt lgkmcnt(8)
  buffer_store_dwordx4 v[128:131], v11, s[20:23], s40 offen
  s_mov_b32 s40, 4608
  s_waitcnt lgkmcnt(7)
  buffer_store_dwordx4 v[132:135], v11, s[20:23], s40 offen
  s_mov_b32 s40, 9216
  s_waitcnt lgkmcnt(6)
  buffer_store_dwordx4 v[136:139], v11, s[20:23], s40 offen
  s_mov_b32 s40, 13824
  s_waitcnt lgkmcnt(5)
  buffer_store_dwordx4 v[140:143], v11, s[20:23], s40 offen
  s_mov_b32 s40, 18432
  s_waitcnt lgkmcnt(4)
  buffer_store_dwordx4 v[144:147], v11, s[20:23], s40 offen
  s_mov_b32 s40, 23040
  s_waitcnt lgkmcnt(3)
  buffer_store_dwordx4 v[148:151], v11, s[20:23], s40 offen
  s_mov_b32 s40, 27648
  s_waitcnt lgkmcnt(2)
  buffer_store_dwordx4 v[152:155], v11, s[20:23], s40 offen
  s_mov_b32 s40, 32256
  s_waitcnt lgkmcnt(1)
  buffer_store_dwordx4 v[156:159], v11, s[20:23], s40 offen
  s_waitcnt lgkmcnt(0)
  buffer_store_dwordx4 v[160:163], v8, s[20:23], 0 offen
g_end_42:
  s_endpgm
.text
.globl fin_kernel
.p2align 8
.type fin_kernel,@function
fin_kernel:
  s_cmp_ge_u32 s2, 256
  s_cbranch_scc1 ln_end_44
  s_load_dwordx2 s[4:5], s[0:1], 0
  s_load_dwordx2 s[6:7], s[0:1], 96
  s_load_dwordx2 s[8:9], s[0:1], 80
  v_lshrrev_b32 v1, 5, v0
  s_lshl_b32 s3, s2, 3
  v_add_u32 v1, s3, v1
  v_and_b32 v2, 31, v0
  v_lshlrev_b32 v2, 2, v2
  s_movk_i32 s10, 1152
  v_mul_lo_u32 v3, v1, s10
  v_add_u32 v3, v3, v2
  v_lshlrev_b32 v4, 1, v3
  s_waitcnt lgkmcnt(0)
  s_mov_b32 s12, s6
  s_mov_b32 s13, s7
  s_mov_b32 s14, 0x1b00
  s_mov_b32 s15, 0x00020000
  s_add_u32 s16, s6, 0x250000
  s_addc_u32 s17, s7, 0
  s_mov_b32 s18, 0x240000
  s_mov_b32 s19, 0x00020000
  s_mov_b32 s20, s8
  s_mov_b32 s21, s9
  s_mov_b32 s22, 0x240000
  s_mov_b32 s23, 0x00020000
  s_add_u32 s28, s6, 0x5400000
  s_addc_u32 s29, s7, 0
  s_mov_b32 s30, 0x900000
  s_mov_b32 s31, 0x00020000
  buffer_load_dword v10, v3, s[16:19], 0 offen offset:0
  buffer_load_dword v11, v3, s[16:19], 0 offen offset:128
  buffer_load_dword v12, v3, s[16:19], 0 offen offset:256
  buffer_load_dword v13, v3, s[16:19], 0 offen offset:384
  buffer_load_dword v14, v3, s[16:19], 0 offen offset:512
  buffer_load_dword v15, v3, s[16:19], 0 offen offset:640
  buffer_load_dword v16, v3, s[16:19], 0 offen offset:768
  buffer_load_dword v17, v3, s[16:19], 0 offen offset:896
  buffer_load_dword v18, v3, s[16:19], 0 offen offset:1024
  s_movk_i32 s11, 5760
  buffer_load_dword v40, v2, s[12:15], s11 offen offset:0
  buffer_load_dword v41, v2, s[12:15], s11 offen offset:128
  buffer_load_dword v42, v2, s[12:15], s11 offen offset:256
  buffer_load_dword v43, v2, s[12:15], s11 offen offset:384
  buffer_load_dword v44, v2, s[12:15], s11 offen offset:512
  buffer_load_dword v45, v2, s[12:15], s11 offen offset:640
  buffer_load_dword v46, v2, s[12:15], s11 offen offset:768
  buffer_load_dword v47, v2, s[12:15], s11 offen offset:896
  buffer_load_dword v48, v2, s[12:15], s11 offen offset:1024
  s_mov_b32 s11, 0x0
  buffer_load_dword v80, v3, s[28:31], s11 offen offset:0
  buffer_load_dword v82, v3, s[28:31], s11 offen offset:128
  buffer_load_dword v84, v3, s[28:31], s11 offen offset:256
  buffer_load_dword v86, v3, s[28:31], s11 offen offset:384
  buffer_load_dword v88, v3, s[28:31], s11 offen offset:512
  buffer_load_dword v90, v3, s[28:31], s11 offen offset:640
  buffer_load_dword v92, v3, s[28:31], s11 offen offset:768
  buffer_load_dword v94, v3, s[28:31], s11 offen offset:896
  buffer_load_dword v96, v3, s[28:31], s11 offen offset:1024
  s_mov_b32 s11, 0x240000
  buffer_load_dword v98, v3, s[28:31], s11 offen offset:0
  buffer_load_dword v100, v3, s[28:31], s11 offen offset:128
  buffer_load_dword v102, v3, s[28:31], s11 offen offset:256
  buffer_load_dword v104, v3, s[28:31], s11 offen offset:384
  buffer_load_dword v106, v3, s[28:31], s11 offen offset:512
  buffer_load_dword v108, v3, s[28:31], s11 offen offset:640
  buffer_load_dword v110, v3, s[28:31], s11 offen offset:768
  buffer_load_dword v112, v3, s[28:31], s11 offen offset:896
  buffer_load_dword v114, v3, s[28:31], s11 offen offset:1024
  s_mov_b32 s11, 0x480000
  buffer_load_dword v116, v3, s[28:31], s11 offen offset:0
  buffer_load_dword v118, v3, s[28:31], s11 offen offset:128
  buffer_load_dword v120, v3, s[28:31], s11 offen offset:256
  buffer_load_dword v122, v3, s[28:31], s11 offen offset:384
  buffer_load_dword v124, v3, s[28:31], s11 offen offset:512
  buffer_load_dword v126, v3, s[28:31], s11 offen offset:640
  buffer_load_dword v128, v3, s[28:31], s11 offen offset:768
  buffer_load_dword v130, v3, s[28:31], s11 offen offset:896
  buffer_load_dword v132, v3, s[28:31], s11 offen offset:1024
  s_mov_b32 s11, 0x6c0000
  buffer_load_dword v134, v3, s[28:31], s11 offen offset:0
  buffer_load_dword v136, v3, s[28:31], s11 offen offset:128
  buffer_load_dword v138, v3, s[28:31], s11 offen offset:256
  buffer_load_dword v140, v3, s[28:31], s11 offen offset:384
  buffer_load_dword v142, v3, s[28:31], s11 offen offset:512
  buffer_load_dword v144, v3, s[28:31], s11 offen offset:640
  buffer_load_dword v146, v3, s[28:31], s11 offen offset:768
  buffer_load_dword v148, v3, s[28:31], s11 offen offset:896
  buffer_load_dword v150, v3, s[28:31], s11 offen offset:1024
  s_waitcnt vmcnt(0)
  v_lshlrev_b32 v60, 16, v10
  v_and_b32 v61, 0xffff0000, v10
  v_lshlrev_b32 v62, 16, v11
  v_and_b32 v63, 0xffff0000, v11
  v_lshlrev_b32 v64, 16, v12
  v_and_b32 v65, 0xffff0000, v12
  v_lshlrev_b32 v66, 16, v13
  v_and_b32 v67, 0xffff0000, v13
  v_lshlrev_b32 v68, 16, v14
  v_and_b32 v69, 0xffff0000, v14
  v_lshlrev_b32 v70, 16, v15
  v_and_b32 v71, 0xffff0000, v15
  v_lshlrev_b32 v72, 16, v16
  v_and_b32 v73, 0xffff0000, v16
  v_lshlrev_b32 v74, 16, v17
  v_and_b32 v75, 0xffff0000, v17
  v_lshlrev_b32 v76, 16, v18
  v_and_b32 v77, 0xffff0000, v18
  v_and_b32 v81, 0xffff0000, v80
  v_lshlrev_b32 v80, 16, v80
  v_and_b32 v99, 0xffff0000, v98
  v_lshlrev_b32 v98, 16, v98
  v_and_b32 v117, 0xffff0000, v116
  v_lshlrev_b32 v116, 16, v116
  v_and_b32 v135, 0xffff0000, v134
  v_lshlrev_b32 v134, 16, v134
  v_add_f32 v80, v80, v98
  v_add_f32 v81, v81, v99
  v_add_f32 v80, v80, v116
  v_add_f32 v81, v81, v117
  v_add_f32 v80, v80, v134
  v_add_f32 v81, v81, v135
  v_cvt_pk_bf16_f32 v5, v80, v81
  v_lshlrev_b32 v80, 16, v5
  v_and_b32 v81, 0xffff0000, v5
  v_lshlrev_b32 v6, 16, v40
  v_and_b32 v7, 0xffff0000, v40
  v_mul_f32 v80, v80, v6
  v_mul_f32 v81, v81, v7
  v_cvt_pk_bf16_f32 v5, v80, v81
  v_lshlrev_b32 v80, 16, v5
  v_and_b32 v81, 0xffff0000, v5
  v_add_f32 v60, v60, v80
  v_add_f32 v61, v61, v81
  v_cvt_pk_bf16_f32 v10, v60, v61
  v_lshlrev_b32 v60, 16, v10
  v_and_b32 v61, 0xffff0000, v10
  buffer_store_dword v10, v3, s[20:23], 0 offen offset:0
  v_and_b32 v83, 0xffff0000, v82
  v_lshlrev_b32 v82, 16, v82
  v_and_b32 v101, 0xffff0000, v100
  v_lshlrev_b32 v100, 16, v100
  v_and_b32 v119, 0xffff0000, v118
  v_lshlrev_b32 v118, 16, v118
  v_and_b32 v137, 0xffff0000, v136
  v_lshlrev_b32 v136, 16, v136
  v_add_f32 v82, v82, v100
  v_add_f32 v83, v83, v101
  v_add_f32 v82, v82, v118
  v_add_f32 v83, v83, v119
  v_add_f32 v82, v82, v136
  v_add_f32 v83, v83, v137
  v_cvt_pk_bf16_f32 v5, v82, v83
  v_lshlrev_b32 v82, 16, v5
  v_and_b32 v83, 0xffff0000, v5
  v_lshlrev_b32 v6, 16, v41
  v_and_b32 v7, 0xffff0000, v41
  v_mul_f32 v82, v82, v6
  v_mul_f32 v83, v83, v7
  v_cvt_pk_bf16_f32 v5, v82, v83
  v_lshlrev_b32 v82, 16, v5
  v_and_b32 v83, 0xffff0000, v5
  v_add_f32 v62, v62, v82
  v_add_f32 v63, v63, v83
  v_cvt_pk_bf16_f32 v11, v62, v63
  v_lshlrev_b32 v62, 16, v11
  v_and_b32 v63, 0xffff0000, v11
  buffer_store_dword v11, v3, s[20:23], 0 offen offset:128
  v_and_b32 v85, 0xffff0000, v84
  v_lshlrev_b32 v84, 16, v84
  v_and_b32 v103, 0xffff0000, v102
  v_lshlrev_b32 v102, 16, v102
  v_and_b32 v121, 0xffff0000, v120
  v_lshlrev_b32 v120, 16, v120
  v_and_b32 v139, 0xffff0000, v138
  v_lshlrev_b32 v138, 16, v138
  v_add_f32 v84, v84, v102
  v_add_f32 v85, v85, v103
  v_add_f32 v84, v84, v120
  v_add_f32 v85, v85, v121
  v_add_f32 v84, v84, v138
  v_add_f32 v85, v85, v139
  v_cvt_pk_bf16_f32 v5, v84, v85
  v_lshlrev_b32 v84, 16, v5
  v_and_b32 v85, 0xffff0000, v5
  v_lshlrev_b32 v6, 16, v42
  v_and_b32 v7, 0xffff0000, v42
  v_mul_f32 v84, v84, v6
  v_mul_f32 v85, v85, v7
  v_cvt_pk_bf16_f32 v5, v84, v85
  v_lshlrev_b32 v84, 16, v5
  v_and_b32 v85, 0xffff0000, v5
  v_add_f32 v64, v64, v84
  v_add_f32 v65, v65, v85
  v_cvt_pk_bf16_f32 v12, v64, v65
  v_lshlrev_b32 v64, 16, v12
  v_and_b32 v65, 0xffff0000, v12
  buffer_store_dword v12, v3, s[20:23], 0 offen offset:256
  v_and_b32 v87, 0xffff0000, v86
  v_lshlrev_b32 v86, 16, v86
  v_and_b32 v105, 0xffff0000, v104
  v_lshlrev_b32 v104, 16, v104
  v_and_b32 v123, 0xffff0000, v122
  v_lshlrev_b32 v122, 16, v122
  v_and_b32 v141, 0xffff0000, v140
  v_lshlrev_b32 v140, 16, v140
  v_add_f32 v86, v86, v104
  v_add_f32 v87, v87, v105
  v_add_f32 v86, v86, v122
  v_add_f32 v87, v87, v123
  v_add_f32 v86, v86, v140
  v_add_f32 v87, v87, v141
  v_cvt_pk_bf16_f32 v5, v86, v87
  v_lshlrev_b32 v86, 16, v5
  v_and_b32 v87, 0xffff0000, v5
  v_lshlrev_b32 v6, 16, v43
  v_and_b32 v7, 0xffff0000, v43
  v_mul_f32 v86, v86, v6
  v_mul_f32 v87, v87, v7
  v_cvt_pk_bf16_f32 v5, v86, v87
  v_lshlrev_b32 v86, 16, v5
  v_and_b32 v87, 0xffff0000, v5
  v_add_f32 v66, v66, v86
  v_add_f32 v67, v67, v87
  v_cvt_pk_bf16_f32 v13, v66, v67
  v_lshlrev_b32 v66, 16, v13
  v_and_b32 v67, 0xffff0000, v13
  buffer_store_dword v13, v3, s[20:23], 0 offen offset:384
  v_and_b32 v89, 0xffff0000, v88
  v_lshlrev_b32 v88, 16, v88
  v_and_b32 v107, 0xffff0000, v106
  v_lshlrev_b32 v106, 16, v106
  v_and_b32 v125, 0xffff0000, v124
  v_lshlrev_b32 v124, 16, v124
  v_and_b32 v143, 0xffff0000, v142
  v_lshlrev_b32 v142, 16, v142
  v_add_f32 v88, v88, v106
  v_add_f32 v89, v89, v107
  v_add_f32 v88, v88, v124
  v_add_f32 v89, v89, v125
  v_add_f32 v88, v88, v142
  v_add_f32 v89, v89, v143
  v_cvt_pk_bf16_f32 v5, v88, v89
  v_lshlrev_b32 v88, 16, v5
  v_and_b32 v89, 0xffff0000, v5
  v_lshlrev_b32 v6, 16, v44
  v_and_b32 v7, 0xffff0000, v44
  v_mul_f32 v88, v88, v6
  v_mul_f32 v89, v89, v7
  v_cvt_pk_bf16_f32 v5, v88, v89
  v_lshlrev_b32 v88, 16, v5
  v_and_b32 v89, 0xffff0000, v5
  v_add_f32 v68, v68, v88
  v_add_f32 v69, v69, v89
  v_cvt_pk_bf16_f32 v14, v68, v69
  v_lshlrev_b32 v68, 16, v14
  v_and_b32 v69, 0xffff0000, v14
  buffer_store_dword v14, v3, s[20:23], 0 offen offset:512
  v_and_b32 v91, 0xffff0000, v90
  v_lshlrev_b32 v90, 16, v90
  v_and_b32 v109, 0xffff0000, v108
  v_lshlrev_b32 v108, 16, v108
  v_and_b32 v127, 0xffff0000, v126
  v_lshlrev_b32 v126, 16, v126
  v_and_b32 v145, 0xffff0000, v144
  v_lshlrev_b32 v144, 16, v144
  v_add_f32 v90, v90, v108
  v_add_f32 v91, v91, v109
  v_add_f32 v90, v90, v126
  v_add_f32 v91, v91, v127
  v_add_f32 v90, v90, v144
  v_add_f32 v91, v91, v145
  v_cvt_pk_bf16_f32 v5, v90, v91
  v_lshlrev_b32 v90, 16, v5
  v_and_b32 v91, 0xffff0000, v5
  v_lshlrev_b32 v6, 16, v45
  v_and_b32 v7, 0xffff0000, v45
  v_mul_f32 v90, v90, v6
  v_mul_f32 v91, v91, v7
  v_cvt_pk_bf16_f32 v5, v90, v91
  v_lshlrev_b32 v90, 16, v5
  v_and_b32 v91, 0xffff0000, v5
  v_add_f32 v70, v70, v90
  v_add_f32 v71, v71, v91
  v_cvt_pk_bf16_f32 v15, v70, v71
  v_lshlrev_b32 v70, 16, v15
  v_and_b32 v71, 0xffff0000, v15
  buffer_store_dword v15, v3, s[20:23], 0 offen offset:640
  v_and_b32 v93, 0xffff0000, v92
  v_lshlrev_b32 v92, 16, v92
  v_and_b32 v111, 0xffff0000, v110
  v_lshlrev_b32 v110, 16, v110
  v_and_b32 v129, 0xffff0000, v128
  v_lshlrev_b32 v128, 16, v128
  v_and_b32 v147, 0xffff0000, v146
  v_lshlrev_b32 v146, 16, v146
  v_add_f32 v92, v92, v110
  v_add_f32 v93, v93, v111
  v_add_f32 v92, v92, v128
  v_add_f32 v93, v93, v129
  v_add_f32 v92, v92, v146
  v_add_f32 v93, v93, v147
  v_cvt_pk_bf16_f32 v5, v92, v93
  v_lshlrev_b32 v92, 16, v5
  v_and_b32 v93, 0xffff0000, v5
  v_lshlrev_b32 v6, 16, v46
  v_and_b32 v7, 0xffff0000, v46
  v_mul_f32 v92, v92, v6
  v_mul_f32 v93, v93, v7
  v_cvt_pk_bf16_f32 v5, v92, v93
  v_lshlrev_b32 v92, 16, v5
  v_and_b32 v93, 0xffff0000, v5
  v_add_f32 v72, v72, v92
  v_add_f32 v73, v73, v93
  v_cvt_pk_bf16_f32 v16, v72, v73
  v_lshlrev_b32 v72, 16, v16
  v_and_b32 v73, 0xffff0000, v16
  buffer_store_dword v16, v3, s[20:23], 0 offen offset:768
  v_and_b32 v95, 0xffff0000, v94
  v_lshlrev_b32 v94, 16, v94
  v_and_b32 v113, 0xffff0000, v112
  v_lshlrev_b32 v112, 16, v112
  v_and_b32 v131, 0xffff0000, v130
  v_lshlrev_b32 v130, 16, v130
  v_and_b32 v149, 0xffff0000, v148
  v_lshlrev_b32 v148, 16, v148
  v_add_f32 v94, v94, v112
  v_add_f32 v95, v95, v113
  v_add_f32 v94, v94, v130
  v_add_f32 v95, v95, v131
  v_add_f32 v94, v94, v148
  v_add_f32 v95, v95, v149
  v_cvt_pk_bf16_f32 v5, v94, v95
  v_lshlrev_b32 v94, 16, v5
  v_and_b32 v95, 0xffff0000, v5
  v_lshlrev_b32 v6, 16, v47
  v_and_b32 v7, 0xffff0000, v47
  v_mul_f32 v94, v94, v6
  v_mul_f32 v95, v95, v7
  v_cvt_pk_bf16_f32 v5, v94, v95
  v_lshlrev_b32 v94, 16, v5
  v_and_b32 v95, 0xffff0000, v5
  v_add_f32 v74, v74, v94
  v_add_f32 v75, v75, v95
  v_cvt_pk_bf16_f32 v17, v74, v75
  v_lshlrev_b32 v74, 16, v17
  v_and_b32 v75, 0xffff0000, v17
  buffer_store_dword v17, v3, s[20:23], 0 offen offset:896
  v_and_b32 v97, 0xffff0000, v96
  v_lshlrev_b32 v96, 16, v96
  v_and_b32 v115, 0xffff0000, v114
  v_lshlrev_b32 v114, 16, v114
  v_and_b32 v133, 0xffff0000, v132
  v_lshlrev_b32 v132, 16, v132
  v_and_b32 v151, 0xffff0000, v150
  v_lshlrev_b32 v150, 16, v150
  v_add_f32 v96, v96, v114
  v_add_f32 v97, v97, v115
  v_add_f32 v96, v96, v132
  v_add_f32 v97, v97, v133
  v_add_f32 v96, v96, v150
  v_add_f32 v97, v97, v151
  v_cvt_pk_bf16_f32 v5, v96, v97
  v_lshlrev_b32 v96, 16, v5
  v_and_b32 v97, 0xffff0000, v5
  v_lshlrev_b32 v6, 16, v48
  v_and_b32 v7, 0xffff0000, v48
  v_mul_f32 v96, v96, v6
  v_mul_f32 v97, v97, v7
  v_cvt_pk_bf16_f32 v5, v96, v97
  v_lshlrev_b32 v96, 16, v5
  v_and_b32 v97, 0xffff0000, v5
  v_add_f32 v76, v76, v96
  v_add_f32 v77, v77, v97
  v_cvt_pk_bf16_f32 v18, v76, v77
  v_lshlrev_b32 v76, 16, v18
  v_and_b32 v77, 0xffff0000, v18
  buffer_store_dword v18, v3, s[20:23], 0 offen offset:1024
ln_end_44:
  s_endpgm
.section .rodata,"a"
.p2align 6
.amdhsa_kernel mod_kernel
  .amdhsa_next_free_vgpr 64
  .amdhsa_next_free_sgpr 80
  .amdhsa_accum_offset 64
  .amdhsa_group_segment_fixed_size 0
  .amdhsa_kernarg_size 104
  .amdhsa_user_sgpr_count 2
  .amdhsa_user_sgpr_kernarg_segment_ptr 1
  .amdhsa_system_sgpr_workgroup_id_x 1
  .amdhsa_float_denorm_mode_32 3
  .amdhsa_float_denorm_mode_16_64 3
.end_amdhsa_kernel
.section .rodata,"a"
.p2align 6
.amdhsa_kernel ln1_kernel
  .amdhsa_next_free_vgpr 80
  .amdhsa_next_free_sgpr 40
  .amdhsa_accum_offset 80
  .amdhsa_group_segment_fixed_size 0
  .amdhsa_kernarg_size 104
  .amdhsa_user_sgpr_count 2
  .amdhsa_user_sgpr_kernarg_segment_ptr 1
  .amdhsa_system_sgpr_workgroup_id_x 1
  .amdhsa_float_denorm_mode_32 3
  .amdhsa_float_denorm_mode_16_64 3
.end_amdhsa_kernel
.section .rodata,"a"
.p2align 6
.amdhsa_kernel attn_kernel
  .amdhsa_next_free_vgpr 512
  .amdhsa_next_free_sgpr 100
  .amdhsa_accum_offset 256
  .amdhsa_group_segment_fixed_size 0
  .amdhsa_kernarg_size 104
  .amdhsa_user_sgpr_count 2
  .amdhsa_user_sgpr_kernarg_segment_ptr 1
  .amdhsa_system_sgpr_workgroup_id_x 1
  .amdhsa_float_denorm_mode_32 3
  .amdhsa_float_denorm_mode_16_64 3
.end_amdhsa_kernel
.section .rodata,"a"
.p2align 6
.amdhsa_kernel oproj_kernel
  .amdhsa_next_free_vgpr 328
  .amdhsa_next_free_sgpr 48
  .amdhsa_accum_offset 256
  .amdhsa_group_segment_fixed_size 0
  .amdhsa_kernarg_size 104
  .amdhsa_user_sgpr_count 2
  .amdhsa_user_sgpr_kernarg_segment_ptr 1
  .amdhsa_system_sgpr_workgroup_id_x 1
  .amdhsa_float_denorm_mode_32 3
  .amdhsa_float_denorm_mode_16_64 3
.end_amdhsa_kernel
.section .rodata,"a"
.p2align 6
.amdhsa_kernel ln2_kernel
  .amdhsa_next_free_vgpr 152
  .amdhsa_next_free_sgpr 40
  .amdhsa_accum_offset 152
  .amdhsa_group_segment_fixed_size 0
  .amdhsa_kernarg_size 104
  .amdhsa_user_sgpr_count 2
  .amdhsa_user_sgpr_kernarg_segment_ptr 1
  .amdhsa_system_sgpr_workgroup_id_x 1
  .amdhsa_float_denorm_mode_32 3
  .amdhsa_float_denorm_mode_16_64 3
.end_amdhsa_kernel
.section .rodata,"a"
.p2align 6
.amdhsa_kernel ffn1_kernel
  .amdhsa_next_free_vgpr 240
  .amdhsa_next_free_sgpr 48
  .amdhsa_accum_offset 168
  .amdhsa_group_segment_fixed_size 0
  .amdhsa_kernarg_size 104
  .amdhsa_user_sgpr_count 2
  .amdhsa_user_sgpr_kernarg_segment_ptr 1
  .amdhsa_system_sgpr_workgroup_id_x 1
  .amdhsa_float_denorm_mode_32 3
  .amdhsa_float_denorm_mode_16_64 3
.end_amdhsa_kernel
.section .rodata,"a"
.p2align 6
.amdhsa_kernel ffn2_kernel
  .amdhsa_next_free_vgpr 328
  .amdhsa_next_free_sgpr 48
  .amdhsa_accum_offset 256
  .amdhsa_group_segment_fixed_size 0
  .amdhsa_kernarg_size 104
  .amdhsa_user_sgpr_count 2
  .amdhsa_user_sgpr_kernarg_segment_ptr 1
  .amdhsa_system_sgpr_workgroup_id_x 1
  .amdhsa_float_denorm_mode_32 3
  .amdhsa_float_denorm_mode_16_64 3
.end_amdhsa_kernel
.section .rodata,"a"
.p2align 6
.amdhsa_kernel fin_kernel
  .amdhsa_next_free_vgpr 152
  .amdhsa_next_free_sgpr 40
  .amdhsa_accum_offset 152
  .amdhsa_group_segment_fixed_size 0
  .amdhsa_kernarg_size 104
  .amdhsa_user_sgpr_count 2
  .amdhsa_user_sgpr_kernarg_segment_ptr 1
  .amdhsa_system_sgpr_workgroup_id_x 1
  .amdhsa_float_denorm_mode_32 3
  .amdhsa_float_denorm_mode_16_64 3
.end_amdhsa_kernel
```
